```python
import torch

def _softmax(x, axis=-1):
    return torch.softmax(x, dim=axis)
def _gelu(x):
    return torch.nn.functional.gelu(x, approximate="tanh")
def _silu(x):
    return torch.nn.functional.silu(x)
def _sigmoid(x):
    return torch.sigmoid(x)
def _layernorm(x, axis=-1, eps=1e-5):
    m = x.mean(dim=axis, keepdim=True)
    v = x.var(dim=axis, keepdim=True, unbiased=False)
    return (x - m) / torch.sqrt(v + eps)
def _scatter_add(tgt, idx, src, axis=0):
    return tgt.clone().index_add_(axis, idx, src)
def _segment_sum(src, seg, n):
    out = torch.zeros((n,) + src.shape[1:], dtype=src.dtype)
    return out.index_add_(0, seg, src)
def _pad(x, pw):
    flat = tuple(v for pair in reversed(pw) for v in pair)
    return torch.nn.functional.pad(x, flat)

kernel_name = 'interleave_layers__linear_attn_block__mixer_channel_mlp__prompt'

def setup_inputs():

    _w = (lambda a: (lambda t: t.to(torch.bfloat16) if t.is_floating_point() else t)(torch.as_tensor(a)))
    def _A_setup():
        B, S, D = 1, 2048, 576
        return {
            "x": _w((lambda *s: torch.randn(*s, dtype=torch.bfloat16) * 0.05)(B, S, D)),
            "wqkv": _w((lambda *s: torch.randn(*s, dtype=torch.bfloat16) * 0.1)(D, 3 * D)),
            "wo": _w((lambda *s: torch.randn(*s, dtype=torch.bfloat16) * 0.05)(D, D)),
        }
    _A_in = _A_setup()

    def _B_setup():
        B, S, D, F = 1, 2048, 576, 4608
        return {
            "x": _w((lambda *s: torch.randn(*s, dtype=torch.bfloat16) * 0.05)(B, S, D)),
            "w1": _w((lambda *s: torch.randn(*s, dtype=torch.bfloat16) * 3.2)(D, F) * (D ** -0.5)),
            "b1": _w((lambda *s: torch.randn(*s, dtype=torch.bfloat16) * 1.6)(F)),
            "w2": _w((lambda *s: torch.randn(*s, dtype=torch.bfloat16) * 1.6)(F, D) * (F ** -0.5)),
            "b2": _w((lambda *s: torch.randn(*s, dtype=torch.bfloat16) * 1.6)(D)),
        }
    _B_in = _B_setup()

    return {
        "A_x": _A_in["x"],
        "A_wqkv": _A_in["wqkv"],
        "A_wo": _A_in["wo"],
        "B_x": _B_in["x"],
        "B_w1": _B_in["w1"],
        "B_b1": _B_in["b1"],
        "B_w2": _B_in["w2"],
        "B_b2": _B_in["b2"],
    }

def reference(A_x, A_wqkv, A_wo, B_x, B_w1, B_b1, B_w2, B_b2):
    def _A_ref(x, wqkv, wo):
        B, S, D = x.shape
        H = 32; Dh = D // H
        qkv = (lambda x, *d: x.permute(*d))((x @ wqkv).reshape(B, S, 3, H, Dh), 2, 0, 3, 1, 4)
        q, k, v = qkv[0], qkv[1], qkv[2]
        phi = lambda t: torch.where(t > 0, t + 1, torch.exp(t)) + 1e-6
        pq, pk = phi(q), phi(k)
        kv = torch.einsum("bhsd,bhse->bhde", pk, v)
        z = torch.einsum("bhsd->bhd", pk)
        num = torch.einsum("bhqd,bhde->bhqe", pq, kv)
        den = torch.einsum("bhqd,bhd->bhq", pq, z)[..., None] + 1e-6
        o = num / den
        return (lambda x, *d: x.permute(*d))(o, 0, 2, 1, 3).reshape(B, S, D) @ wo

    def _B_ref(x, w1, b1, w2, b2):
        y = _layernorm(x, axis=-1)
        h = _gelu(torch.einsum("bsd,df->bsf", y, w1) + b1)
        return torch.einsum("bsf,fd->bsd", h, w2) + b2

    x = A_x
    x = x + _A_ref(_layernorm(x, axis=-1), A_wqkv, A_wo)
    x = x + _B_ref(_layernorm(x, axis=-1), B_w1, B_b1, B_w2, B_b2)
    x = x + _A_ref(_layernorm(x, axis=-1), A_wqkv, A_wo)
    x = x + _B_ref(_layernorm(x, axis=-1), B_w1, B_b1, B_w2, B_b2)
    return x
```

```asm
; @launch grid=(256,1,1) block=(512,1,1) lds=163840
.amdgcn_target "amdgcn-amd-amdhsa--gfx950"
.text
.globl interleave_layers__linear_attn_block__mixer_channel_mlp__prompt_kernel
.p2align 8
.type interleave_layers__linear_attn_block__mixer_channel_mlp__prompt_kernel,@function
interleave_layers__linear_attn_block__mixer_channel_mlp__prompt_kernel:
    s_cmp_ge_u32 s2, 256
    s_cbranch_scc1 .L_mlp_end
    s_load_dwordx4 s[8:11], s[0:1], 0
    s_load_dwordx2 s[12:13], s[0:1], 80
    s_load_dwordx2 s[52:53], s[0:1], 72
    s_load_dwordx2 s[34:35], s[0:1], 16
    s_load_dwordx4 s[96:99], s[0:1], 32
    s_mov_b64 s[94:95], s[0:1]
    v_lshrrev_b32 v4, 6, v0
    v_and_b32 v1, 63, v0
    v_readfirstlane_b32 s19, v4
    v_lshrrev_b32 v2, 4, v1
    v_and_b32 v3, 15, v1
    s_and_b32 s20, s19, 3
    s_and_b32 s22, s2, 3
    s_lshl_b32 s22, s22, 2
    s_bfe_u32 s23, s2, 0x20003
    s_add_u32 s22, s22, s23
    s_and_b32 s21, s2, 4
    s_lshl_b32 s21, s21, 1
    s_lshr_b32 s23, s2, 5
    s_add_u32 s21, s21, s23
    s_lshl_b32 s24, s22, 3
    s_lshl_b32 s23, s20, 1
    s_add_u32 s24, s24, s23
    v_lshlrev_b32 v5, 4, v1
    s_lshl_b32 s30, s20, 12
    s_cmp_lt_u32 s19, 4
    s_cbranch_scc1 .L_mlp_zp
    s_mul_i32 s26, s24, 18432
    s_sub_u32 s26, s26, 4096
    s_xor_b32 s28, s21, 1
    s_sub_u32 s33, s21, s28
    s_mul_i32 s33, s33, 72
    s_mul_i32 s28, s28, 72
    s_sub_u32 s28, s28, 4096
    s_lshr_b32 s31, s2, 5
    s_bfe_u32 s40, s2, 0x20003
    s_add_u32 s31, s31, s40
    s_lshl_b32 s31, s31, 2
    s_mov_b32 s40, 0x30630630
    s_mov_b32 s41, 0x306
    s_lshr_b64 s[40:41], s[40:41], s31
    s_and_b32 s31, s40, 15
    s_and_b32 s40, s2, 3
    s_add_u32 s31, s31, s40
    s_sub_u32 s40, s31, 9
    s_cmp_lt_u32 s31, 9
    s_cselect_b32 s31, s31, s40
    s_lshl_b32 s32, s31, 7
    v_lshrrev_b32 v6, 3, v1
    v_and_b32 v7, 7, v1
    v_xor_b32 v164, v7, v2
    v_xor_b32 v165, 4, v164
    v_mul_u32_u24 v6, 1152, v6
    v_lshl_add_u32 v160, v164, 4, v6
    v_add_u32 v162, 20480, v160
    v_add_u32 v160, 4096, v160
    v_lshl_add_u32 v161, v165, 4, v6
    v_add_u32 v163, 28672, v161
    v_add_u32 v161, 12288, v161
    s_ashr_i32 s40, s28, 31
    s_ashr_i32 s41, s26, 31
    s_add_u32 m0, s30, 110592
    s_waitcnt lgkmcnt(0)
    s_add_u32 s16, s10, s28
    s_addc_u32 s17, s11, s40
    s_sub_u32 s18, 1990656, s28
    s_mov_b32 s19, 0x20000
    s_add_u32 s8, s8, s26
    s_addc_u32 s9, s9, s41
    s_mov_b32 s10, 40960
    s_mov_b32 s11, 0x20000
    buffer_load_dwordx4 v160, s[8:11], s32 offen offset:0 lds
    buffer_load_dwordx4 v161, s[8:11], s32 offen offset:1024 lds
    buffer_load_dwordx4 v162, s[8:11], s32 offen offset:2048 lds
    buffer_load_dwordx4 v163, s[8:11], s32 offen offset:3072 lds
    s_mov_b32 s27, 3456
    s_mov_b32 s29, 1072
    s_mul_i32 s100, s20, 3840
    s_mul_i32 s40, s20, 55296
    s_add_u32 s40, s40, 4096
    v_mov_b32 v9, 0x31ce0
    v_mul_u32_u24 v7, 137, v1
    v_lshrrev_b32 v7, 11, v7
    v_mul_u32_u24 v8, 15, v7
    v_sub_u32 v6, v1, v8
    v_lshrrev_b32 v8, v6, v9
    v_and_b32 v8, 8, v8
    v_lshl_add_u32 v168, v6, 4, s40
    v_sub_u32 v168, v168, v8
    v_mul_u32_u24 v8, 52, v6
    v_lshrrev_b32 v8, 8, v8
    v_mad_u32_u24 v168, v8, s29, v168
    v_min_u32 v8, 1, v8
    v_mad_i32_i24 v168, v8, s33, v168
    v_and_b32 v6, 1, v7
    v_lshrrev_b32 v8, 1, v7
    v_lshl_add_u32 v8, v6, 2, v8
    v_mad_u32_u24 v168, v8, s27, v168
    v_and_b32 v7, 4, v7
    v_mad_u32_u24 v7, v7, s27, v168
    v_add_u32 v169, 5952, v7
    v_add_u32 v170, 25728, v168
    v_add_u32 v171, 31680, v7
    s_cmp_eq_u32 s20, 3
    s_cselect_b32 s101, 0x0fffffff, -1
    s_add_u32 m0, s100, 0
    s_mul_i32 s25, s32, 1728
    buffer_load_dwordx4 v168, s[16:19], s25 offen offset:0 lds
    buffer_load_dwordx4 v169, s[16:19], s25 offen offset:960 lds
    buffer_load_dwordx4 v170, s[16:19], s25 offen offset:1920 lds
    s_mov_b32 exec_hi, s101
    buffer_load_dwordx4 v171, s[16:19], s25 offen offset:2880 lds
    s_mov_b32 exec_hi, -1
    s_add_u32 m0, s30, 15360
    s_add_u32 s32, s32, 128
    s_cmp_eq_u32 s32, 1152
    s_cselect_b32 s32, 0, s32
    buffer_load_dwordx4 v160, s[8:11], s32 offen offset:0 lds
    buffer_load_dwordx4 v161, s[8:11], s32 offen offset:1024 lds
    buffer_load_dwordx4 v162, s[8:11], s32 offen offset:2048 lds
    buffer_load_dwordx4 v163, s[8:11], s32 offen offset:3072 lds
    v_mov_b32 v172, 0
    v_mov_b32 v173, 0
    v_mov_b32 v174, 0
    v_mov_b32 v175, 0
    s_mov_b32 s54, 256
    s_mov_b32 s55, 0x20000
    s_lshl_b32 s1, s21, 2
    v_mov_b32 v20, s1
    s_lshl_b32 s23, s22, 2
    s_add_u32 s23, s23, s20
    s_add_u32 s1, s1, s20
    s_mul_i32 s1, s1, 3584
    s_add_u32 s44, s12, 0x2700000
    s_addc_u32 s45, s13, 0
    s_add_u32 s44, s44, s1
    s_addc_u32 s45, s45, 0
    s_mov_b32 s46, 0xe00
    s_mov_b32 s47, 0x20000
    s_cmp_eq_u32 s22, 0
    s_cselect_b32 s46, s46, 0
    v_mov_b32 v21, 0x80000000
    buffer_store_dwordx4 v[172:175], v5, s[44:47], 0 offen offset:0 sc1
    buffer_store_dwordx4 v[172:175], v5, s[44:47], 0 offen offset:1024 sc1
    buffer_store_dwordx4 v[172:175], v5, s[44:47], 0 offen offset:2048 sc1
    buffer_store_dwordx4 v[172:175], v5, s[44:47], 0 offen offset:3072 sc1
    v_min_u32 v181, 15, v1
    v_lshlrev_b32 v181, 2, v181
    s_and_b32 s56, s2, 3
    s_bfe_u32 s40, s2, 0x20003
    s_lshl_b32 s40, s40, 2
    s_add_u32 s56, s56, s40
    s_lshr_b32 s40, s2, 6
    s_lshl_b32 s40, s40, 4
    s_add_u32 s56, s56, s40
    s_bfe_u32 s40, s2, 0x10002
    s_lshl_b32 s41, s40, 6
    s_add_u32 s56, s56, s41
    s_bfe_u32 s41, s2, 0x10005
    s_xor_b32 s40, s40, s41
    s_lshl_b32 s40, s40, 7
    s_add_u32 s56, s56, s40
    s_mov_b32 s40, -18
    s_cmp_lt_u32 s56, 18
    s_cselect_b32 s40, 144, s40
    s_cmp_lt_u32 s56, 162
    s_cselect_b32 s40, s40, 0
    s_add_u32 s56, s56, s40
    s_mul_i32 s14, s20, 9216
    s_add_u32 s14, s14, 126976
    s_sub_u32 s86, s56, 144
    s_mul_i32 s87, s86, 36
    s_lshr_b32 s88, s20, 1
    s_lshl_b32 s88, s88, 2
    s_add_u32 s87, s87, s88
    s_lshl_b32 s88, s20, 3
    s_add_u32 s87, s87, s88
    s_sub_u32 s86, s56, 160
    s_mul_i32 s86, s86, 288
    s_mul_i32 s89, s20, 72
    s_add_u32 s86, s86, s89
    s_add_u32 s86, s86, 16
    s_cmp_ge_u32 s56, 160
    s_cselect_b32 s87, s86, s87
    s_cselect_b32 s89, 36864, 0
    s_sub_u32 s86, s56, 144
    s_cmp_lt_u32 s86, 18
    s_cselect_b32 s87, s87, 0
    s_cselect_b32 s46, 663552, 0
    s_mul_i32 s87, s87, 1152
    s_sub_u32 s46, s46, s87
    s_add_u32 s44, s34, s87
    s_addc_u32 s45, s35, 0
    s_mov_b32 s47, 0x20000
    s_add_u32 s84, s89, 4096
    s_add_u32 s85, s89, 8192
    v_add_u32 v148, s84, v5
    v_add_u32 v6, 4096, v5
    v_cmp_gt_u32 vcc, 32, v1
    s_nop 1
    v_cndmask_b32 v148, v148, v6, vcc
    s_lshr_b32 s86, s56, 1
    s_lshl_b32 s89, s86, 7
    s_and_b32 s86, s56, 1
    s_lshl_b32 s88, s20, 1
    s_add_u32 s88, s88, s86
    s_mul_i32 s88, s88, 663552
    s_add_u32 s87, s89, s88
    s_sub_u32 s88, 5312512, s87
    s_add_u32 s96, s96, s87
    s_addc_u32 s97, s97, 0
    s_sub_u32 s96, s96, 4096
    s_subb_u32 s97, s97, 0
    s_lshl_b32 s87, s20, 5
    s_add_u32 s87, s87, s89
    s_xor_b32 s86, s86, 1
    s_lshl_b32 s86, s86, 5
    s_cmp_lt_u32 s56, 144
    s_cselect_b32 s44, s96, s44
    s_cselect_b32 s45, s97, s45
    s_cselect_b32 s46, s88, s46
    s_cselect_b32 s43, 73728, 0
    s_cselect_b32 s84, 0, s84
    s_cselect_b32 s85, 0, s85
    s_cselect_b32 s87, s87, 0
    s_cselect_b32 s88, s86, 0
    s_cselect_b64 s[0:1], -1, 0
    s_add_u32 s96, s98, s87
    s_addc_u32 s97, s99, 0
    s_mov_b32 s98, s88
    s_mov_b32 s99, 0x20000
    v_lshlrev_b32 v43, 1, v3
    buffer_load_ushort v43, v43, s[96:99], 0 offen
    v_lshrrev_b32 v6, 3, v1
    v_mul_u32_u24 v6, 9216, v6
    v_and_b32 v7, 7, v1
    v_lshrrev_b32 v8, 2, v1
    v_and_b32 v8, 4, v8
    v_xor_b32 v7, v7, v8
    v_lshl_add_u32 v6, v7, 4, v6
    v_xor_b32 v7, 0, v6
    v_add_u32 v7, 4096, v7
    v_cndmask_b32 v144, v5, v7, s[0:1]
    v_xor_b32 v7, 32, v6
    v_add_u32 v7, 3072, v7
    v_cndmask_b32 v145, v5, v7, s[0:1]
    v_xor_b32 v7, 64, v6
    v_add_u32 v7, 2048, v7
    v_cndmask_b32 v146, v5, v7, s[0:1]
    v_xor_b32 v7, 96, v6
    v_add_u32 v7, 1024, v7
    v_cndmask_b32 v147, v5, v7, s[0:1]
    v_cndmask_b32 v148, v148, v144, s[0:1]
    v_lshrrev_b32 v6, 2, v3
    v_and_b32 v7, 3, v3
    v_lshl_add_u32 v6, v2, 2, v6
    v_mul_u32_u24 v11, 480, v6
    v_lshl_add_u32 v10, v7, 3, v11
    v_lshlrev_b32 v7, 3, v7
    v_mov_b32 v6, 0x28c078c0
    v_lshrrev_b32 v6, v7, v6
    v_and_b32 v6, 0xff, v6
    v_add_u32 v11, v11, v6
    s_add_u32 m0, s100, 31744
    s_mul_i32 s25, s32, 1728
    buffer_load_dwordx4 v168, s[16:19], s25 offen offset:0 lds
    buffer_load_dwordx4 v169, s[16:19], s25 offen offset:960 lds
    buffer_load_dwordx4 v170, s[16:19], s25 offen offset:1920 lds
    s_mov_b32 exec_hi, s101
    buffer_load_dwordx4 v171, s[16:19], s25 offen offset:2880 lds
    s_mov_b32 exec_hi, -1
    s_mul_i32 s15, s23, 37
    s_lshr_b32 s15, s15, 8
    s_mul_i32 s41, s15, 7
    s_sub_u32 s41, s23, s41
    s_lshl_b32 s41, s41, 1
    s_sub_u32 s35, s15, s31
    s_add_u32 s3, s35, 9
    s_cmp_lt_u32 s15, s31
    s_cselect_b32 s35, s3, s35
    s_and_b32 s3, s35, 3
    s_mul_i32 s3, s3, 31744
    s_cmp_eq_u32 s23, 63
    s_cselect_b32 s35, 99, s35
    s_mov_b32 s86, 0xd080a050
    s_mov_b32 s87, 0x300000
    s_sub_u32 s40, s41, 7
    s_cmp_lt_u32 s41, 7
    s_cselect_b32 s40, s41, s40
    s_cselect_b32 s88, 0, 7680
    s_lshl_b32 s89, s40, 3
    s_lshr_b64 s[86:87], s[86:87], s89
    s_and_b32 s86, s86, 0xff
    s_add_u32 s86, s86, s88
    s_add_u32 s86, s86, s3
    s_cmp_eq_u32 s40, 4
    s_cselect_b64 vcc, -1, 0
    v_cndmask_b32 v34, v10, v11, vcc
    v_add_u32 v34, s86, v34
    s_lshr_b32 s88, s88, 10
    s_and_b32 s88, s88, 4
    s_lshl_b32 s89, s15, 3
    s_add_u32 s88, s88, s89
    v_add_u32 v6, s88, v2
    v_mul_u32_u24 v7, 57, v6
    v_lshrrev_b32 v7, 9, v7
    v_mul_u32_u24 v8, 9, v7
    v_sub_u32 v6, v6, v8
    v_lshl_add_u32 v8, v7, 3, v6
    v_add_u32 v7, 64, v7
    v_cmp_eq_u32 vcc, 8, v6
    s_nop 1
    v_cndmask_b32 v6, v8, v7, vcc
    v_lshrrev_b32 v7, 2, v6
    v_mul_u32_u24 v7, 6144, v7
    v_lshl_add_u32 v7, v6, 8, v7
    s_lshl_b32 s40, s40, 10
    v_lshl_add_u32 v6, v3, 4, s40
    v_add_u32 v36, v6, v7
    s_add_u32 s41, s41, 1
    s_mov_b32 s86, 0xd080a050
    s_mov_b32 s87, 0x300000
    s_sub_u32 s40, s41, 7
    s_cmp_lt_u32 s41, 7
    s_cselect_b32 s40, s41, s40
    s_cselect_b32 s88, 0, 7680
    s_lshl_b32 s89, s40, 3
    s_lshr_b64 s[86:87], s[86:87], s89
    s_and_b32 s86, s86, 0xff
    s_add_u32 s86, s86, s88
    s_add_u32 s86, s86, s3
    s_cmp_eq_u32 s40, 4
    s_cselect_b64 vcc, -1, 0
    v_cndmask_b32 v35, v10, v11, vcc
    v_add_u32 v35, s86, v35
    s_lshr_b32 s88, s88, 10
    s_and_b32 s88, s88, 4
    s_lshl_b32 s89, s15, 3
    s_add_u32 s88, s88, s89
    v_add_u32 v6, s88, v2
    v_mul_u32_u24 v7, 57, v6
    v_lshrrev_b32 v7, 9, v7
    v_mul_u32_u24 v8, 9, v7
    v_sub_u32 v6, v6, v8
    v_lshl_add_u32 v8, v7, 3, v6
    v_add_u32 v7, 64, v7
    v_cmp_eq_u32 vcc, 8, v6
    s_nop 1
    v_cndmask_b32 v6, v8, v7, vcc
    v_lshrrev_b32 v7, 2, v6
    v_mul_u32_u24 v7, 6144, v7
    v_lshl_add_u32 v7, v6, 8, v7
    s_lshl_b32 s40, s40, 10
    v_lshl_add_u32 v6, v3, 4, s40
    v_add_u32 v37, v6, v7
    s_add_u32 s41, s41, 1
    s_mul_i32 s40, s21, 136192
    s_add_u32 s36, s12, 0xa50000
    s_addc_u32 s37, s13, 0
    s_add_u32 s36, s36, s40
    s_addc_u32 s37, s37, 0
    s_mov_b32 s38, 0x21400
    s_mov_b32 s39, 0x20000
    s_mul_i32 s1, s21, 2816
    s_add_u32 s96, s12, 0x14e0000
    s_addc_u32 s97, s13, 0
    s_add_u32 s96, s96, s1
    s_addc_u32 s97, s97, 0
    s_mov_b32 s98, 0xb00
    s_mov_b32 s99, 0x20000
    s_cmp_eq_u32 s23, 3
    s_cselect_b32 s98, s98, 0
    buffer_store_dwordx4 v[172:175], v5, s[96:99], 0 offen offset:0 sc1
    buffer_store_dwordx4 v[172:175], v5, s[96:99], 0 offen offset:1024 sc1
    buffer_store_dwordx4 v[172:175], v5, s[96:99], 0 offen offset:2048 sc1
    v_mov_b32 v176, 0x3f803f80
    v_mov_b32 v177, 0x3f803f80
    v_mov_b32 v178, 0x3f803f80
    v_mov_b32 v179, 0x3f803f80
    v_lshlrev_b32 v40, 2, v3
    s_waitcnt vmcnt(12)
    s_barrier
    s_add_u32 m0, s30, 47104
    s_add_u32 s32, s32, 128
    s_cmp_eq_u32 s32, 1152
    s_cselect_b32 s32, 0, s32
    buffer_load_dwordx4 v160, s[8:11], s32 offen offset:0 lds
    buffer_load_dwordx4 v161, s[8:11], s32 offen offset:1024 lds
    buffer_load_dwordx4 v162, s[8:11], s32 offen offset:2048 lds
    buffer_load_dwordx4 v163, s[8:11], s32 offen offset:3072 lds
    s_add_u32 m0, s100, 63488
    s_mul_i32 s25, s32, 1728
    buffer_load_dwordx4 v168, s[16:19], s25 offen offset:0 lds
    buffer_load_dwordx4 v169, s[16:19], s25 offen offset:960 lds
    buffer_load_dwordx4 v170, s[16:19], s25 offen offset:1920 lds
    s_mov_b32 exec_hi, s101
    buffer_load_dwordx4 v171, s[16:19], s25 offen offset:2880 lds
    s_mov_b32 exec_hi, -1
    s_add_u32 m0, s30, 78848
    s_add_u32 s32, s32, 128
    s_cmp_eq_u32 s32, 1152
    s_cselect_b32 s32, 0, s32
    buffer_load_dwordx4 v160, s[8:11], s32 offen offset:0 lds
    buffer_load_dwordx4 v161, s[8:11], s32 offen offset:1024 lds
    buffer_load_dwordx4 v162, s[8:11], s32 offen offset:2048 lds
    buffer_load_dwordx4 v163, s[8:11], s32 offen offset:3072 lds
    s_add_u32 m0, s100, 95232
    s_mul_i32 s25, s32, 1728
    buffer_load_dwordx4 v168, s[16:19], s25 offen offset:0 lds
    buffer_load_dwordx4 v169, s[16:19], s25 offen offset:960 lds
    buffer_load_dwordx4 v170, s[16:19], s25 offen offset:1920 lds
    s_mov_b32 exec_hi, s101
    buffer_load_dwordx4 v171, s[16:19], s25 offen offset:2880 lds
    s_mov_b32 exec_hi, -1
    s_cmp_lg_u32 s35, 0
    s_cbranch_scc1 .L_mlp_zk0
    ds_read_b64_tr_b16 v[88:89], v34 offset:0
    ds_read_b64_tr_b16 v[90:91], v34 offset:240
    ds_read_b64_tr_b16 v[92:93], v35 offset:0
    ds_read_b64_tr_b16 v[94:95], v35 offset:240
    s_waitcnt lgkmcnt(0)
.L_mlp_zk0:
    s_waitcnt vmcnt(12)
    s_barrier
    s_add_u32 m0, s30, 110592
    s_add_u32 s32, s32, 128
    s_cmp_eq_u32 s32, 1152
    s_cselect_b32 s32, 0, s32
    buffer_load_dwordx4 v160, s[8:11], s32 offen offset:0 lds
    buffer_load_dwordx4 v161, s[8:11], s32 offen offset:1024 lds
    buffer_load_dwordx4 v162, s[8:11], s32 offen offset:2048 lds
    buffer_load_dwordx4 v163, s[8:11], s32 offen offset:3072 lds
    s_add_u32 m0, s100, 0
    s_mul_i32 s25, s32, 1728
    buffer_load_dwordx4 v168, s[16:19], s25 offen offset:0 lds
    buffer_load_dwordx4 v169, s[16:19], s25 offen offset:960 lds
    buffer_load_dwordx4 v170, s[16:19], s25 offen offset:1920 lds
    s_mov_b32 exec_hi, s101
    buffer_load_dwordx4 v171, s[16:19], s25 offen offset:2880 lds
    s_mov_b32 exec_hi, -1
    s_add_u32 m0, s30, 15360
    s_add_u32 s32, s32, 128
    s_cmp_eq_u32 s32, 1152
    s_cselect_b32 s32, 0, s32
    buffer_load_dwordx4 v160, s[8:11], s32 offen offset:0 lds
    buffer_load_dwordx4 v161, s[8:11], s32 offen offset:1024 lds
    buffer_load_dwordx4 v162, s[8:11], s32 offen offset:2048 lds
    buffer_load_dwordx4 v163, s[8:11], s32 offen offset:3072 lds
    s_cmp_lg_u32 s35, 1
    s_cbranch_scc1 .L_mlp_zk1
    ds_read_b64_tr_b16 v[88:89], v34 offset:0
    ds_read_b64_tr_b16 v[90:91], v34 offset:240
    ds_read_b64_tr_b16 v[92:93], v35 offset:0
    ds_read_b64_tr_b16 v[94:95], v35 offset:240
    s_waitcnt lgkmcnt(0)
.L_mlp_zk1:
    s_waitcnt vmcnt(16)
    s_barrier
    s_add_u32 m0, s100, 31744
    s_mul_i32 s25, s32, 1728
    buffer_load_dwordx4 v168, s[16:19], s25 offen offset:0 lds
    buffer_load_dwordx4 v169, s[16:19], s25 offen offset:960 lds
    buffer_load_dwordx4 v170, s[16:19], s25 offen offset:1920 lds
    s_mov_b32 exec_hi, s101
    buffer_load_dwordx4 v171, s[16:19], s25 offen offset:2880 lds
    s_mov_b32 exec_hi, -1
    s_add_u32 m0, s30, 47104
    s_add_u32 s32, s32, 128
    s_cmp_eq_u32 s32, 1152
    s_cselect_b32 s32, 0, s32
    buffer_load_dwordx4 v160, s[8:11], s32 offen offset:0 lds
    buffer_load_dwordx4 v161, s[8:11], s32 offen offset:1024 lds
    buffer_load_dwordx4 v162, s[8:11], s32 offen offset:2048 lds
    buffer_load_dwordx4 v163, s[8:11], s32 offen offset:3072 lds
    s_min_u32 s98, s98, 256
    s_mov_b32 s96, s52
    s_mov_b32 s97, s53
    v_mov_b32 v180, 1
    buffer_store_dword v180, v20, s[96:99], 0 offen offset:128 sc1
    s_lshr_b32 s3, s56, 1
    s_mul_i32 s40, s3, 57
    s_lshr_b32 s40, s40, 9
    s_lshl_b32 s3, s3, 2
    s_add_u32 s3, s3, s20
    s_lshl_b32 s24, s3, 1
    s_and_b32 s89, s56, 1
    s_add_u32 s24, s24, s89
    s_lshl_b32 s24, s24, 8
    s_mul_i32 s41, s40, 36
    s_sub_u32 s3, s3, s41
    s_lshr_b32 s3, s3, 1
    s_lshl_b32 s40, s40, 3
    s_sub_u32 s41, s3, 10
    s_cmp_lt_u32 s3, 10
    s_cselect_b32 s41, s3, s41
    s_and_b32 s22, s41, 1
    s_lshr_b32 s41, s41, 1
    s_lshl_b32 s15, s22, 2
    s_add_u32 s41, s41, s15
    s_mul_i32 s15, s22, 18
    s_sub_u32 s15, 54, s15
    s_sub_u32 s22, 3, s22
    s_cmp_lt_u32 s3, 10
    s_cselect_b32 s22, s22, 2
    s_cselect_b32 s15, 0, s15
    s_and_b32 s0, s20, 1
    s_add_u32 s15, s15, s0
    s_sub_u32 s3, s3, 8
    s_lshl_b32 s1, s3, 1
    s_add_u32 s1, s1, s0
    s_cmp_lt_u32 s3, 2
    s_cselect_b32 s41, s1, s41
    s_cselect_b32 s22, 3, s22
    s_cselect_b32 s15, 2, s15
    s_add_u32 s40, s40, s41
    s_mul_i32 s40, s40, 165888
    s_lshl_b32 s15, s15, 10
    s_add_u32 s15, s15, s40
    s_lshl_b32 s22, s22, 10
    v_lshrrev_b32 v6, 2, v3
    v_and_b32 v7, 2, v6
    v_xor_b32 v7, s20, v7
    v_and_b32 v8, 3, v3
    v_lshlrev_b32 v8, 3, v8
    v_lshl_add_u32 v8, v6, 7, v8
    v_lshl_add_u32 v153, v7, 5, v8
    v_xor_b32 v7, v7, v2
    v_lshl_add_u32 v8, v7, 5, v8
    v_lshl_add_u32 v8, v2, 10, v8
    v_add_u32 v152, 126976, v8
    v_mul_u32_u24 v6, 9216, v2
    v_add_u32 v153, v153, v6
    v_add_u32 v153, 135168, v153
    v_lshrrev_b32 v6, 1, v2
    v_mul_u32_u24 v6, s22, v6
    v_and_b32 v7, 1, v2
    v_lshl_add_u32 v6, v7, 9, v6
    s_lshl_b32 s89, s89, 8
    v_lshl_add_u32 v4, v3, 4, s89
    v_add_u32 v4, v4, v6
    s_mul_i32 s41, s20, 172032
    s_add_u32 s41, s41, 0xc70000
    s_sub_u32 s3, s56, 144
    s_cmp_lt_u32 s3, 18
    s_cselect_b32 s98, 172032, 0
    s_add_u32 s96, s12, s41
    s_addc_u32 s97, s13, 0
    s_mov_b32 s99, 0x20000
    s_lshl_b32 s34, s3, 12
    s_add_u32 s87, s34, 86016
    s_lshl_b32 s89, s3, 9
    s_add_u32 s89, s89, 73728
    s_add_u32 s86, s34, 2048
    s_add_u32 s88, s87, 2048
    v_lshrrev_b32 v6, 2, v3
    v_and_b32 v7, 1, v6
    v_lshrrev_b32 v8, 1, v6
    v_lshl_add_u32 v7, v8, 3, v7
    v_lshl_add_u32 v7, v2, 1, v7
    v_lshl_add_u32 v6, v2, 2, v6
    s_cmp_ge_u32 s56, 160
    s_cselect_b64 vcc, -1, 0
    v_cndmask_b32 v6, v6, v7, vcc
    v_and_b32 v7, 3, v3
    v_mul_u32_u24 v6, 1152, v6
    s_mul_i32 s40, s20, 288
    s_add_u32 s40, s40, 126976
    v_add_u32 v150, s40, v6
    v_lshl_add_u32 v150, v7, 4, v150
    v_lshrrev_b32 v8, 1, v7
    v_mul_u32_u24 v8, 144, v8
    v_and_b32 v7, 1, v7
    v_lshl_add_u32 v8, v7, 3, v8
    s_add_u32 s40, s40, 128
    v_add3_u32 v151, v8, v6, s40
    v_lshrrev_b32 v6, 3, v3
    v_mul_u32_u24 v6, 86016, v6
    v_and_b32 v7, 7, v3
    v_lshl_add_u32 v7, v2, 3, v7
    v_lshl_add_u32 v42, v7, 4, v6
    s_cmp_lg_u32 s35, 2
    s_cbranch_scc1 .L_mlp_zk2
    ds_read_b64_tr_b16 v[88:89], v34 offset:0
    ds_read_b64_tr_b16 v[90:91], v34 offset:240
    ds_read_b64_tr_b16 v[92:93], v35 offset:0
    ds_read_b64_tr_b16 v[94:95], v35 offset:240
    s_waitcnt lgkmcnt(0)
.L_mlp_zk2:
    s_waitcnt vmcnt(17)
    s_barrier
    s_add_u32 m0, s100, 63488
    s_mul_i32 s25, s32, 1728
    buffer_load_dwordx4 v168, s[16:19], s25 offen offset:0 lds
    buffer_load_dwordx4 v169, s[16:19], s25 offen offset:960 lds
    buffer_load_dwordx4 v170, s[16:19], s25 offen offset:1920 lds
    s_mov_b32 exec_hi, s101
    buffer_load_dwordx4 v171, s[16:19], s25 offen offset:2880 lds
    s_mov_b32 exec_hi, -1
    s_add_u32 m0, s30, 78848
    s_add_u32 s32, s32, 128
    s_cmp_eq_u32 s32, 1152
    s_cselect_b32 s32, 0, s32
    buffer_load_dwordx4 v160, s[8:11], s32 offen offset:0 lds
    buffer_load_dwordx4 v161, s[8:11], s32 offen offset:1024 lds
    buffer_load_dwordx4 v162, s[8:11], s32 offen offset:2048 lds
    buffer_load_dwordx4 v163, s[8:11], s32 offen offset:3072 lds
    s_add_u32 m0, s14, 0
    s_nop 0
    buffer_load_dwordx4 v144, s[44:47], 0 offen offset:0 lds
    s_mul_i32 s42, s43, 1
    buffer_load_dwordx4 v145, s[44:47], s42 offen offset:1024 lds
    s_mul_i32 s42, s43, 2
    buffer_load_dwordx4 v146, s[44:47], s42 offen offset:2048 lds
    s_mul_i32 s42, s43, 3
    buffer_load_dwordx4 v147, s[44:47], s42 offen offset:3072 lds
    s_add_u32 m0, s14, 4096
    s_mul_i32 s42, s43, 4
    buffer_load_dwordx4 v148, s[44:47], s42 offen offset:0 lds
    s_mul_i32 s42, s43, 5
    s_add_u32 s42, s42, s84
    buffer_load_dwordx4 v145, s[44:47], s42 offen offset:1024 lds
    s_mul_i32 s42, s43, 6
    s_add_u32 s42, s42, s84
    buffer_load_dwordx4 v146, s[44:47], s42 offen offset:2048 lds
    s_mul_i32 s42, s43, 7
    s_add_u32 s42, s42, s84
    buffer_load_dwordx4 v147, s[44:47], s42 offen offset:3072 lds
    s_add_u32 m0, s14, 8192
    s_mul_i32 s42, s43, 8
    s_add_u32 s42, s42, s85
    buffer_load_dwordx4 v144, s[44:47], s42 offen offset:0 lds
    s_cmp_lg_u32 s35, 3
    s_cbranch_scc1 .L_mlp_zk3
    ds_read_b64_tr_b16 v[88:89], v34 offset:0
    ds_read_b64_tr_b16 v[90:91], v34 offset:240
    ds_read_b64_tr_b16 v[92:93], v35 offset:0
    ds_read_b64_tr_b16 v[94:95], v35 offset:240
    s_waitcnt lgkmcnt(0)
.L_mlp_zk3:
    s_waitcnt vmcnt(26)
    s_barrier
    s_add_u32 m0, s100, 95232
    s_mul_i32 s25, s32, 1728
    buffer_load_dwordx4 v168, s[16:19], s25 offen offset:0 lds
    buffer_load_dwordx4 v169, s[16:19], s25 offen offset:960 lds
    buffer_load_dwordx4 v170, s[16:19], s25 offen offset:1920 lds
    s_mov_b32 exec_hi, s101
    buffer_load_dwordx4 v171, s[16:19], s25 offen offset:2880 lds
    s_mov_b32 exec_hi, -1
    s_add_u32 m0, s30, 110592
    s_add_u32 s32, s32, 128
    s_cmp_eq_u32 s32, 1152
    s_cselect_b32 s32, 0, s32
    buffer_load_dwordx4 v160, s[8:11], s32 offen offset:0 lds
    buffer_load_dwordx4 v161, s[8:11], s32 offen offset:1024 lds
    buffer_load_dwordx4 v162, s[8:11], s32 offen offset:2048 lds
    buffer_load_dwordx4 v163, s[8:11], s32 offen offset:3072 lds
    s_cmp_lg_u32 s35, 4
    s_cbranch_scc1 .L_mlp_zk4
    ds_read_b64_tr_b16 v[88:89], v34 offset:0
    ds_read_b64_tr_b16 v[90:91], v34 offset:240
    ds_read_b64_tr_b16 v[92:93], v35 offset:0
    ds_read_b64_tr_b16 v[94:95], v35 offset:240
    s_waitcnt lgkmcnt(0)
.L_mlp_zk4:
    s_waitcnt vmcnt(8)
    s_barrier
    s_add_u32 m0, s100, 0
    s_mul_i32 s25, s32, 1728
    buffer_load_dwordx4 v168, s[16:19], s25 offen offset:0 lds
    buffer_load_dwordx4 v169, s[16:19], s25 offen offset:960 lds
    buffer_load_dwordx4 v170, s[16:19], s25 offen offset:1920 lds
    s_mov_b32 exec_hi, s101
    buffer_load_dwordx4 v171, s[16:19], s25 offen offset:2880 lds
    s_mov_b32 exec_hi, -1
    buffer_load_dword v180, v181, s[52:55], 0 offen offset:128 sc1
    s_cmp_lg_u32 s35, 5
    s_cbranch_scc1 .L_mlp_zk5
    ds_read_b64_tr_b16 v[88:89], v34 offset:0
    ds_read_b64_tr_b16 v[90:91], v34 offset:240
    ds_read_b64_tr_b16 v[92:93], v35 offset:0
    ds_read_b64_tr_b16 v[94:95], v35 offset:240
    s_waitcnt lgkmcnt(0)
.L_mlp_zk5:
    s_cmp_lg_u32 s43, 0
    s_cbranch_scc1 .L_mlp_zeb5
    ds_read_b64_tr_b16 v[44:45], v150 offset:0
    ds_read_b64_tr_b16 v[46:47], v150 offset:18432
    ds_read_b64_tr_b16 v[48:49], v150 offset:8
    ds_read_b64_tr_b16 v[50:51], v150 offset:18440
    ds_read_b64_tr_b16 v[52:53], v150 offset:64
    ds_read_b64_tr_b16 v[54:55], v150 offset:18496
    ds_read_b64_tr_b16 v[56:57], v150 offset:72
    ds_read_b64_tr_b16 v[58:59], v150 offset:18504
    ds_read_b64_tr_b16 v[60:61], v150 offset:144
    ds_read_b64_tr_b16 v[62:63], v150 offset:18576
    ds_read_b64_tr_b16 v[64:65], v150 offset:152
    ds_read_b64_tr_b16 v[66:67], v150 offset:18584
    ds_read_b64_tr_b16 v[68:69], v150 offset:208
    ds_read_b64_tr_b16 v[70:71], v150 offset:18640
    ds_read_b64_tr_b16 v[72:73], v150 offset:216
    ds_read_b64_tr_b16 v[74:75], v150 offset:18648
    ds_read_b64_tr_b16 v[76:77], v151 offset:0
    ds_read_b64_tr_b16 v[78:79], v151 offset:18432
    s_waitcnt lgkmcnt(15)
    buffer_store_dwordx4 v[44:47], v5, s[96:99], s34 offen offset:0 sc1
    s_waitcnt lgkmcnt(14)
    buffer_store_dwordx4 v[48:51], v5, s[96:99], s34 offen offset:1024 sc1
    s_waitcnt lgkmcnt(12)
    buffer_store_dwordx4 v[52:55], v5, s[96:99], s86 offen offset:0 sc1
    s_waitcnt lgkmcnt(10)
    buffer_store_dwordx4 v[56:59], v5, s[96:99], s86 offen offset:1024 sc1
    s_waitcnt lgkmcnt(0)
    s_branch .L_mlp_zej5
.L_mlp_zeb5:
    s_add_u32 s96, s12, s15
    s_addc_u32 s97, s13, 0
    s_mov_b32 s98, 0x28800
    s_mov_b32 s99, 0x20000
    s_add_u32 s44, s12, 0xa20000
    s_addc_u32 s45, s13, 0
    s_add_u32 s44, s44, s24
    s_addc_u32 s45, s45, 0
    s_mov_b32 s46, 0x100
    s_mov_b32 s47, 0x20000
    s_and_b32 s86, s56, 1
    s_lshl_b32 s86, s86, 1
    s_mul_i32 s86, s86, s22
    ds_read_b64_tr_b16 v[44:45], v152 offset:0
    ds_read_b64_tr_b16 v[46:47], v152 offset:512
    ds_read_b64_tr_b16 v[48:49], v152 offset:4096
    ds_read_b64_tr_b16 v[50:51], v152 offset:4608
    ds_read_b64_tr_b16 v[52:53], v152 offset:9216
    ds_read_b64_tr_b16 v[54:55], v152 offset:9728
    ds_read_b64_tr_b16 v[56:57], v152 offset:13312
    ds_read_b64_tr_b16 v[58:59], v152 offset:13824
    ds_read_b64_tr_b16 v[60:61], v152 offset:18432
    ds_read_b64_tr_b16 v[62:63], v152 offset:18944
    ds_read_b64_tr_b16 v[64:65], v152 offset:22528
    ds_read_b64_tr_b16 v[66:67], v152 offset:23040
    ds_read_b64_tr_b16 v[68:69], v152 offset:27648
    ds_read_b64_tr_b16 v[70:71], v152 offset:28160
    ds_read_b64_tr_b16 v[72:73], v152 offset:31744
    ds_read_b64_tr_b16 v[74:75], v152 offset:32256
    ds_read_b64_tr_b16 v[76:77], v153 offset:0
    ds_read_b64_tr_b16 v[78:79], v153 offset:512
    s_waitcnt lgkmcnt(15)
    v_mfma_f32_16x16x32_bf16 v[84:87], v[176:179], v[44:47], 0
    s_waitcnt lgkmcnt(14)
    v_mfma_f32_16x16x32_bf16 v[84:87], v[176:179], v[48:51], v[84:87]
    s_waitcnt lgkmcnt(12)
    v_mfma_f32_16x16x32_bf16 v[84:87], v[176:179], v[52:55], v[84:87]
    s_waitcnt lgkmcnt(10)
    v_mfma_f32_16x16x32_bf16 v[84:87], v[176:179], v[56:59], v[84:87]
    s_waitcnt lgkmcnt(8)
    v_mfma_f32_16x16x32_bf16 v[84:87], v[176:179], v[60:63], v[84:87]
    s_waitcnt lgkmcnt(6)
    v_mfma_f32_16x16x32_bf16 v[84:87], v[176:179], v[64:67], v[84:87]
    s_waitcnt lgkmcnt(4)
    v_mfma_f32_16x16x32_bf16 v[84:87], v[176:179], v[68:71], v[84:87]
    s_waitcnt lgkmcnt(2)
    v_mfma_f32_16x16x32_bf16 v[84:87], v[176:179], v[72:75], v[84:87]
    s_waitcnt lgkmcnt(0)
    v_mfma_f32_16x16x32_bf16 v[84:87], v[176:179], v[76:79], v[84:87]
    s_nop 7
    v_cvt_pk_bf16_f32 v100, v84, v84
    v_and_b32 v85, 0xffff0000, v100
    v_sub_f32 v85, v84, v85
    v_cvt_pk_bf16_f32 v101, v85, v85
    v_lshl_or_b32 v102, v43, 16, v43
    v_mov_b32 v103, v43
    s_mul_i32 s34, s22, 0
    s_add_u32 s34, s34, s86
    buffer_store_dwordx4 v[44:47], v5, s[96:99], s34 offen sc1
    s_mul_i32 s34, s22, 1
    s_add_u32 s34, s34, s86
    buffer_store_dwordx4 v[48:51], v5, s[96:99], s34 offen sc1
    s_mul_i32 s34, s22, 4
    s_add_u32 s34, s34, s86
    buffer_store_dwordx4 v[52:55], v5, s[96:99], s34 offen sc1
    s_mul_i32 s34, s22, 5
    s_add_u32 s34, s34, s86
    buffer_store_dwordx4 v[56:59], v5, s[96:99], s34 offen sc1
    s_waitcnt lgkmcnt(0)
.L_mlp_zej5:
    s_barrier
    s_cmp_lg_u32 s35, 6
    s_cbranch_scc1 .L_mlp_zk6
    ds_read_b64_tr_b16 v[88:89], v34 offset:0
    ds_read_b64_tr_b16 v[90:91], v34 offset:240
    ds_read_b64_tr_b16 v[92:93], v35 offset:0
    ds_read_b64_tr_b16 v[94:95], v35 offset:240
    s_waitcnt lgkmcnt(0)
.L_mlp_zk6:
    s_cmp_lg_u32 s43, 0
    s_cbranch_scc1 .L_mlp_zeb6
    buffer_store_dwordx4 v[60:63], v5, s[96:99], s87 offen offset:0 sc1
    buffer_store_dwordx4 v[64:67], v5, s[96:99], s87 offen offset:1024 sc1
    buffer_store_dwordx4 v[68:71], v5, s[96:99], s88 offen offset:0 sc1
    s_branch .L_mlp_zej6
.L_mlp_zeb6:
    s_nop 0
    s_mul_i32 s34, s22, 8
    s_add_u32 s34, s34, s86
    buffer_store_dwordx4 v[60:63], v5, s[96:99], s34 offen sc1
    s_mul_i32 s34, s22, 9
    s_add_u32 s34, s34, s86
    buffer_store_dwordx4 v[64:67], v5, s[96:99], s34 offen sc1
    s_mul_i32 s34, s22, 12
    s_add_u32 s34, s34, s86
    buffer_store_dwordx4 v[68:71], v5, s[96:99], s34 offen sc1
.L_mlp_zej6:
    s_waitcnt vmcnt(12)
    s_barrier
    s_cmp_lg_u32 s35, 7
    s_cbranch_scc1 .L_mlp_zk7
    ds_read_b64_tr_b16 v[88:89], v34 offset:0
    ds_read_b64_tr_b16 v[90:91], v34 offset:240
    ds_read_b64_tr_b16 v[92:93], v35 offset:0
    ds_read_b64_tr_b16 v[94:95], v35 offset:240
    s_waitcnt lgkmcnt(0)
.L_mlp_zk7:
    s_cmp_lg_u32 s43, 0
    s_cbranch_scc1 .L_mlp_zeb7
    buffer_store_dwordx4 v[72:75], v5, s[96:99], s88 offen offset:1024 sc1
    buffer_store_dwordx4 v[76:79], v42, s[96:99], s89 offen offset:0 sc1
    buffer_store_dword v21, v21, s[96:99], 0 offen sc1
    s_branch .L_mlp_zej7
.L_mlp_zeb7:
    s_nop 0
    s_mul_i32 s34, s22, 13
    s_add_u32 s34, s34, s86
    buffer_store_dwordx4 v[72:75], v5, s[96:99], s34 offen sc1
    s_mul_i32 s34, s22, 16
    buffer_store_dwordx4 v[76:79], v4, s[96:99], s34 offen sc1
    buffer_store_dwordx4 v[100:103], v5, s[44:47], 0 offen sc1
.L_mlp_zej7:
    s_waitcnt vmcnt(11)
    s_sub_u32 s57, s56, 144
    s_cmp_lt_u32 s57, 18
    s_cbranch_scc0 .L_mlp_zq
    s_waitcnt vmcnt(0)
.L_mlp_zq:
    s_barrier
    s_cmp_lg_u32 s35, 8
    s_cbranch_scc1 .L_mlp_zk8
    ds_read_b64_tr_b16 v[88:89], v34 offset:0
    ds_read_b64_tr_b16 v[90:91], v34 offset:240
    ds_read_b64_tr_b16 v[92:93], v35 offset:0
    ds_read_b64_tr_b16 v[94:95], v35 offset:240
    s_waitcnt lgkmcnt(0)
.L_mlp_zk8:
    s_setprio 0
    s_waitcnt vmcnt(10)
    v_cmp_ne_u32 vcc, 0, v180
    s_mov_b32 s41, 0x40000
    s_cmp_eq_u32 vcc_lo, -1
    s_cbranch_scc1 .L_mlp_zok
.L_mlp_zw:
    s_sleep 8
    buffer_load_dword v180, v181, s[52:55], 0 offen offset:128 sc1
    s_waitcnt vmcnt(0)
    v_cmp_ne_u32 vcc, 0, v180
    s_sub_u32 s41, s41, 1
    s_cbranch_scc1 .L_mlp_zok
    s_cmp_lg_u32 vcc_lo, -1
    s_cbranch_scc1 .L_mlp_zw
.L_mlp_zok:
    s_lshl_b32 s40, s20, 8
    s_add_u32 s57, s57, s40
    s_cmp_lt_u32 s57, 18
    s_cbranch_scc0 .L_mlp_zr
    s_add_u32 s44, s12, 0x2728000
    s_addc_u32 s45, s13, 0
    s_mov_b32 s46, 0x8000
    s_mov_b32 s47, 0x20000
    v_lshlrev_b32 v6, 7, v1
    v_mov_b32 v7, 1
    buffer_atomic_add v7, v6, s[44:47], 0 offen offset:4 sc1
    s_mov_b32 s40, 8192
    buffer_atomic_add v7, v6, s[44:47], s40 offen offset:4 sc1
    s_mov_b32 s40, 16384
    buffer_atomic_add v7, v6, s[44:47], s40 offen offset:4 sc1
    s_mov_b32 s40, 24576
    buffer_atomic_add v7, v6, s[44:47], s40 offen offset:4 sc1
.L_mlp_zr:
    s_cmp_eq_u32 s23, 63
    s_cbranch_scc1 .L_mlp_zm
    buffer_store_dwordx4 v[88:91], v36, s[36:39], 0 offen sc1
    buffer_store_dwordx4 v[92:95], v37, s[36:39], 0 offen sc1
.L_mlp_zm:
    s_barrier
    s_cmp_lg_u32 s23, 63
    s_cbranch_scc1 .L_mlp_zn
    ds_read_b32 v48, v40 offset:64512
    ds_read_b32 v56, v40 offset:64576
    ds_read_b32 v64, v40 offset:64640
    ds_read_b32 v72, v40 offset:64704
    ds_read_b32 v80, v40 offset:64768
    ds_read_b32 v88, v40 offset:64832
    ds_read_b32 v96, v40 offset:64896
    v_cmp_eq_u32 vcc, 0, v2
    s_waitcnt lgkmcnt(6)
    s_nop 0
    v_cndmask_b32 v48, 0, v48, vcc
    v_cvt_pk_bf16_f32 v44, v48, v48
    v_and_b32 v49, 0xffff0000, v44
    v_sub_f32 v49, v48, v49
    v_cvt_pk_bf16_f32 v45, v49, v49
    v_mov_b32 v46, 0
    v_mov_b32 v47, 0
    s_mov_b32 s40, 129024
    buffer_store_dwordx4 v[44:47], v5, s[36:39], s40 offen offset:0 sc1
    s_waitcnt lgkmcnt(5)
    v_cndmask_b32 v56, 0, v56, vcc
    v_cvt_pk_bf16_f32 v52, v56, v56
    v_and_b32 v57, 0xffff0000, v52
    v_sub_f32 v57, v56, v57
    v_cvt_pk_bf16_f32 v53, v57, v57
    v_mov_b32 v54, 0
    v_mov_b32 v55, 0
    buffer_store_dwordx4 v[52:55], v5, s[36:39], s40 offen offset:1024 sc1
    s_waitcnt lgkmcnt(4)
    v_cndmask_b32 v64, 0, v64, vcc
    v_cvt_pk_bf16_f32 v60, v64, v64
    v_and_b32 v65, 0xffff0000, v60
    v_sub_f32 v65, v64, v65
    v_cvt_pk_bf16_f32 v61, v65, v65
    v_mov_b32 v62, 0
    v_mov_b32 v63, 0
    buffer_store_dwordx4 v[60:63], v5, s[36:39], s40 offen offset:2048 sc1
    s_waitcnt lgkmcnt(3)
    v_cndmask_b32 v72, 0, v72, vcc
    v_cvt_pk_bf16_f32 v68, v72, v72
    v_and_b32 v73, 0xffff0000, v68
    v_sub_f32 v73, v72, v73
    v_cvt_pk_bf16_f32 v69, v73, v73
    v_mov_b32 v70, 0
    v_mov_b32 v71, 0
    buffer_store_dwordx4 v[68:71], v5, s[36:39], s40 offen offset:3072 sc1
    s_waitcnt lgkmcnt(2)
    v_cndmask_b32 v80, 0, v80, vcc
    v_cvt_pk_bf16_f32 v76, v80, v80
    v_and_b32 v81, 0xffff0000, v76
    v_sub_f32 v81, v80, v81
    v_cvt_pk_bf16_f32 v77, v81, v81
    v_mov_b32 v78, 0
    v_mov_b32 v79, 0
    s_mov_b32 s40, 133120
    buffer_store_dwordx4 v[76:79], v5, s[36:39], s40 offen offset:0 sc1
    s_waitcnt lgkmcnt(1)
    v_cndmask_b32 v88, 0, v88, vcc
    v_cvt_pk_bf16_f32 v84, v88, v88
    v_and_b32 v89, 0xffff0000, v84
    v_sub_f32 v89, v88, v89
    v_cvt_pk_bf16_f32 v85, v89, v89
    v_mov_b32 v86, 0
    v_mov_b32 v87, 0
    buffer_store_dwordx4 v[84:87], v5, s[36:39], s40 offen offset:1024 sc1
    s_waitcnt lgkmcnt(0)
    v_cndmask_b32 v96, 0, v96, vcc
    v_cvt_pk_bf16_f32 v92, v96, v96
    v_and_b32 v97, 0xffff0000, v92
    v_sub_f32 v97, v96, v97
    v_cvt_pk_bf16_f32 v93, v97, v97
    v_mov_b32 v94, 0
    v_mov_b32 v95, 0
    buffer_store_dwordx4 v[92:95], v5, s[36:39], s40 offen offset:2048 sc1
.L_mlp_zn:
    s_mov_b32 s3, 0
    s_branch .L_mlp_l0
.L_mlp_zp:
    s_lshr_b32 s40, s2, 3
    s_cmp_ge_u32 s40, 4
    s_cbranch_scc1 .L_mlp_cpx
    s_getpc_b64 s[40:41]
.L_mlp_cpa:
    s_lshr_b32 s42, s2, 3
    s_lshl_b32 s42, s42, 2
    s_add_u32 s42, s42, s20
    s_and_b32 s42, s42, 15
    s_lshl_b32 s42, s42, 12
    v_lshl_add_u32 v34, v1, 6, s42
    v_min_u32 v34, .L_mlp_fin - .L_mlp_cpa - 4, v34
    v_mov_b32 v35, s41
    v_add_co_u32 v34, vcc, s40, v34
    v_addc_co_u32 v35, vcc, 0, v35, vcc
    global_load_dword v36, v[34:35], off
.L_mlp_cpx:
    v_mov_b32 v168, 0x3f803f80
    v_mov_b32 v169, 0x3f803f80
    v_mov_b32 v170, 0x3f803f80
    v_mov_b32 v171, 0x3f803f80
    v_lshrrev_b32 v6, 1, v3
    v_xor_b32 v6, v6, v2
    v_lshlrev_b32 v6, 4, v6
    v_lshl_add_u32 v6, v3, 7, v6
    s_add_u32 s40, s30, 15360
    v_add_u32 v28, s40, v6
    v_xor_b32 v29, 64, v28
    v_add_u32 v30, 63488, v28
    v_add_u32 v31, 63488, v29
    v_lshrrev_b32 v6, 2, v3
    v_and_b32 v7, 3, v3
    v_lshl_add_u32 v6, v2, 2, v6
    v_mul_u32_u24 v11, 480, v6
    v_lshl_add_u32 v10, v7, 3, v11
    v_lshlrev_b32 v7, 3, v7
    v_mov_b32 v6, 0x28c078c0
    v_lshrrev_b32 v6, v7, v6
    v_and_b32 v6, 0xff, v6
    v_add_u32 v11, v11, v6
    v_add_u32 v32, 63488, v10
    v_add_u32 v33, 63488, v11
    s_lshl_b32 s40, s20, 8
    s_add_u32 s40, s40, 63488
    v_lshl_add_u32 v12, v3, 2, s40
    v_lshl_add_u32 v9, v2, 4, s40
    v_lshlrev_b32 v6, 2, v2
    v_sub_u32 v6, v3, v6
    v_lshlrev_b32 v40, 2, v3
    v_lshlrev_b32 v41, 4, v2
    s_and_b32 s40, s20, 1
    s_lshl_b32 s40, s40, 8
    v_add_u32 v39, s40, v40
    v_cmp_eq_u32 s[60:61], 0, v6
    v_cmp_eq_u32 s[62:63], 1, v6
    v_cmp_eq_u32 s[80:81], 2, v6
    v_cmp_eq_u32 s[82:83], 3, v6
    s_waitcnt lgkmcnt(0)
    s_and_b32 s40, s20, 1
    s_lshl_b32 s41, s21, 1
    s_add_u32 s41, s41, s40
    s_mul_i32 s41, s41, 1408
    s_add_u32 s48, s12, 0x14e0000
    s_addc_u32 s49, s13, 0
    s_add_u32 s48, s48, s41
    s_addc_u32 s49, s49, 0
    s_mov_b32 s50, 0x580
    s_mov_b32 s51, 0x20000
    s_cmp_lt_u32 s20, 2
    s_cselect_b64 s[56:57], -1, 0
    s_cmp_eq_u32 s40, 1
    s_cselect_b64 s[58:59], -1, 0
    v_mov_b32 v8, 0x80000000
    v_lshlrev_b32 v6, 2, v1
    v_cndmask_b32 v13, v8, v6, s[56:57]
    v_add_u32 v7, 1152, v6
    v_cmp_gt_u32 vcc, 48, v1
    s_nop 1
    v_cndmask_b32 v15, v8, v7, vcc
    v_add_u32 v7, 768, v6
    v_cndmask_b32 v15, v15, v7, s[56:57]
    v_lshlrev_b32 v6, 3, v3
    v_lshl_add_u32 v6, v2, 2, v6
    v_add_u32 v6, 1024, v6
    v_cmp_gt_u32 vcc, 2, v2
    s_nop 1
    v_cndmask_b32 v6, v8, v6, vcc
    v_and_b32 v7, 1, v3
    v_lshlrev_b32 v7, 2, v7
    v_lshl_add_u32 v7, v2, 3, v7
    v_add_u32 v7, 1344, v7
    v_cmp_gt_u32 vcc, 3, v2
    s_nop 1
    v_cndmask_b32 v7, v8, v7, vcc
    s_add_u32 s41, s40, 2
    v_lshrrev_b32 v16, 1, v3
    v_cmp_eq_u32 vcc, s41, v16
    s_nop 1
    v_cndmask_b32 v7, v8, v7, vcc
    v_cndmask_b32 v16, v7, v6, s[56:57]
    s_mul_i32 s41, s20, 5120
    v_add_u32 v17, s41, v5
    s_lshl_b32 s41, s20, 11
    s_add_u32 s41, s41, 1024
    s_cmp_lt_u32 s20, 2
    s_cselect_b32 s41, s41, 4096
    v_add_u32 v18, s41, v5
    s_lshl_b32 s41, s40, 11
    v_add_u32 v19, s41, v5
    v_and_b32 v6, 1, v3
    v_lshlrev_b32 v6, 4, v6
    v_mov_b32 v7, 0x3f80
    v_lshlrev_b32 v6, v6, v7
    v_lshrrev_b32 v7, 2, v3
    v_mov_b32 v22, 0
    v_mov_b32 v23, 0
    v_mov_b32 v26, 0
    v_mov_b32 v27, 0
    v_cmp_eq_u32 s[26:27], 0, v7
    v_cmp_eq_u32 s[28:29], 2, v7
    v_cmp_eq_u32 vcc, v7, v2
    s_nop 1
    v_cndmask_b32 v6, v22, v6, vcc
    v_and_b32 v7, 2, v3
    v_cmp_eq_u32 vcc, 0, v7
    s_nop 1
    v_cndmask_b32 v24, v22, v6, vcc
    v_cndmask_b32 v25, v6, v22, vcc
    s_lshl_b32 s41, s24, 3
    s_add_u32 s41, s41, s21
    s_xor_b32 s41, s41, 1
    s_mul_i32 s41, s41, 3072
    s_add_u32 s4, s12, 0x11e0000
    s_addc_u32 s5, s13, 0
    s_add_u32 s4, s4, s41
    s_addc_u32 s5, s5, 0
    s_mov_b32 s6, 0xc00
    s_mov_b32 s7, 0x20000
    s_mov_b32 s31, 0x358637bd
    s_lshr_b32 s18, s21, 1
    s_lshl_b32 s18, s18, 7
    s_barrier
    ds_read_b128 a[0:3], v30 offset:31744
    ds_read_b128 a[4:7], v30 offset:33792
    ds_read_b64_tr_b16 v[116:117], v11 offset:0
    ds_read_b64_tr_b16 v[118:119], v11 offset:240
    ds_read_b64_tr_b16 v[100:101], v10 offset:80
    ds_read_b64_tr_b16 v[102:103], v10 offset:320
    ds_read_b64_tr_b16 v[108:109], v10 offset:128
    ds_read_b64_tr_b16 v[110:111], v10 offset:368
    ds_read_b64_tr_b16 v[104:105], v10 offset:160
    ds_read_b64_tr_b16 v[106:107], v10 offset:400
    ds_read_b64_tr_b16 v[112:113], v10 offset:208
    ds_read_b64_tr_b16 v[114:115], v10 offset:448
    ds_read_b64_tr_b16 v[120:121], v10 offset:0
    ds_read_b64_tr_b16 v[122:123], v10 offset:240
    ds_read_b64_tr_b16 v[124:125], v10 offset:48
    ds_read_b64_tr_b16 v[126:127], v10 offset:288
    ds_read_b128 a[8:11], v31 offset:31744
    ds_read_b128 a[12:15], v31 offset:33792
    ds_read_b128 a[16:19], v28 offset:0
    ds_read_b128 a[20:23], v28 offset:2048
    s_waitcnt lgkmcnt(15)
    v_mfma_f32_16x16x32_bf16 a[48:51], v[168:171], a[0:3], 0
    v_mfma_f32_16x16x32_bf16 a[56:59], a[0:3], a[0:3], 0
    v_mfma_f32_16x16x32_bf16 a[52:55], v[168:171], a[4:7], 0
    v_mfma_f32_16x16x32_bf16 a[60:63], a[4:7], a[4:7], 0
    s_waitcnt lgkmcnt(3)
    v_mfma_f32_16x16x32_bf16 a[48:51], v[168:171], a[8:11], a[48:51]
    v_mfma_f32_16x16x32_bf16 a[56:59], a[8:11], a[8:11], a[56:59]
    s_waitcnt lgkmcnt(2)
    v_mfma_f32_16x16x32_bf16 a[52:55], v[168:171], a[12:15], a[52:55]
    v_mfma_f32_16x16x32_bf16 a[60:63], a[12:15], a[12:15], a[60:63]
    s_waitcnt lgkmcnt(0)
    s_bitcmp1_b32 s20, 1
    s_cbranch_scc1 .L_mlp_zc0
    s_bitcmp1_b32 s20, 0
    s_cbranch_scc1 .L_mlp_zb0
    v_mfma_f32_16x16x32_bf16 a[32:35], v[168:171], v[100:103], 0
    v_mfma_f32_16x16x32_bf16 a[36:39], v[168:171], v[104:107], 0
    v_mfma_f32_16x16x32_bf16 a[40:43], v[168:171], v[108:111], 0
    v_mfma_f32_16x16x32_bf16 a[44:47], v[168:171], v[112:115], 0
    s_branch .L_mlp_zc0
.L_mlp_zb0:
    s_nop 1
    v_mfma_f32_16x16x32_bf16 a[32:35], v[168:171], v[116:119], 0
    v_mfma_f32_16x16x32_bf16 a[36:39], v[168:171], v[120:123], 0
    v_mfma_f32_16x16x32_bf16 a[40:43], v[168:171], v[124:127], 0
.L_mlp_zc0:
    v_mfma_f32_16x16x32_bf16 a[48:51], v[168:171], a[16:19], a[48:51]
    ds_read_b64_tr_b16 v[144:145], v11 offset:7680
    ds_read_b64_tr_b16 v[146:147], v11 offset:7920
    v_mfma_f32_16x16x32_bf16 a[56:59], a[16:19], a[16:19], a[56:59]
    ds_read_b64_tr_b16 v[128:129], v10 offset:7760
    ds_read_b64_tr_b16 v[130:131], v10 offset:8000
    v_mfma_f32_16x16x32_bf16 a[52:55], v[168:171], a[20:23], a[52:55]
    ds_read_b64_tr_b16 v[136:137], v10 offset:7808
    ds_read_b64_tr_b16 v[138:139], v10 offset:8048
    v_mfma_f32_16x16x32_bf16 a[60:63], a[20:23], a[20:23], a[60:63]
    ds_read_b64_tr_b16 v[132:133], v10 offset:7840
    v_mfma_f32_16x16x32_bf16 v[76:79], a[0:3], v[116:119], 0
    ds_read_b64_tr_b16 v[134:135], v10 offset:8080
    v_mfma_f32_16x16x32_bf16 v[80:83], a[4:7], v[116:119], 0
    ds_read_b64_tr_b16 v[140:141], v10 offset:7888
    v_mfma_f32_16x16x32_bf16 v[44:47], a[0:3], v[100:103], 0
    ds_read_b64_tr_b16 v[142:143], v10 offset:8128
    v_mfma_f32_16x16x32_bf16 v[48:51], a[4:7], v[100:103], 0
    ds_read_b64_tr_b16 v[148:149], v10 offset:7680
    v_mfma_f32_16x16x32_bf16 v[60:63], a[0:3], v[108:111], 0
    ds_read_b64_tr_b16 v[150:151], v10 offset:7920
    v_mfma_f32_16x16x32_bf16 v[64:67], a[4:7], v[108:111], 0
    ds_read_b64_tr_b16 v[152:153], v10 offset:7728
    v_mfma_f32_16x16x32_bf16 v[52:55], a[0:3], v[104:107], 0
    ds_read_b64_tr_b16 v[154:155], v10 offset:7968
    v_mfma_f32_16x16x32_bf16 v[56:59], a[4:7], v[104:107], 0
    ds_read_b128 a[24:27], v29 offset:0
    v_mfma_f32_16x16x32_bf16 v[68:71], a[0:3], v[112:115], 0
    ds_read_b128 a[28:31], v29 offset:2048
    v_mfma_f32_16x16x32_bf16 v[72:75], a[4:7], v[112:115], 0
    v_mfma_f32_16x16x32_bf16 v[84:87], v[120:123], a[0:3], 0
    v_mfma_f32_16x16x32_bf16 v[88:91], v[120:123], a[4:7], 0
    v_mfma_f32_16x16x32_bf16 v[92:95], v[124:127], a[0:3], 0
    v_mfma_f32_16x16x32_bf16 v[96:99], v[124:127], a[4:7], 0
    s_waitcnt lgkmcnt(0)
    s_barrier
    s_bitcmp0_b32 s20, 1
    s_cbranch_scc1 .L_mlp_zc1
    s_bitcmp1_b32 s20, 0
    s_cbranch_scc1 .L_mlp_zb1
    v_mfma_f32_16x16x32_bf16 a[32:35], v[168:171], v[128:131], 0
    v_mfma_f32_16x16x32_bf16 a[36:39], v[168:171], v[132:135], 0
    v_mfma_f32_16x16x32_bf16 a[40:43], v[168:171], v[136:139], 0
    v_mfma_f32_16x16x32_bf16 a[44:47], v[168:171], v[140:143], 0
    s_branch .L_mlp_zc1
.L_mlp_zb1:
    s_nop 1
    v_mfma_f32_16x16x32_bf16 a[32:35], v[168:171], v[144:147], 0
    v_mfma_f32_16x16x32_bf16 a[36:39], v[168:171], v[148:151], 0
    v_mfma_f32_16x16x32_bf16 a[40:43], v[168:171], v[152:155], 0
.L_mlp_zc1:
    v_mfma_f32_16x16x32_bf16 a[48:51], v[168:171], a[24:27], a[48:51]
    ds_read_b64_tr_b16 v[116:117], v11 offset:31744
    ds_read_b64_tr_b16 v[118:119], v11 offset:31984
    v_mfma_f32_16x16x32_bf16 a[56:59], a[24:27], a[24:27], a[56:59]
    ds_read_b64_tr_b16 v[100:101], v10 offset:31824
    ds_read_b64_tr_b16 v[102:103], v10 offset:32064
    v_mfma_f32_16x16x32_bf16 a[52:55], v[168:171], a[28:31], a[52:55]
    ds_read_b64_tr_b16 v[108:109], v10 offset:31872
    ds_read_b64_tr_b16 v[110:111], v10 offset:32112
    v_mfma_f32_16x16x32_bf16 a[60:63], a[28:31], a[28:31], a[60:63]
    ds_read_b64_tr_b16 v[104:105], v10 offset:31904
    v_mfma_f32_16x16x32_bf16 v[76:79], a[8:11], v[144:147], v[76:79]
    ds_read_b64_tr_b16 v[106:107], v10 offset:32144
    v_mfma_f32_16x16x32_bf16 v[80:83], a[12:15], v[144:147], v[80:83]
    ds_read_b64_tr_b16 v[112:113], v10 offset:31952
    v_mfma_f32_16x16x32_bf16 v[44:47], a[8:11], v[128:131], v[44:47]
    ds_read_b64_tr_b16 v[114:115], v10 offset:32192
    v_mfma_f32_16x16x32_bf16 v[48:51], a[12:15], v[128:131], v[48:51]
    ds_read_b64_tr_b16 v[120:121], v10 offset:31744
    v_mfma_f32_16x16x32_bf16 v[60:63], a[8:11], v[136:139], v[60:63]
    ds_read_b64_tr_b16 v[122:123], v10 offset:31984
    v_mfma_f32_16x16x32_bf16 v[64:67], a[12:15], v[136:139], v[64:67]
    ds_read_b64_tr_b16 v[124:125], v10 offset:31792
    v_mfma_f32_16x16x32_bf16 v[52:55], a[8:11], v[132:135], v[52:55]
    ds_read_b64_tr_b16 v[126:127], v10 offset:32032
    v_mfma_f32_16x16x32_bf16 v[56:59], a[12:15], v[132:135], v[56:59]
    ds_read_b128 a[0:3], v28 offset:31744
    v_mfma_f32_16x16x32_bf16 v[68:71], a[8:11], v[140:143], v[68:71]
    ds_read_b128 a[4:7], v28 offset:33792
    v_mfma_f32_16x16x32_bf16 v[72:75], a[12:15], v[140:143], v[72:75]
    v_mfma_f32_16x16x32_bf16 v[84:87], v[148:151], a[8:11], v[84:87]
    v_mfma_f32_16x16x32_bf16 v[88:91], v[148:151], a[12:15], v[88:91]
    v_mfma_f32_16x16x32_bf16 v[92:95], v[152:155], a[8:11], v[92:95]
    v_mfma_f32_16x16x32_bf16 v[96:99], v[152:155], a[12:15], v[96:99]
    s_waitcnt lgkmcnt(0)
    s_bitcmp1_b32 s20, 1
    s_cbranch_scc1 .L_mlp_zc2
    s_bitcmp1_b32 s20, 0
    s_cbranch_scc1 .L_mlp_zb2
    v_mfma_f32_16x16x32_bf16 a[32:35], v[168:171], v[100:103], a[32:35]
    v_mfma_f32_16x16x32_bf16 a[36:39], v[168:171], v[104:107], a[36:39]
    v_mfma_f32_16x16x32_bf16 a[40:43], v[168:171], v[108:111], a[40:43]
    v_mfma_f32_16x16x32_bf16 a[44:47], v[168:171], v[112:115], a[44:47]
    s_branch .L_mlp_zc2
.L_mlp_zb2:
    v_mfma_f32_16x16x32_bf16 a[32:35], v[168:171], v[116:119], a[32:35]
    v_mfma_f32_16x16x32_bf16 a[36:39], v[168:171], v[120:123], a[36:39]
    v_mfma_f32_16x16x32_bf16 a[40:43], v[168:171], v[124:127], a[40:43]
.L_mlp_zc2:
    v_mfma_f32_16x16x32_bf16 a[48:51], v[168:171], a[0:3], a[48:51]
    ds_read_b64_tr_b16 v[144:145], v11 offset:39424
    ds_read_b64_tr_b16 v[146:147], v11 offset:39664
    v_mfma_f32_16x16x32_bf16 a[56:59], a[0:3], a[0:3], a[56:59]
    ds_read_b64_tr_b16 v[128:129], v10 offset:39504
    ds_read_b64_tr_b16 v[130:131], v10 offset:39744
    v_mfma_f32_16x16x32_bf16 a[52:55], v[168:171], a[4:7], a[52:55]
    ds_read_b64_tr_b16 v[136:137], v10 offset:39552
    ds_read_b64_tr_b16 v[138:139], v10 offset:39792
    v_mfma_f32_16x16x32_bf16 a[60:63], a[4:7], a[4:7], a[60:63]
    ds_read_b64_tr_b16 v[132:133], v10 offset:39584
    v_mfma_f32_16x16x32_bf16 v[76:79], a[16:19], v[116:119], v[76:79]
    ds_read_b64_tr_b16 v[134:135], v10 offset:39824
    v_mfma_f32_16x16x32_bf16 v[80:83], a[20:23], v[116:119], v[80:83]
    ds_read_b64_tr_b16 v[140:141], v10 offset:39632
    v_mfma_f32_16x16x32_bf16 v[44:47], a[16:19], v[100:103], v[44:47]
    ds_read_b64_tr_b16 v[142:143], v10 offset:39872
    v_mfma_f32_16x16x32_bf16 v[48:51], a[20:23], v[100:103], v[48:51]
    ds_read_b64_tr_b16 v[148:149], v10 offset:39424
    v_mfma_f32_16x16x32_bf16 v[60:63], a[16:19], v[108:111], v[60:63]
    ds_read_b64_tr_b16 v[150:151], v10 offset:39664
    v_mfma_f32_16x16x32_bf16 v[64:67], a[20:23], v[108:111], v[64:67]
    ds_read_b64_tr_b16 v[152:153], v10 offset:39472
    v_mfma_f32_16x16x32_bf16 v[52:55], a[16:19], v[104:107], v[52:55]
    ds_read_b64_tr_b16 v[154:155], v10 offset:39712
    v_mfma_f32_16x16x32_bf16 v[56:59], a[20:23], v[104:107], v[56:59]
    ds_read_b128 a[8:11], v29 offset:31744
    v_mfma_f32_16x16x32_bf16 v[68:71], a[16:19], v[112:115], v[68:71]
    ds_read_b128 a[12:15], v29 offset:33792
    v_mfma_f32_16x16x32_bf16 v[72:75], a[20:23], v[112:115], v[72:75]
    v_mfma_f32_16x16x32_bf16 v[84:87], v[120:123], a[16:19], v[84:87]
    v_mfma_f32_16x16x32_bf16 v[88:91], v[120:123], a[20:23], v[88:91]
    v_mfma_f32_16x16x32_bf16 v[92:95], v[124:127], a[16:19], v[92:95]
    v_mfma_f32_16x16x32_bf16 v[96:99], v[124:127], a[20:23], v[96:99]
    s_waitcnt lgkmcnt(0)
    s_barrier
    s_bitcmp0_b32 s20, 1
    s_cbranch_scc1 .L_mlp_zc3
    s_bitcmp1_b32 s20, 0
    s_cbranch_scc1 .L_mlp_zb3
    v_mfma_f32_16x16x32_bf16 a[32:35], v[168:171], v[128:131], a[32:35]
    v_mfma_f32_16x16x32_bf16 a[36:39], v[168:171], v[132:135], a[36:39]
    v_mfma_f32_16x16x32_bf16 a[40:43], v[168:171], v[136:139], a[40:43]
    v_mfma_f32_16x16x32_bf16 a[44:47], v[168:171], v[140:143], a[44:47]
    s_branch .L_mlp_zc3
.L_mlp_zb3:
    v_mfma_f32_16x16x32_bf16 a[32:35], v[168:171], v[144:147], a[32:35]
    v_mfma_f32_16x16x32_bf16 a[36:39], v[168:171], v[148:151], a[36:39]
    v_mfma_f32_16x16x32_bf16 a[40:43], v[168:171], v[152:155], a[40:43]
.L_mlp_zc3:
    v_mfma_f32_16x16x32_bf16 a[48:51], v[168:171], a[8:11], a[48:51]
    ds_read_b64_tr_b16 v[116:117], v33 offset:0
    ds_read_b64_tr_b16 v[118:119], v33 offset:240
    v_mfma_f32_16x16x32_bf16 a[56:59], a[8:11], a[8:11], a[56:59]
    ds_read_b64_tr_b16 v[100:101], v32 offset:80
    ds_read_b64_tr_b16 v[102:103], v32 offset:320
    v_mfma_f32_16x16x32_bf16 a[52:55], v[168:171], a[12:15], a[52:55]
    ds_read_b64_tr_b16 v[108:109], v32 offset:128
    ds_read_b64_tr_b16 v[110:111], v32 offset:368
    v_mfma_f32_16x16x32_bf16 a[60:63], a[12:15], a[12:15], a[60:63]
    ds_read_b64_tr_b16 v[104:105], v32 offset:160
    v_mfma_f32_16x16x32_bf16 v[76:79], a[24:27], v[144:147], v[76:79]
    ds_read_b64_tr_b16 v[106:107], v32 offset:400
    v_mfma_f32_16x16x32_bf16 v[80:83], a[28:31], v[144:147], v[80:83]
    ds_read_b64_tr_b16 v[112:113], v32 offset:208
    v_mfma_f32_16x16x32_bf16 v[44:47], a[24:27], v[128:131], v[44:47]
    ds_read_b64_tr_b16 v[114:115], v32 offset:448
    v_mfma_f32_16x16x32_bf16 v[48:51], a[28:31], v[128:131], v[48:51]
    ds_read_b64_tr_b16 v[120:121], v32 offset:0
    v_mfma_f32_16x16x32_bf16 v[60:63], a[24:27], v[136:139], v[60:63]
    ds_read_b64_tr_b16 v[122:123], v32 offset:240
    v_mfma_f32_16x16x32_bf16 v[64:67], a[28:31], v[136:139], v[64:67]
    ds_read_b64_tr_b16 v[124:125], v32 offset:48
    v_mfma_f32_16x16x32_bf16 v[52:55], a[24:27], v[132:135], v[52:55]
    ds_read_b64_tr_b16 v[126:127], v32 offset:288
    v_mfma_f32_16x16x32_bf16 v[56:59], a[28:31], v[132:135], v[56:59]
    ds_read_b128 a[16:19], v30 offset:0
    v_mfma_f32_16x16x32_bf16 v[68:71], a[24:27], v[140:143], v[68:71]
    ds_read_b128 a[20:23], v30 offset:2048
    v_mfma_f32_16x16x32_bf16 v[72:75], a[28:31], v[140:143], v[72:75]
    v_mfma_f32_16x16x32_bf16 v[84:87], v[148:151], a[24:27], v[84:87]
    v_mfma_f32_16x16x32_bf16 v[88:91], v[148:151], a[28:31], v[88:91]
    v_mfma_f32_16x16x32_bf16 v[92:95], v[152:155], a[24:27], v[92:95]
    v_mfma_f32_16x16x32_bf16 v[96:99], v[152:155], a[28:31], v[96:99]
    s_waitcnt lgkmcnt(0)
    s_bitcmp1_b32 s20, 1
    s_cbranch_scc1 .L_mlp_zc4
    s_bitcmp1_b32 s20, 0
    s_cbranch_scc1 .L_mlp_zb4
    v_mfma_f32_16x16x32_bf16 a[32:35], v[168:171], v[100:103], a[32:35]
    v_mfma_f32_16x16x32_bf16 a[36:39], v[168:171], v[104:107], a[36:39]
    v_mfma_f32_16x16x32_bf16 a[40:43], v[168:171], v[108:111], a[40:43]
    v_mfma_f32_16x16x32_bf16 a[44:47], v[168:171], v[112:115], a[44:47]
    s_branch .L_mlp_zc4
.L_mlp_zb4:
    v_mfma_f32_16x16x32_bf16 a[32:35], v[168:171], v[116:119], a[32:35]
    v_mfma_f32_16x16x32_bf16 a[36:39], v[168:171], v[120:123], a[36:39]
    v_mfma_f32_16x16x32_bf16 a[40:43], v[168:171], v[124:127], a[40:43]
.L_mlp_zc4:
    v_mfma_f32_16x16x32_bf16 a[48:51], v[168:171], a[16:19], a[48:51]
    ds_read_b64_tr_b16 v[144:145], v33 offset:7680
    ds_read_b64_tr_b16 v[146:147], v33 offset:7920
    v_mfma_f32_16x16x32_bf16 a[56:59], a[16:19], a[16:19], a[56:59]
    ds_read_b64_tr_b16 v[128:129], v32 offset:7760
    ds_read_b64_tr_b16 v[130:131], v32 offset:8000
    v_mfma_f32_16x16x32_bf16 a[52:55], v[168:171], a[20:23], a[52:55]
    ds_read_b64_tr_b16 v[136:137], v32 offset:7808
    ds_read_b64_tr_b16 v[138:139], v32 offset:8048
    v_mfma_f32_16x16x32_bf16 a[60:63], a[20:23], a[20:23], a[60:63]
    ds_read_b64_tr_b16 v[132:133], v32 offset:7840
    v_mfma_f32_16x16x32_bf16 v[76:79], a[0:3], v[116:119], v[76:79]
    ds_read_b64_tr_b16 v[134:135], v32 offset:8080
    v_mfma_f32_16x16x32_bf16 v[80:83], a[4:7], v[116:119], v[80:83]
    ds_read_b64_tr_b16 v[140:141], v32 offset:7888
    v_mfma_f32_16x16x32_bf16 v[44:47], a[0:3], v[100:103], v[44:47]
    ds_read_b64_tr_b16 v[142:143], v32 offset:8128
    v_mfma_f32_16x16x32_bf16 v[48:51], a[4:7], v[100:103], v[48:51]
    ds_read_b64_tr_b16 v[148:149], v32 offset:7680
    v_mfma_f32_16x16x32_bf16 v[60:63], a[0:3], v[108:111], v[60:63]
    ds_read_b64_tr_b16 v[150:151], v32 offset:7920
    v_mfma_f32_16x16x32_bf16 v[64:67], a[4:7], v[108:111], v[64:67]
    ds_read_b64_tr_b16 v[152:153], v32 offset:7728
    v_mfma_f32_16x16x32_bf16 v[52:55], a[0:3], v[104:107], v[52:55]
    ds_read_b64_tr_b16 v[154:155], v32 offset:7968
    v_mfma_f32_16x16x32_bf16 v[56:59], a[4:7], v[104:107], v[56:59]
    ds_read_b128 a[24:27], v31 offset:0
    v_mfma_f32_16x16x32_bf16 v[68:71], a[0:3], v[112:115], v[68:71]
    ds_read_b128 a[28:31], v31 offset:2048
    v_mfma_f32_16x16x32_bf16 v[72:75], a[4:7], v[112:115], v[72:75]
    v_mfma_f32_16x16x32_bf16 v[84:87], v[120:123], a[0:3], v[84:87]
    v_mfma_f32_16x16x32_bf16 v[88:91], v[120:123], a[4:7], v[88:91]
    v_mfma_f32_16x16x32_bf16 v[92:95], v[124:127], a[0:3], v[92:95]
    v_mfma_f32_16x16x32_bf16 v[96:99], v[124:127], a[4:7], v[96:99]
    s_waitcnt lgkmcnt(0)
    s_barrier
    s_bitcmp0_b32 s20, 1
    s_cbranch_scc1 .L_mlp_zc5
    s_bitcmp1_b32 s20, 0
    s_cbranch_scc1 .L_mlp_zb5
    v_mfma_f32_16x16x32_bf16 a[32:35], v[168:171], v[128:131], a[32:35]
    v_mfma_f32_16x16x32_bf16 a[36:39], v[168:171], v[132:135], a[36:39]
    v_mfma_f32_16x16x32_bf16 a[40:43], v[168:171], v[136:139], a[40:43]
    v_mfma_f32_16x16x32_bf16 a[44:47], v[168:171], v[140:143], a[44:47]
    s_branch .L_mlp_zc5
.L_mlp_zb5:
    v_mfma_f32_16x16x32_bf16 a[32:35], v[168:171], v[144:147], a[32:35]
    v_mfma_f32_16x16x32_bf16 a[36:39], v[168:171], v[148:151], a[36:39]
    v_mfma_f32_16x16x32_bf16 a[40:43], v[168:171], v[152:155], a[40:43]
.L_mlp_zc5:
    v_mfma_f32_16x16x32_bf16 a[48:51], v[168:171], a[24:27], a[48:51]
    ds_read_b64_tr_b16 v[116:117], v33 offset:31744
    ds_read_b64_tr_b16 v[118:119], v33 offset:31984
    v_mfma_f32_16x16x32_bf16 a[56:59], a[24:27], a[24:27], a[56:59]
    ds_read_b64_tr_b16 v[100:101], v32 offset:31824
    ds_read_b64_tr_b16 v[102:103], v32 offset:32064
    v_mfma_f32_16x16x32_bf16 a[52:55], v[168:171], a[28:31], a[52:55]
    ds_read_b64_tr_b16 v[108:109], v32 offset:31872
    ds_read_b64_tr_b16 v[110:111], v32 offset:32112
    v_mfma_f32_16x16x32_bf16 a[60:63], a[28:31], a[28:31], a[60:63]
    ds_read_b64_tr_b16 v[104:105], v32 offset:31904
    v_mfma_f32_16x16x32_bf16 v[76:79], a[8:11], v[144:147], v[76:79]
    ds_read_b64_tr_b16 v[106:107], v32 offset:32144
    v_mfma_f32_16x16x32_bf16 v[80:83], a[12:15], v[144:147], v[80:83]
    ds_read_b64_tr_b16 v[112:113], v32 offset:31952
    v_mfma_f32_16x16x32_bf16 v[44:47], a[8:11], v[128:131], v[44:47]
    ds_read_b64_tr_b16 v[114:115], v32 offset:32192
    v_mfma_f32_16x16x32_bf16 v[48:51], a[12:15], v[128:131], v[48:51]
    ds_read_b64_tr_b16 v[120:121], v32 offset:31744
    v_mfma_f32_16x16x32_bf16 v[60:63], a[8:11], v[136:139], v[60:63]
    ds_read_b64_tr_b16 v[122:123], v32 offset:31984
    v_mfma_f32_16x16x32_bf16 v[64:67], a[12:15], v[136:139], v[64:67]
    ds_read_b64_tr_b16 v[124:125], v32 offset:31792
    v_mfma_f32_16x16x32_bf16 v[52:55], a[8:11], v[132:135], v[52:55]
    ds_read_b64_tr_b16 v[126:127], v32 offset:32032
    v_mfma_f32_16x16x32_bf16 v[56:59], a[12:15], v[132:135], v[56:59]
    ds_read_b128 a[0:3], v30 offset:31744
    v_mfma_f32_16x16x32_bf16 v[68:71], a[8:11], v[140:143], v[68:71]
    ds_read_b128 a[4:7], v30 offset:33792
    v_mfma_f32_16x16x32_bf16 v[72:75], a[12:15], v[140:143], v[72:75]
    v_mfma_f32_16x16x32_bf16 v[84:87], v[148:151], a[8:11], v[84:87]
    v_mfma_f32_16x16x32_bf16 v[88:91], v[148:151], a[12:15], v[88:91]
    v_mfma_f32_16x16x32_bf16 v[92:95], v[152:155], a[8:11], v[92:95]
    v_mfma_f32_16x16x32_bf16 v[96:99], v[152:155], a[12:15], v[96:99]
    s_waitcnt lgkmcnt(0)
    s_bitcmp1_b32 s20, 1
    s_cbranch_scc1 .L_mlp_zc6
    s_bitcmp1_b32 s20, 0
    s_cbranch_scc1 .L_mlp_zb6
    v_mfma_f32_16x16x32_bf16 a[32:35], v[168:171], v[100:103], a[32:35]
    v_mfma_f32_16x16x32_bf16 a[36:39], v[168:171], v[104:107], a[36:39]
    v_mfma_f32_16x16x32_bf16 a[40:43], v[168:171], v[108:111], a[40:43]
    v_mfma_f32_16x16x32_bf16 a[44:47], v[168:171], v[112:115], a[44:47]
    s_branch .L_mlp_zc6
.L_mlp_zb6:
    v_mfma_f32_16x16x32_bf16 a[32:35], v[168:171], v[116:119], a[32:35]
    v_mfma_f32_16x16x32_bf16 a[36:39], v[168:171], v[120:123], a[36:39]
    v_mfma_f32_16x16x32_bf16 a[40:43], v[168:171], v[124:127], a[40:43]
.L_mlp_zc6:
    v_mfma_f32_16x16x32_bf16 a[48:51], v[168:171], a[0:3], a[48:51]
    ds_read_b64_tr_b16 v[144:145], v33 offset:39424
    ds_read_b64_tr_b16 v[146:147], v33 offset:39664
    v_mfma_f32_16x16x32_bf16 a[56:59], a[0:3], a[0:3], a[56:59]
    ds_read_b64_tr_b16 v[128:129], v32 offset:39504
    ds_read_b64_tr_b16 v[130:131], v32 offset:39744
    v_mfma_f32_16x16x32_bf16 a[52:55], v[168:171], a[4:7], a[52:55]
    ds_read_b64_tr_b16 v[136:137], v32 offset:39552
    ds_read_b64_tr_b16 v[138:139], v32 offset:39792
    v_mfma_f32_16x16x32_bf16 a[60:63], a[4:7], a[4:7], a[60:63]
    ds_read_b64_tr_b16 v[132:133], v32 offset:39584
    v_mfma_f32_16x16x32_bf16 v[76:79], a[16:19], v[116:119], v[76:79]
    ds_read_b64_tr_b16 v[134:135], v32 offset:39824
    v_mfma_f32_16x16x32_bf16 v[80:83], a[20:23], v[116:119], v[80:83]
    ds_read_b64_tr_b16 v[140:141], v32 offset:39632
    v_mfma_f32_16x16x32_bf16 v[44:47], a[16:19], v[100:103], v[44:47]
    ds_read_b64_tr_b16 v[142:143], v32 offset:39872
    v_mfma_f32_16x16x32_bf16 v[48:51], a[20:23], v[100:103], v[48:51]
    ds_read_b64_tr_b16 v[148:149], v32 offset:39424
    v_mfma_f32_16x16x32_bf16 v[60:63], a[16:19], v[108:111], v[60:63]
    ds_read_b64_tr_b16 v[150:151], v32 offset:39664
    v_mfma_f32_16x16x32_bf16 v[64:67], a[20:23], v[108:111], v[64:67]
    ds_read_b64_tr_b16 v[152:153], v32 offset:39472
    v_mfma_f32_16x16x32_bf16 v[52:55], a[16:19], v[104:107], v[52:55]
    ds_read_b64_tr_b16 v[154:155], v32 offset:39712
    v_mfma_f32_16x16x32_bf16 v[56:59], a[20:23], v[104:107], v[56:59]
    ds_read_b128 a[8:11], v31 offset:31744
    v_mfma_f32_16x16x32_bf16 v[68:71], a[16:19], v[112:115], v[68:71]
    ds_read_b128 a[12:15], v31 offset:33792
    v_mfma_f32_16x16x32_bf16 v[72:75], a[20:23], v[112:115], v[72:75]
    v_mfma_f32_16x16x32_bf16 v[84:87], v[120:123], a[16:19], v[84:87]
    v_mfma_f32_16x16x32_bf16 v[88:91], v[120:123], a[20:23], v[88:91]
    v_mfma_f32_16x16x32_bf16 v[92:95], v[124:127], a[16:19], v[92:95]
    v_mfma_f32_16x16x32_bf16 v[96:99], v[124:127], a[20:23], v[96:99]
    s_waitcnt lgkmcnt(0)
    s_barrier
    s_bitcmp0_b32 s20, 1
    s_cbranch_scc1 .L_mlp_zc7
    s_bitcmp1_b32 s20, 0
    s_cbranch_scc1 .L_mlp_zb7
    v_mfma_f32_16x16x32_bf16 a[32:35], v[168:171], v[128:131], a[32:35]
    v_mfma_f32_16x16x32_bf16 a[36:39], v[168:171], v[132:135], a[36:39]
    v_mfma_f32_16x16x32_bf16 a[40:43], v[168:171], v[136:139], a[40:43]
    v_mfma_f32_16x16x32_bf16 a[44:47], v[168:171], v[140:143], a[44:47]
    s_branch .L_mlp_zc7
.L_mlp_zb7:
    v_mfma_f32_16x16x32_bf16 a[32:35], v[168:171], v[144:147], a[32:35]
    v_mfma_f32_16x16x32_bf16 a[36:39], v[168:171], v[148:151], a[36:39]
    v_mfma_f32_16x16x32_bf16 a[40:43], v[168:171], v[152:155], a[40:43]
.L_mlp_zc7:
    v_mfma_f32_16x16x32_bf16 a[48:51], v[168:171], a[8:11], a[48:51]
    ds_read_b64_tr_b16 v[116:117], v11 offset:0
    ds_read_b64_tr_b16 v[118:119], v11 offset:240
    v_mfma_f32_16x16x32_bf16 a[56:59], a[8:11], a[8:11], a[56:59]
    ds_read_b64_tr_b16 v[100:101], v10 offset:80
    ds_read_b64_tr_b16 v[102:103], v10 offset:320
    v_mfma_f32_16x16x32_bf16 a[52:55], v[168:171], a[12:15], a[52:55]
    ds_read_b64_tr_b16 v[108:109], v10 offset:128
    ds_read_b64_tr_b16 v[110:111], v10 offset:368
    v_mfma_f32_16x16x32_bf16 a[60:63], a[12:15], a[12:15], a[60:63]
    ds_read_b64_tr_b16 v[104:105], v10 offset:160
    v_mfma_f32_16x16x32_bf16 v[76:79], a[24:27], v[144:147], v[76:79]
    ds_read_b64_tr_b16 v[106:107], v10 offset:400
    v_mfma_f32_16x16x32_bf16 v[80:83], a[28:31], v[144:147], v[80:83]
    ds_read_b64_tr_b16 v[112:113], v10 offset:208
    v_mfma_f32_16x16x32_bf16 v[44:47], a[24:27], v[128:131], v[44:47]
    ds_read_b64_tr_b16 v[114:115], v10 offset:448
    v_mfma_f32_16x16x32_bf16 v[48:51], a[28:31], v[128:131], v[48:51]
    ds_read_b64_tr_b16 v[120:121], v10 offset:0
    v_mfma_f32_16x16x32_bf16 v[60:63], a[24:27], v[136:139], v[60:63]
    ds_read_b64_tr_b16 v[122:123], v10 offset:240
    v_mfma_f32_16x16x32_bf16 v[64:67], a[28:31], v[136:139], v[64:67]
    ds_read_b64_tr_b16 v[124:125], v10 offset:48
    v_mfma_f32_16x16x32_bf16 v[52:55], a[24:27], v[132:135], v[52:55]
    ds_read_b64_tr_b16 v[126:127], v10 offset:288
    v_mfma_f32_16x16x32_bf16 v[56:59], a[28:31], v[132:135], v[56:59]
    ds_read_b128 a[16:19], v28 offset:0
    v_mfma_f32_16x16x32_bf16 v[68:71], a[24:27], v[140:143], v[68:71]
    ds_read_b128 a[20:23], v28 offset:2048
    v_mfma_f32_16x16x32_bf16 v[72:75], a[28:31], v[140:143], v[72:75]
    v_mfma_f32_16x16x32_bf16 v[84:87], v[148:151], a[24:27], v[84:87]
    v_mfma_f32_16x16x32_bf16 v[88:91], v[148:151], a[28:31], v[88:91]
    v_mfma_f32_16x16x32_bf16 v[92:95], v[152:155], a[24:27], v[92:95]
    v_mfma_f32_16x16x32_bf16 v[96:99], v[152:155], a[28:31], v[96:99]
    s_waitcnt lgkmcnt(0)
    s_bitcmp1_b32 s20, 1
    s_cbranch_scc1 .L_mlp_zc8
    s_bitcmp1_b32 s20, 0
    s_cbranch_scc1 .L_mlp_zb8
    v_mfma_f32_16x16x32_bf16 a[32:35], v[168:171], v[100:103], a[32:35]
    v_mfma_f32_16x16x32_bf16 a[36:39], v[168:171], v[104:107], a[36:39]
    v_mfma_f32_16x16x32_bf16 a[40:43], v[168:171], v[108:111], a[40:43]
    v_mfma_f32_16x16x32_bf16 a[44:47], v[168:171], v[112:115], a[44:47]
    s_branch .L_mlp_zc8
.L_mlp_zb8:
    v_mfma_f32_16x16x32_bf16 a[32:35], v[168:171], v[116:119], a[32:35]
    v_mfma_f32_16x16x32_bf16 a[36:39], v[168:171], v[120:123], a[36:39]
    v_mfma_f32_16x16x32_bf16 a[40:43], v[168:171], v[124:127], a[40:43]
.L_mlp_zc8:
    v_mfma_f32_16x16x32_bf16 a[48:51], v[168:171], a[16:19], a[48:51]
    ds_read_b64_tr_b16 v[144:145], v11 offset:7680
    ds_read_b64_tr_b16 v[146:147], v11 offset:7920
    v_mfma_f32_16x16x32_bf16 a[56:59], a[16:19], a[16:19], a[56:59]
    ds_read_b64_tr_b16 v[128:129], v10 offset:7760
    ds_read_b64_tr_b16 v[130:131], v10 offset:8000
    v_mfma_f32_16x16x32_bf16 a[52:55], v[168:171], a[20:23], a[52:55]
    ds_read_b64_tr_b16 v[136:137], v10 offset:7808
    ds_read_b64_tr_b16 v[138:139], v10 offset:8048
    v_mfma_f32_16x16x32_bf16 a[60:63], a[20:23], a[20:23], a[60:63]
    ds_read_b64_tr_b16 v[132:133], v10 offset:7840
    v_mfma_f32_16x16x32_bf16 v[76:79], a[0:3], v[116:119], v[76:79]
    ds_read_b64_tr_b16 v[134:135], v10 offset:8080
    v_mfma_f32_16x16x32_bf16 v[80:83], a[4:7], v[116:119], v[80:83]
    ds_read_b64_tr_b16 v[140:141], v10 offset:7888
    v_mfma_f32_16x16x32_bf16 v[44:47], a[0:3], v[100:103], v[44:47]
    ds_read_b64_tr_b16 v[142:143], v10 offset:8128
    v_mfma_f32_16x16x32_bf16 v[48:51], a[4:7], v[100:103], v[48:51]
    ds_read_b64_tr_b16 v[148:149], v10 offset:7680
    v_mfma_f32_16x16x32_bf16 v[60:63], a[0:3], v[108:111], v[60:63]
    ds_read_b64_tr_b16 v[150:151], v10 offset:7920
    v_mfma_f32_16x16x32_bf16 v[64:67], a[4:7], v[108:111], v[64:67]
    ds_read_b64_tr_b16 v[152:153], v10 offset:7728
    v_mfma_f32_16x16x32_bf16 v[52:55], a[0:3], v[104:107], v[52:55]
    ds_read_b64_tr_b16 v[154:155], v10 offset:7968
    v_mfma_f32_16x16x32_bf16 v[56:59], a[4:7], v[104:107], v[56:59]
    ds_read_b128 a[24:27], v29 offset:0
    v_mfma_f32_16x16x32_bf16 v[68:71], a[0:3], v[112:115], v[68:71]
    ds_read_b128 a[28:31], v29 offset:2048
    v_mfma_f32_16x16x32_bf16 v[72:75], a[4:7], v[112:115], v[72:75]
    v_mfma_f32_16x16x32_bf16 v[84:87], v[120:123], a[0:3], v[84:87]
    v_mfma_f32_16x16x32_bf16 v[88:91], v[120:123], a[4:7], v[88:91]
    v_mfma_f32_16x16x32_bf16 v[92:95], v[124:127], a[0:3], v[92:95]
    v_mfma_f32_16x16x32_bf16 v[96:99], v[124:127], a[4:7], v[96:99]
    s_waitcnt lgkmcnt(0)
    s_barrier
    s_bitcmp0_b32 s20, 1
    s_cbranch_scc1 .L_mlp_zc9
    s_bitcmp1_b32 s20, 0
    s_cbranch_scc1 .L_mlp_zb9
    v_mfma_f32_16x16x32_bf16 a[32:35], v[168:171], v[128:131], a[32:35]
    v_mfma_f32_16x16x32_bf16 a[36:39], v[168:171], v[132:135], a[36:39]
    v_mfma_f32_16x16x32_bf16 a[40:43], v[168:171], v[136:139], a[40:43]
    v_mfma_f32_16x16x32_bf16 a[44:47], v[168:171], v[140:143], a[44:47]
    s_branch .L_mlp_zc9
.L_mlp_zb9:
    v_mfma_f32_16x16x32_bf16 a[32:35], v[168:171], v[144:147], a[32:35]
    v_mfma_f32_16x16x32_bf16 a[36:39], v[168:171], v[148:151], a[36:39]
    v_mfma_f32_16x16x32_bf16 a[40:43], v[168:171], v[152:155], a[40:43]
.L_mlp_zc9:
    v_mfma_f32_16x16x32_bf16 a[48:51], v[168:171], a[24:27], a[48:51]
    ds_read_b64_tr_b16 v[116:117], v11 offset:31744
    ds_read_b64_tr_b16 v[118:119], v11 offset:31984
    v_mfma_f32_16x16x32_bf16 a[56:59], a[24:27], a[24:27], a[56:59]
    ds_read_b64_tr_b16 v[100:101], v10 offset:31824
    ds_read_b64_tr_b16 v[102:103], v10 offset:32064
    v_mfma_f32_16x16x32_bf16 a[52:55], v[168:171], a[28:31], a[52:55]
    ds_read_b64_tr_b16 v[108:109], v10 offset:31872
    ds_read_b64_tr_b16 v[110:111], v10 offset:32112
    v_mfma_f32_16x16x32_bf16 a[60:63], a[28:31], a[28:31], a[60:63]
    ds_read_b64_tr_b16 v[104:105], v10 offset:31904
    v_mfma_f32_16x16x32_bf16 v[76:79], a[8:11], v[144:147], v[76:79]
    ds_read_b64_tr_b16 v[106:107], v10 offset:32144
    v_mfma_f32_16x16x32_bf16 v[80:83], a[12:15], v[144:147], v[80:83]
    ds_read_b64_tr_b16 v[112:113], v10 offset:31952
    v_mfma_f32_16x16x32_bf16 v[44:47], a[8:11], v[128:131], v[44:47]
    ds_read_b64_tr_b16 v[114:115], v10 offset:32192
    v_mfma_f32_16x16x32_bf16 v[48:51], a[12:15], v[128:131], v[48:51]
    ds_read_b64_tr_b16 v[120:121], v10 offset:31744
    v_mfma_f32_16x16x32_bf16 v[60:63], a[8:11], v[136:139], v[60:63]
    ds_read_b64_tr_b16 v[122:123], v10 offset:31984
    v_mfma_f32_16x16x32_bf16 v[64:67], a[12:15], v[136:139], v[64:67]
    ds_read_b64_tr_b16 v[124:125], v10 offset:31792
    v_mfma_f32_16x16x32_bf16 v[52:55], a[8:11], v[132:135], v[52:55]
    ds_read_b64_tr_b16 v[126:127], v10 offset:32032
    v_mfma_f32_16x16x32_bf16 v[56:59], a[12:15], v[132:135], v[56:59]
    ds_read_b128 a[0:3], v28 offset:31744
    v_mfma_f32_16x16x32_bf16 v[68:71], a[8:11], v[140:143], v[68:71]
    ds_read_b128 a[4:7], v28 offset:33792
    v_mfma_f32_16x16x32_bf16 v[72:75], a[12:15], v[140:143], v[72:75]
    v_mfma_f32_16x16x32_bf16 v[84:87], v[148:151], a[8:11], v[84:87]
    v_mfma_f32_16x16x32_bf16 v[88:91], v[148:151], a[12:15], v[88:91]
    v_mfma_f32_16x16x32_bf16 v[92:95], v[152:155], a[8:11], v[92:95]
    v_mfma_f32_16x16x32_bf16 v[96:99], v[152:155], a[12:15], v[96:99]
    s_waitcnt lgkmcnt(0)
    s_bitcmp1_b32 s20, 1
    s_cbranch_scc1 .L_mlp_zc10
    s_bitcmp1_b32 s20, 0
    s_cbranch_scc1 .L_mlp_zb10
    v_mfma_f32_16x16x32_bf16 a[32:35], v[168:171], v[100:103], a[32:35]
    v_mfma_f32_16x16x32_bf16 a[36:39], v[168:171], v[104:107], a[36:39]
    v_mfma_f32_16x16x32_bf16 a[40:43], v[168:171], v[108:111], a[40:43]
    v_mfma_f32_16x16x32_bf16 a[44:47], v[168:171], v[112:115], a[44:47]
    s_branch .L_mlp_zc10
.L_mlp_zb10:
    v_mfma_f32_16x16x32_bf16 a[32:35], v[168:171], v[116:119], a[32:35]
    v_mfma_f32_16x16x32_bf16 a[36:39], v[168:171], v[120:123], a[36:39]
    v_mfma_f32_16x16x32_bf16 a[40:43], v[168:171], v[124:127], a[40:43]
.L_mlp_zc10:
    v_mfma_f32_16x16x32_bf16 a[48:51], v[168:171], a[0:3], a[48:51]
    ds_read_b64_tr_b16 v[144:145], v11 offset:39424
    ds_read_b64_tr_b16 v[146:147], v11 offset:39664
    v_mfma_f32_16x16x32_bf16 a[56:59], a[0:3], a[0:3], a[56:59]
    ds_read_b64_tr_b16 v[128:129], v10 offset:39504
    ds_read_b64_tr_b16 v[130:131], v10 offset:39744
    v_mfma_f32_16x16x32_bf16 a[52:55], v[168:171], a[4:7], a[52:55]
    ds_read_b64_tr_b16 v[136:137], v10 offset:39552
    ds_read_b64_tr_b16 v[138:139], v10 offset:39792
    v_mfma_f32_16x16x32_bf16 a[60:63], a[4:7], a[4:7], a[60:63]
    ds_read_b64_tr_b16 v[132:133], v10 offset:39584
    v_mfma_f32_16x16x32_bf16 v[76:79], a[16:19], v[116:119], v[76:79]
    ds_read_b64_tr_b16 v[134:135], v10 offset:39824
    v_mfma_f32_16x16x32_bf16 v[80:83], a[20:23], v[116:119], v[80:83]
    ds_read_b64_tr_b16 v[140:141], v10 offset:39632
    v_mfma_f32_16x16x32_bf16 v[44:47], a[16:19], v[100:103], v[44:47]
    ds_read_b64_tr_b16 v[142:143], v10 offset:39872
    v_mfma_f32_16x16x32_bf16 v[48:51], a[20:23], v[100:103], v[48:51]
    ds_read_b64_tr_b16 v[148:149], v10 offset:39424
    v_mfma_f32_16x16x32_bf16 v[60:63], a[16:19], v[108:111], v[60:63]
    ds_read_b64_tr_b16 v[150:151], v10 offset:39664
    v_mfma_f32_16x16x32_bf16 v[64:67], a[20:23], v[108:111], v[64:67]
    ds_read_b64_tr_b16 v[152:153], v10 offset:39472
    v_mfma_f32_16x16x32_bf16 v[52:55], a[16:19], v[104:107], v[52:55]
    ds_read_b64_tr_b16 v[154:155], v10 offset:39712
    v_mfma_f32_16x16x32_bf16 v[56:59], a[20:23], v[104:107], v[56:59]
    ds_read_b128 a[8:11], v29 offset:31744
    v_mfma_f32_16x16x32_bf16 v[68:71], a[16:19], v[112:115], v[68:71]
    ds_read_b128 a[12:15], v29 offset:33792
    v_mfma_f32_16x16x32_bf16 v[72:75], a[20:23], v[112:115], v[72:75]
    v_mfma_f32_16x16x32_bf16 v[84:87], v[120:123], a[16:19], v[84:87]
    v_mfma_f32_16x16x32_bf16 v[88:91], v[120:123], a[20:23], v[88:91]
    v_mfma_f32_16x16x32_bf16 v[92:95], v[124:127], a[16:19], v[92:95]
    v_mfma_f32_16x16x32_bf16 v[96:99], v[124:127], a[20:23], v[96:99]
    s_waitcnt lgkmcnt(0)
    s_barrier
    s_bitcmp0_b32 s20, 1
    s_cbranch_scc1 .L_mlp_zc11
    s_bitcmp1_b32 s20, 0
    s_cbranch_scc1 .L_mlp_zb11
    v_mfma_f32_16x16x32_bf16 a[32:35], v[168:171], v[128:131], a[32:35]
    v_mfma_f32_16x16x32_bf16 a[36:39], v[168:171], v[132:135], a[36:39]
    v_mfma_f32_16x16x32_bf16 a[40:43], v[168:171], v[136:139], a[40:43]
    v_mfma_f32_16x16x32_bf16 a[44:47], v[168:171], v[140:143], a[44:47]
    s_branch .L_mlp_zc11
.L_mlp_zb11:
    v_mfma_f32_16x16x32_bf16 a[32:35], v[168:171], v[144:147], a[32:35]
    v_mfma_f32_16x16x32_bf16 a[36:39], v[168:171], v[148:151], a[36:39]
    v_mfma_f32_16x16x32_bf16 a[40:43], v[168:171], v[152:155], a[40:43]
.L_mlp_zc11:
    v_mfma_f32_16x16x32_bf16 a[48:51], v[168:171], a[8:11], a[48:51]
    ds_read_b64_tr_b16 v[116:117], v33 offset:0
    ds_read_b64_tr_b16 v[118:119], v33 offset:240
    v_mfma_f32_16x16x32_bf16 a[56:59], a[8:11], a[8:11], a[56:59]
    ds_read_b64_tr_b16 v[100:101], v32 offset:80
    ds_read_b64_tr_b16 v[102:103], v32 offset:320
    v_mfma_f32_16x16x32_bf16 a[52:55], v[168:171], a[12:15], a[52:55]
    ds_read_b64_tr_b16 v[108:109], v32 offset:128
    ds_read_b64_tr_b16 v[110:111], v32 offset:368
    v_mfma_f32_16x16x32_bf16 a[60:63], a[12:15], a[12:15], a[60:63]
    ds_read_b64_tr_b16 v[104:105], v32 offset:160
    v_mfma_f32_16x16x32_bf16 v[76:79], a[24:27], v[144:147], v[76:79]
    ds_read_b64_tr_b16 v[106:107], v32 offset:400
    v_mfma_f32_16x16x32_bf16 v[80:83], a[28:31], v[144:147], v[80:83]
    ds_read_b64_tr_b16 v[112:113], v32 offset:208
    v_mfma_f32_16x16x32_bf16 v[44:47], a[24:27], v[128:131], v[44:47]
    ds_read_b64_tr_b16 v[114:115], v32 offset:448
    v_mfma_f32_16x16x32_bf16 v[48:51], a[28:31], v[128:131], v[48:51]
    ds_read_b64_tr_b16 v[120:121], v32 offset:0
    v_mfma_f32_16x16x32_bf16 v[60:63], a[24:27], v[136:139], v[60:63]
    ds_read_b64_tr_b16 v[122:123], v32 offset:240
    v_mfma_f32_16x16x32_bf16 v[64:67], a[28:31], v[136:139], v[64:67]
    ds_read_b64_tr_b16 v[124:125], v32 offset:48
    v_mfma_f32_16x16x32_bf16 v[52:55], a[24:27], v[132:135], v[52:55]
    ds_read_b64_tr_b16 v[126:127], v32 offset:288
    v_mfma_f32_16x16x32_bf16 v[56:59], a[28:31], v[132:135], v[56:59]
    ds_read_b128 a[16:19], v30 offset:0
    v_mfma_f32_16x16x32_bf16 v[68:71], a[24:27], v[140:143], v[68:71]
    ds_read_b128 a[20:23], v30 offset:2048
    v_mfma_f32_16x16x32_bf16 v[72:75], a[28:31], v[140:143], v[72:75]
    v_mfma_f32_16x16x32_bf16 v[84:87], v[148:151], a[24:27], v[84:87]
    v_mfma_f32_16x16x32_bf16 v[88:91], v[148:151], a[28:31], v[88:91]
    v_mfma_f32_16x16x32_bf16 v[92:95], v[152:155], a[24:27], v[92:95]
    v_mfma_f32_16x16x32_bf16 v[96:99], v[152:155], a[28:31], v[96:99]
    s_waitcnt lgkmcnt(0)
    s_bitcmp1_b32 s20, 1
    s_cbranch_scc1 .L_mlp_zc12
    s_bitcmp1_b32 s20, 0
    s_cbranch_scc1 .L_mlp_zb12
    v_mfma_f32_16x16x32_bf16 a[32:35], v[168:171], v[100:103], a[32:35]
    v_mfma_f32_16x16x32_bf16 a[36:39], v[168:171], v[104:107], a[36:39]
    v_mfma_f32_16x16x32_bf16 a[40:43], v[168:171], v[108:111], a[40:43]
    v_mfma_f32_16x16x32_bf16 a[44:47], v[168:171], v[112:115], a[44:47]
    s_branch .L_mlp_zc12
.L_mlp_zb12:
    v_mfma_f32_16x16x32_bf16 a[32:35], v[168:171], v[116:119], a[32:35]
    v_mfma_f32_16x16x32_bf16 a[36:39], v[168:171], v[120:123], a[36:39]
    v_mfma_f32_16x16x32_bf16 a[40:43], v[168:171], v[124:127], a[40:43]
.L_mlp_zc12:
    v_mfma_f32_16x16x32_bf16 a[48:51], v[168:171], a[16:19], a[48:51]
    ds_read_b64_tr_b16 v[144:145], v33 offset:7680
    ds_read_b64_tr_b16 v[146:147], v33 offset:7920
    v_mfma_f32_16x16x32_bf16 a[56:59], a[16:19], a[16:19], a[56:59]
    ds_read_b64_tr_b16 v[128:129], v32 offset:7760
    ds_read_b64_tr_b16 v[130:131], v32 offset:8000
    v_mfma_f32_16x16x32_bf16 a[52:55], v[168:171], a[20:23], a[52:55]
    ds_read_b64_tr_b16 v[136:137], v32 offset:7808
    ds_read_b64_tr_b16 v[138:139], v32 offset:8048
    v_mfma_f32_16x16x32_bf16 a[60:63], a[20:23], a[20:23], a[60:63]
    ds_read_b64_tr_b16 v[132:133], v32 offset:7840
    v_mfma_f32_16x16x32_bf16 v[76:79], a[0:3], v[116:119], v[76:79]
    ds_read_b64_tr_b16 v[134:135], v32 offset:8080
    v_mfma_f32_16x16x32_bf16 v[80:83], a[4:7], v[116:119], v[80:83]
    ds_read_b64_tr_b16 v[140:141], v32 offset:7888
    v_mfma_f32_16x16x32_bf16 v[44:47], a[0:3], v[100:103], v[44:47]
    ds_read_b64_tr_b16 v[142:143], v32 offset:8128
    v_mfma_f32_16x16x32_bf16 v[48:51], a[4:7], v[100:103], v[48:51]
    ds_read_b64_tr_b16 v[148:149], v32 offset:7680
    v_mfma_f32_16x16x32_bf16 v[60:63], a[0:3], v[108:111], v[60:63]
    ds_read_b64_tr_b16 v[150:151], v32 offset:7920
    v_mfma_f32_16x16x32_bf16 v[64:67], a[4:7], v[108:111], v[64:67]
    ds_read_b64_tr_b16 v[152:153], v32 offset:7728
    v_mfma_f32_16x16x32_bf16 v[52:55], a[0:3], v[104:107], v[52:55]
    ds_read_b64_tr_b16 v[154:155], v32 offset:7968
    v_mfma_f32_16x16x32_bf16 v[56:59], a[4:7], v[104:107], v[56:59]
    ds_read_b128 a[24:27], v31 offset:0
    v_mfma_f32_16x16x32_bf16 v[68:71], a[0:3], v[112:115], v[68:71]
    ds_read_b128 a[28:31], v31 offset:2048
    v_mfma_f32_16x16x32_bf16 v[72:75], a[4:7], v[112:115], v[72:75]
    v_mfma_f32_16x16x32_bf16 v[84:87], v[120:123], a[0:3], v[84:87]
    v_mfma_f32_16x16x32_bf16 v[88:91], v[120:123], a[4:7], v[88:91]
    v_mfma_f32_16x16x32_bf16 v[92:95], v[124:127], a[0:3], v[92:95]
    v_mfma_f32_16x16x32_bf16 v[96:99], v[124:127], a[4:7], v[96:99]
    s_waitcnt lgkmcnt(0)
    s_barrier
    s_bitcmp0_b32 s20, 1
    s_cbranch_scc1 .L_mlp_zc13
    s_bitcmp1_b32 s20, 0
    s_cbranch_scc1 .L_mlp_zb13
    v_mfma_f32_16x16x32_bf16 a[32:35], v[168:171], v[128:131], a[32:35]
    v_mfma_f32_16x16x32_bf16 a[36:39], v[168:171], v[132:135], a[36:39]
    v_mfma_f32_16x16x32_bf16 a[40:43], v[168:171], v[136:139], a[40:43]
    v_mfma_f32_16x16x32_bf16 a[44:47], v[168:171], v[140:143], a[44:47]
    s_branch .L_mlp_zc13
.L_mlp_zb13:
    v_mfma_f32_16x16x32_bf16 a[32:35], v[168:171], v[144:147], a[32:35]
    v_mfma_f32_16x16x32_bf16 a[36:39], v[168:171], v[148:151], a[36:39]
    v_mfma_f32_16x16x32_bf16 a[40:43], v[168:171], v[152:155], a[40:43]
.L_mlp_zc13:
    v_mfma_f32_16x16x32_bf16 a[48:51], v[168:171], a[24:27], a[48:51]
    ds_read_b64_tr_b16 v[116:117], v33 offset:31744
    ds_read_b64_tr_b16 v[118:119], v33 offset:31984
    v_mfma_f32_16x16x32_bf16 a[56:59], a[24:27], a[24:27], a[56:59]
    ds_read_b64_tr_b16 v[100:101], v32 offset:31824
    ds_read_b64_tr_b16 v[102:103], v32 offset:32064
    v_mfma_f32_16x16x32_bf16 a[52:55], v[168:171], a[28:31], a[52:55]
    ds_read_b64_tr_b16 v[108:109], v32 offset:31872
    ds_read_b64_tr_b16 v[110:111], v32 offset:32112
    v_mfma_f32_16x16x32_bf16 a[60:63], a[28:31], a[28:31], a[60:63]
    ds_read_b64_tr_b16 v[104:105], v32 offset:31904
    v_mfma_f32_16x16x32_bf16 v[76:79], a[8:11], v[144:147], v[76:79]
    ds_read_b64_tr_b16 v[106:107], v32 offset:32144
    v_mfma_f32_16x16x32_bf16 v[80:83], a[12:15], v[144:147], v[80:83]
    ds_read_b64_tr_b16 v[112:113], v32 offset:31952
    v_mfma_f32_16x16x32_bf16 v[44:47], a[8:11], v[128:131], v[44:47]
    ds_read_b64_tr_b16 v[114:115], v32 offset:32192
    v_mfma_f32_16x16x32_bf16 v[48:51], a[12:15], v[128:131], v[48:51]
    ds_read_b64_tr_b16 v[120:121], v32 offset:31744
    v_mfma_f32_16x16x32_bf16 v[60:63], a[8:11], v[136:139], v[60:63]
    ds_read_b64_tr_b16 v[122:123], v32 offset:31984
    v_mfma_f32_16x16x32_bf16 v[64:67], a[12:15], v[136:139], v[64:67]
    ds_read_b64_tr_b16 v[124:125], v32 offset:31792
    v_mfma_f32_16x16x32_bf16 v[52:55], a[8:11], v[132:135], v[52:55]
    ds_read_b64_tr_b16 v[126:127], v32 offset:32032
    v_mfma_f32_16x16x32_bf16 v[56:59], a[12:15], v[132:135], v[56:59]
    ds_read_b128 a[0:3], v30 offset:31744
    v_mfma_f32_16x16x32_bf16 v[68:71], a[8:11], v[140:143], v[68:71]
    ds_read_b128 a[4:7], v30 offset:33792
    v_mfma_f32_16x16x32_bf16 v[72:75], a[12:15], v[140:143], v[72:75]
    v_mfma_f32_16x16x32_bf16 v[84:87], v[148:151], a[8:11], v[84:87]
    v_mfma_f32_16x16x32_bf16 v[88:91], v[148:151], a[12:15], v[88:91]
    v_mfma_f32_16x16x32_bf16 v[92:95], v[152:155], a[8:11], v[92:95]
    v_mfma_f32_16x16x32_bf16 v[96:99], v[152:155], a[12:15], v[96:99]
    s_waitcnt lgkmcnt(0)
    s_bitcmp1_b32 s20, 1
    s_cbranch_scc1 .L_mlp_zc14
    s_bitcmp1_b32 s20, 0
    s_cbranch_scc1 .L_mlp_zb14
    v_mfma_f32_16x16x32_bf16 a[32:35], v[168:171], v[100:103], a[32:35]
    v_mfma_f32_16x16x32_bf16 a[36:39], v[168:171], v[104:107], a[36:39]
    v_mfma_f32_16x16x32_bf16 a[40:43], v[168:171], v[108:111], a[40:43]
    v_mfma_f32_16x16x32_bf16 a[44:47], v[168:171], v[112:115], a[44:47]
    s_branch .L_mlp_zc14
.L_mlp_zb14:
    v_mfma_f32_16x16x32_bf16 a[32:35], v[168:171], v[116:119], a[32:35]
    v_mfma_f32_16x16x32_bf16 a[36:39], v[168:171], v[120:123], a[36:39]
    v_mfma_f32_16x16x32_bf16 a[40:43], v[168:171], v[124:127], a[40:43]
.L_mlp_zc14:
    v_mfma_f32_16x16x32_bf16 a[48:51], v[168:171], a[0:3], a[48:51]
    ds_read_b64_tr_b16 v[144:145], v33 offset:39424
    ds_read_b64_tr_b16 v[146:147], v33 offset:39664
    v_mov_b32 v6, 0
    v_mfma_f32_16x16x32_bf16 a[56:59], a[0:3], a[0:3], a[56:59]
    ds_read_b64_tr_b16 v[128:129], v32 offset:39504
    ds_read_b64_tr_b16 v[130:131], v32 offset:39744
    v_lshlrev_b32 v7, 3, v1
    v_mfma_f32_16x16x32_bf16 a[52:55], v[168:171], a[4:7], a[52:55]
    ds_read_b64_tr_b16 v[136:137], v32 offset:39552
    ds_read_b64_tr_b16 v[138:139], v32 offset:39792
    v_mfma_f32_16x16x32_bf16 a[60:63], a[4:7], a[4:7], a[60:63]
    ds_read_b64_tr_b16 v[132:133], v32 offset:39584
    ds_write_b32 v7, v6 offset:64512
    v_mfma_f32_16x16x32_bf16 v[76:79], a[16:19], v[116:119], v[76:79]
    ds_read_b64_tr_b16 v[134:135], v32 offset:39824
    ds_write_b32 v7, v6 offset:64516
    v_mfma_f32_16x16x32_bf16 v[80:83], a[20:23], v[116:119], v[80:83]
    ds_read_b64_tr_b16 v[140:141], v32 offset:39632
    v_mfma_f32_16x16x32_bf16 v[44:47], a[16:19], v[100:103], v[44:47]
    ds_read_b64_tr_b16 v[142:143], v32 offset:39872
    v_mfma_f32_16x16x32_bf16 v[48:51], a[20:23], v[100:103], v[48:51]
    ds_read_b64_tr_b16 v[148:149], v32 offset:39424
    v_mfma_f32_16x16x32_bf16 v[60:63], a[16:19], v[108:111], v[60:63]
    ds_read_b64_tr_b16 v[150:151], v32 offset:39664
    v_mfma_f32_16x16x32_bf16 v[64:67], a[20:23], v[108:111], v[64:67]
    ds_read_b64_tr_b16 v[152:153], v32 offset:39472
    v_mfma_f32_16x16x32_bf16 v[52:55], a[16:19], v[104:107], v[52:55]
    ds_read_b64_tr_b16 v[154:155], v32 offset:39712
    v_mfma_f32_16x16x32_bf16 v[56:59], a[20:23], v[104:107], v[56:59]
    ds_read_b128 a[8:11], v31 offset:31744
    v_mfma_f32_16x16x32_bf16 v[68:71], a[16:19], v[112:115], v[68:71]
    ds_read_b128 a[12:15], v31 offset:33792
    v_mfma_f32_16x16x32_bf16 v[72:75], a[20:23], v[112:115], v[72:75]
    v_mfma_f32_16x16x32_bf16 v[84:87], v[120:123], a[16:19], v[84:87]
    v_mfma_f32_16x16x32_bf16 v[88:91], v[120:123], a[20:23], v[88:91]
    v_mfma_f32_16x16x32_bf16 v[92:95], v[124:127], a[16:19], v[92:95]
    v_mfma_f32_16x16x32_bf16 v[96:99], v[124:127], a[20:23], v[96:99]
    s_waitcnt lgkmcnt(0)
    s_barrier
    s_bitcmp0_b32 s20, 1
    s_cbranch_scc1 .L_mlp_zc15
    s_bitcmp1_b32 s20, 0
    s_cbranch_scc1 .L_mlp_zb15
    v_mfma_f32_16x16x32_bf16 a[32:35], v[168:171], v[128:131], a[32:35]
    v_mfma_f32_16x16x32_bf16 a[36:39], v[168:171], v[132:135], a[36:39]
    v_mfma_f32_16x16x32_bf16 a[40:43], v[168:171], v[136:139], a[40:43]
    v_mfma_f32_16x16x32_bf16 a[44:47], v[168:171], v[140:143], a[44:47]
    s_branch .L_mlp_zc15
.L_mlp_zb15:
    v_mfma_f32_16x16x32_bf16 a[32:35], v[168:171], v[144:147], a[32:35]
    v_mfma_f32_16x16x32_bf16 a[36:39], v[168:171], v[148:151], a[36:39]
    v_mfma_f32_16x16x32_bf16 a[40:43], v[168:171], v[152:155], a[40:43]
.L_mlp_zc15:
    v_mfma_f32_16x16x32_bf16 a[48:51], v[168:171], a[8:11], a[48:51]
    ds_read_b64_tr_b16 v[116:117], v11 offset:0
    ds_read_b64_tr_b16 v[118:119], v11 offset:240
    v_mfma_f32_16x16x32_bf16 a[56:59], a[8:11], a[8:11], a[56:59]
    ds_read_b64_tr_b16 v[100:101], v10 offset:80
    v_mfma_f32_16x16x32_bf16 a[52:55], v[168:171], a[12:15], a[52:55]
    ds_read_b64_tr_b16 v[102:103], v10 offset:320
    v_mfma_f32_16x16x32_bf16 a[60:63], a[12:15], a[12:15], a[60:63]
    ds_read_b64_tr_b16 v[108:109], v10 offset:128
    v_mfma_f32_16x16x32_bf16 v[76:79], a[24:27], v[144:147], v[76:79]
    ds_read_b64_tr_b16 v[110:111], v10 offset:368
    v_mfma_f32_16x16x32_bf16 v[80:83], a[28:31], v[144:147], v[80:83]
    ds_read_b64_tr_b16 v[104:105], v10 offset:160
    v_mfma_f32_16x16x32_bf16 v[44:47], a[24:27], v[128:131], v[44:47]
    ds_read_b64_tr_b16 v[106:107], v10 offset:400
    v_mfma_f32_16x16x32_bf16 v[48:51], a[28:31], v[128:131], v[48:51]
    ds_read_b64_tr_b16 v[112:113], v10 offset:208
    v_mfma_f32_16x16x32_bf16 v[60:63], a[24:27], v[136:139], v[60:63]
    ds_read_b64_tr_b16 v[114:115], v10 offset:448
    v_mfma_f32_16x16x32_bf16 v[64:67], a[28:31], v[136:139], v[64:67]
    ds_read_b64_tr_b16 v[120:121], v10 offset:0
    v_mfma_f32_16x16x32_bf16 v[52:55], a[24:27], v[132:135], v[52:55]
    ds_read_b64_tr_b16 v[122:123], v10 offset:240
    v_mfma_f32_16x16x32_bf16 v[56:59], a[28:31], v[132:135], v[56:59]
    ds_read_b64_tr_b16 v[124:125], v10 offset:48
    v_mfma_f32_16x16x32_bf16 v[68:71], a[24:27], v[140:143], v[68:71]
    ds_read_b64_tr_b16 v[126:127], v10 offset:288
    v_mfma_f32_16x16x32_bf16 v[72:75], a[28:31], v[140:143], v[72:75]
    v_mfma_f32_16x16x32_bf16 v[84:87], v[148:151], a[24:27], v[84:87]
    v_mfma_f32_16x16x32_bf16 v[88:91], v[148:151], a[28:31], v[88:91]
    v_mfma_f32_16x16x32_bf16 v[92:95], v[152:155], a[24:27], v[92:95]
    v_mfma_f32_16x16x32_bf16 v[96:99], v[152:155], a[28:31], v[96:99]
    s_waitcnt lgkmcnt(0)
    s_bitcmp1_b32 s20, 1
    s_cbranch_scc1 .L_mlp_zc16
    s_bitcmp1_b32 s20, 0
    s_cbranch_scc1 .L_mlp_zb16
    v_mfma_f32_16x16x32_bf16 a[32:35], v[168:171], v[100:103], a[32:35]
    v_mfma_f32_16x16x32_bf16 a[36:39], v[168:171], v[104:107], a[36:39]
    v_mfma_f32_16x16x32_bf16 a[40:43], v[168:171], v[108:111], a[40:43]
    v_mfma_f32_16x16x32_bf16 a[44:47], v[168:171], v[112:115], a[44:47]
    s_branch .L_mlp_zc16
.L_mlp_zb16:
    v_mfma_f32_16x16x32_bf16 a[32:35], v[168:171], v[116:119], a[32:35]
    v_mfma_f32_16x16x32_bf16 a[36:39], v[168:171], v[120:123], a[36:39]
    v_mfma_f32_16x16x32_bf16 a[40:43], v[168:171], v[124:127], a[40:43]
.L_mlp_zc16:
    v_mfma_f32_16x16x32_bf16 v[76:79], a[0:3], v[116:119], v[76:79]
    ds_read_b64_tr_b16 v[144:145], v11 offset:7680
    ds_read_b64_tr_b16 v[146:147], v11 offset:7920
    v_accvgpr_read_b32 v172, a48
    v_mov_b32 v176, 0
    v_mfma_f32_16x16x32_bf16 v[80:83], a[4:7], v[116:119], v[80:83]
    ds_read_b64_tr_b16 v[128:129], v10 offset:7760
    ds_read_b64_tr_b16 v[130:131], v10 offset:8000
    v_accvgpr_read_b32 v177, a56
    v_cndmask_b32 v176, v176, v177, s[60:61]
    v_mfma_f32_16x16x32_bf16 v[44:47], a[0:3], v[100:103], v[44:47]
    ds_read_b64_tr_b16 v[136:137], v10 offset:7808
    ds_read_b64_tr_b16 v[138:139], v10 offset:8048
    v_accvgpr_read_b32 v177, a57
    v_cndmask_b32 v176, v176, v177, s[62:63]
    v_mfma_f32_16x16x32_bf16 v[48:51], a[4:7], v[100:103], v[48:51]
    ds_read_b64_tr_b16 v[132:133], v10 offset:7840
    ds_read_b64_tr_b16 v[134:135], v10 offset:8080
    v_accvgpr_read_b32 v177, a58
    v_mfma_f32_16x16x32_bf16 v[60:63], a[0:3], v[108:111], v[60:63]
    ds_read_b64_tr_b16 v[140:141], v10 offset:7888
    ds_read_b64_tr_b16 v[142:143], v10 offset:8128
    v_cndmask_b32 v176, v176, v177, s[80:81]
    v_accvgpr_read_b32 v177, a59
    v_mfma_f32_16x16x32_bf16 v[64:67], a[4:7], v[108:111], v[64:67]
    ds_read_b64_tr_b16 v[148:149], v10 offset:7680
    v_cndmask_b32 v176, v176, v177, s[82:83]
    v_accvgpr_read_b32 v173, a52
    v_mfma_f32_16x16x32_bf16 v[52:55], a[0:3], v[104:107], v[52:55]
    ds_read_b64_tr_b16 v[150:151], v10 offset:7920
    v_mov_b32 v180, 0
    v_accvgpr_read_b32 v181, a60
    v_mfma_f32_16x16x32_bf16 v[56:59], a[4:7], v[104:107], v[56:59]
    ds_read_b64_tr_b16 v[152:153], v10 offset:7728
    v_cndmask_b32 v180, v180, v181, s[60:61]
    v_accvgpr_read_b32 v181, a61
    v_mfma_f32_16x16x32_bf16 v[68:71], a[0:3], v[112:115], v[68:71]
    ds_read_b64_tr_b16 v[154:155], v10 offset:7968
    v_cndmask_b32 v180, v180, v181, s[62:63]
    v_accvgpr_read_b32 v181, a62
    v_mfma_f32_16x16x32_bf16 v[72:75], a[4:7], v[112:115], v[72:75]
    v_cndmask_b32 v180, v180, v181, s[80:81]
    v_accvgpr_read_b32 v181, a63
    v_mfma_f32_16x16x32_bf16 v[84:87], v[120:123], a[0:3], v[84:87]
    v_cndmask_b32 v180, v180, v181, s[82:83]
    v_mov_b32 v177, v176
    v_mov_b32 v181, v180
    v_mul_f32 v172, 0x3ae38e39, v172
    v_mfma_f32_16x16x32_bf16 v[88:91], v[120:123], a[4:7], v[88:91]
    v_permlane32_swap_b32 v176, v177
    v_permlane32_swap_b32 v180, v181
    v_add_f32 v176, v176, v177
    v_mfma_f32_16x16x32_bf16 v[92:95], v[124:127], a[0:3], v[92:95]
    v_add_f32 v180, v180, v181
    v_mov_b32 v177, v176
    v_mov_b32 v181, v180
    v_mfma_f32_16x16x32_bf16 v[96:99], v[124:127], a[4:7], v[96:99]
    v_mul_f32 v173, 0x3ae38e39, v173
    v_permlane16_swap_b32 v176, v177
    v_permlane16_swap_b32 v180, v181
    s_waitcnt lgkmcnt(0)
    s_bitcmp0_b32 s20, 1
    s_cbranch_scc1 .L_mlp_zc17
    s_bitcmp1_b32 s20, 0
    s_cbranch_scc1 .L_mlp_zb17
    v_mfma_f32_16x16x32_bf16 a[32:35], v[168:171], v[128:131], a[32:35]
    v_mfma_f32_16x16x32_bf16 a[36:39], v[168:171], v[132:135], a[36:39]
    v_mfma_f32_16x16x32_bf16 a[40:43], v[168:171], v[136:139], a[40:43]
    v_mfma_f32_16x16x32_bf16 a[44:47], v[168:171], v[140:143], a[44:47]
    s_branch .L_mlp_zc17
.L_mlp_zb17:
    v_mfma_f32_16x16x32_bf16 a[32:35], v[168:171], v[144:147], a[32:35]
    v_mfma_f32_16x16x32_bf16 a[36:39], v[168:171], v[148:151], a[36:39]
    v_mfma_f32_16x16x32_bf16 a[40:43], v[168:171], v[152:155], a[40:43]
.L_mlp_zc17:
    v_mfma_f32_16x16x32_bf16 v[76:79], a[8:11], v[144:147], v[76:79]
    v_add_f32 v176, v176, v177
    v_add_f32 v180, v180, v181
    v_mul_f32 v176, 0x3ae38e39, v176
    v_mul_f32 v180, 0x3ae38e39, v180
    v_mfma_f32_16x16x32_bf16 v[80:83], a[12:15], v[144:147], v[80:83]
    s_mov_b64 exec, 0xffff
    ds_add_f32 v39, a32 offset:64512
    ds_add_f32 v39, a36 offset:64576
    ds_add_f32 v39, a40 offset:64640
    ds_add_f32 v39, a44 offset:64704
    s_mov_b64 exec, -1
    v_fma_f32 v176, -v172, v172, v176
    v_fma_f32 v180, -v173, v173, v180
    v_mfma_f32_16x16x32_bf16 v[44:47], a[8:11], v[128:131], v[44:47]
    v_max_f32 v176, 0, v176
    v_max_f32 v180, 0, v180
    v_add_f32 v176, 0x3727c5ac, v176
    v_add_f32 v180, 0x3727c5ac, v180
    v_mfma_f32_16x16x32_bf16 v[48:51], a[12:15], v[128:131], v[48:51]
    v_rsq_f32 v156, v176
    v_mfma_f32_16x16x32_bf16 v[60:63], a[8:11], v[136:139], v[60:63]
    v_rsq_f32 v158, v180
    ds_write_b32 v12, v172 offset:128
    ds_write_b32 v12, v173 offset:192
    v_mfma_f32_16x16x32_bf16 v[64:67], a[12:15], v[136:139], v[64:67]
    ds_write_b32 v12, v156 offset:0
    ds_write_b32 v12, v158 offset:64
    v_mul_f32 v157, 0x3fb8aa3b, v156
    v_mfma_f32_16x16x32_bf16 v[52:55], a[8:11], v[132:135], v[52:55]
    v_mul_f32 v159, 0x3fb8aa3b, v158
    ds_read_b128 v[176:179], v9 offset:128
    ds_read_b128 v[160:163], v9 offset:0
    ds_read_b128 v[180:183], v9 offset:192
    v_mfma_f32_16x16x32_bf16 v[56:59], a[12:15], v[132:135], v[56:59]
    s_waitcnt lgkmcnt(0)
    s_barrier
    ds_read_b32 v100, v40 offset:64512
    ds_read_b32 v101, v40 offset:64576
    ds_read_b32 v102, v40 offset:64640
    ds_read_b32 v103, v40 offset:64704
    ds_read_b32 v104, v40 offset:64768
    ds_read_b128 v[108:111], v41 offset:64832
    ds_read_b128 v[112:115], v41 offset:64896
    ds_read_b128 v[164:167], v9 offset:64
    v_mfma_f32_16x16x32_bf16 v[68:71], a[8:11], v[140:143], v[68:71]
    v_mfma_f32_16x16x32_bf16 v[72:75], a[12:15], v[140:143], v[72:75]
    v_mfma_f32_16x16x32_bf16 v[84:87], v[148:151], a[8:11], v[84:87]
    v_mfma_f32_16x16x32_bf16 v[88:91], v[148:151], a[12:15], v[88:91]
    v_mfma_f32_16x16x32_bf16 v[92:95], v[152:155], a[8:11], v[92:95]
    v_mfma_f32_16x16x32_bf16 v[96:99], v[152:155], a[12:15], v[96:99]
    v_mul_f32 v168, 0x3fb8aa3b, v160
    v_mul_f32 v169, 0x3fb8aa3b, v161
    v_mul_f32 v170, 0x3fb8aa3b, v162
    v_mul_f32 v171, 0x3fb8aa3b, v163
    s_waitcnt lgkmcnt(3)
    v_fma_f32 v76, -v176, v104, v76
    v_fma_f32 v77, -v177, v104, v77
    v_fma_f32 v78, -v178, v104, v78
    v_fma_f32 v79, -v179, v104, v79
    v_fma_f32 v80, -v180, v104, v80
    v_fma_f32 v81, -v181, v104, v81
    v_fma_f32 v82, -v182, v104, v82
    v_fma_f32 v83, -v183, v104, v83
    v_fma_f32 v44, -v176, v100, v44
    v_fma_f32 v45, -v177, v100, v45
    v_fma_f32 v46, -v178, v100, v46
    v_fma_f32 v47, -v179, v100, v47
    v_fma_f32 v48, -v180, v100, v48
    v_fma_f32 v49, -v181, v100, v49
    v_fma_f32 v50, -v182, v100, v50
    v_fma_f32 v51, -v183, v100, v51
    v_fma_f32 v60, -v176, v102, v60
    v_fma_f32 v61, -v177, v102, v61
    v_fma_f32 v62, -v178, v102, v62
    v_fma_f32 v63, -v179, v102, v63
    v_fma_f32 v64, -v180, v102, v64
    v_fma_f32 v65, -v181, v102, v65
    v_fma_f32 v66, -v182, v102, v66
    v_fma_f32 v67, -v183, v102, v67
    v_fma_f32 v52, -v176, v101, v52
    v_fma_f32 v53, -v177, v101, v53
    v_fma_f32 v54, -v178, v101, v54
    v_fma_f32 v55, -v179, v101, v55
    v_fma_f32 v56, -v180, v101, v56
    v_fma_f32 v57, -v181, v101, v57
    v_fma_f32 v58, -v182, v101, v58
    v_fma_f32 v59, -v183, v101, v59
    v_fma_f32 v68, -v176, v103, v68
    v_fma_f32 v69, -v177, v103, v69
    v_fma_f32 v70, -v178, v103, v70
    v_fma_f32 v71, -v179, v103, v71
    v_fma_f32 v72, -v180, v103, v72
    v_fma_f32 v73, -v181, v103, v73
    v_fma_f32 v74, -v182, v103, v74
    v_fma_f32 v75, -v183, v103, v75
    s_waitcnt lgkmcnt(2)
    v_fma_f32 v84, -v172, v108, v84
    v_fma_f32 v85, -v172, v109, v85
    v_fma_f32 v86, -v172, v110, v86
    v_fma_f32 v87, -v172, v111, v87
    v_fma_f32 v88, -v173, v108, v88
    v_fma_f32 v89, -v173, v109, v89
    v_fma_f32 v90, -v173, v110, v90
    v_fma_f32 v91, -v173, v111, v91
    s_waitcnt lgkmcnt(1)
    v_fma_f32 v92, -v172, v112, v92
    v_fma_f32 v93, -v172, v113, v93
    v_fma_f32 v94, -v172, v114, v94
    v_fma_f32 v95, -v172, v115, v95
    v_fma_f32 v96, -v173, v112, v96
    v_fma_f32 v97, -v173, v113, v97
    v_fma_f32 v98, -v173, v114, v98
    v_fma_f32 v99, -v173, v115, v99
    s_waitcnt lgkmcnt(0)
    v_mul_f32 v172, 0x3fb8aa3b, v164
    v_mul_f32 v173, 0x3fb8aa3b, v165
    v_mul_f32 v174, 0x3fb8aa3b, v166
    v_mul_f32 v175, 0x3fb8aa3b, v167
    v_mov_b32 v140, 0x3f803f80
    v_mul_f32 v136, v76, v160
    v_mul_f32 v137, v77, v161
    v_mul_f32 v138, v78, v162
    v_mul_f32 v139, v79, v163
    v_mul_f32 v128, v76, v168
    v_mul_f32 v129, v77, v169
    v_mul_f32 v130, v78, v170
    v_mul_f32 v131, v79, v171
    v_max_f32 v76, 0, v76
    v_max_f32 v77, 0, v77
    v_max_f32 v78, 0, v78
    v_max_f32 v79, 0, v79
    v_exp_f32 v128, v128 clamp
    v_exp_f32 v129, v129 clamp
    v_exp_f32 v130, v130 clamp
    v_exp_f32 v131, v131 clamp
    v_fma_f32 v76, v76, v160, s31
    v_fma_f32 v77, v77, v161, s31
    v_fma_f32 v78, v78, v162, s31
    v_fma_f32 v79, v79, v163, s31
    v_add_f32 v76, v76, v128
    v_add_f32 v77, v77, v129
    v_add_f32 v78, v78, v130
    v_add_f32 v79, v79, v131
    v_cndmask_b32 v76, v76, v136, s[26:27]
    v_cndmask_b32 v77, v77, v137, s[26:27]
    v_cndmask_b32 v78, v78, v138, s[26:27]
    v_cndmask_b32 v79, v79, v139, s[26:27]
    v_cvt_pk_bf16_f32 v116, v76, v77
    v_cvt_pk_bf16_f32 v117, v78, v79
    v_mul_f32 v136, v80, v164
    v_mul_f32 v137, v81, v165
    v_mul_f32 v138, v82, v166
    v_mul_f32 v139, v83, v167
    v_mul_f32 v132, v80, v172
    v_mul_f32 v133, v81, v173
    v_mul_f32 v134, v82, v174
    v_mul_f32 v135, v83, v175
    v_max_f32 v80, 0, v80
    v_max_f32 v81, 0, v81
    v_max_f32 v82, 0, v82
    v_max_f32 v83, 0, v83
    v_exp_f32 v132, v132 clamp
    v_exp_f32 v133, v133 clamp
    v_exp_f32 v134, v134 clamp
    v_exp_f32 v135, v135 clamp
    v_fma_f32 v80, v80, v164, s31
    v_fma_f32 v81, v81, v165, s31
    v_fma_f32 v82, v82, v166, s31
    v_fma_f32 v83, v83, v167, s31
    v_add_f32 v80, v80, v132
    v_add_f32 v81, v81, v133
    v_add_f32 v82, v82, v134
    v_add_f32 v83, v83, v135
    v_cndmask_b32 v80, v80, v136, s[26:27]
    v_cndmask_b32 v81, v81, v137, s[26:27]
    v_cndmask_b32 v82, v82, v138, s[26:27]
    v_cndmask_b32 v83, v83, v139, s[26:27]
    v_cvt_pk_bf16_f32 v118, v80, v81
    v_cvt_pk_bf16_f32 v119, v82, v83
    v_cndmask_b32 v116, v116, v140, s[28:29]
    v_cndmask_b32 v117, v117, v140, s[28:29]
    v_cndmask_b32 v118, v118, v140, s[28:29]
    v_cndmask_b32 v119, v119, v140, s[28:29]
    ds_write_b128 v17, v[116:119] offset:35840
    s_nop 0
    v_mfma_f32_16x16x32_bf16 v[144:147], v[116:119], v[24:27], 0
    v_mfma_f32_16x16x32_bf16 v[148:151], v[116:119], v[22:25], 0
    v_mul_f32 v128, v44, v168
    v_mul_f32 v129, v45, v169
    v_mul_f32 v130, v46, v170
    v_mul_f32 v131, v47, v171
    v_max_f32 v44, 0, v44
    v_max_f32 v45, 0, v45
    v_max_f32 v46, 0, v46
    v_max_f32 v47, 0, v47
    v_exp_f32 v128, v128 clamp
    v_exp_f32 v129, v129 clamp
    v_exp_f32 v130, v130 clamp
    v_exp_f32 v131, v131 clamp
    v_fma_f32 v44, v44, v160, s31
    v_fma_f32 v45, v45, v161, s31
    v_fma_f32 v46, v46, v162, s31
    v_fma_f32 v47, v47, v163, s31
    v_add_f32 v44, v44, v128
    v_add_f32 v45, v45, v129
    v_add_f32 v46, v46, v130
    v_add_f32 v47, v47, v131
    v_cvt_pk_bf16_f32 v100, v44, v45
    v_cvt_pk_bf16_f32 v101, v46, v47
    v_mul_f32 v132, v48, v172
    v_mul_f32 v133, v49, v173
    v_mul_f32 v134, v50, v174
    v_mul_f32 v135, v51, v175
    v_max_f32 v48, 0, v48
    v_max_f32 v49, 0, v49
    v_max_f32 v50, 0, v50
    v_max_f32 v51, 0, v51
    v_exp_f32 v132, v132 clamp
    v_exp_f32 v133, v133 clamp
    v_exp_f32 v134, v134 clamp
    v_exp_f32 v135, v135 clamp
    v_fma_f32 v48, v48, v164, s31
    v_fma_f32 v49, v49, v165, s31
    v_fma_f32 v50, v50, v166, s31
    v_fma_f32 v51, v51, v167, s31
    v_add_f32 v48, v48, v132
    v_add_f32 v49, v49, v133
    v_add_f32 v50, v50, v134
    v_add_f32 v51, v51, v135
    v_cvt_pk_bf16_f32 v102, v48, v49
    v_cvt_pk_bf16_f32 v103, v50, v51
    ds_write_b128 v17, v[100:103] offset:31744
    v_mul_f32 v52, v52, v160
    v_mul_f32 v53, v53, v161
    v_mul_f32 v54, v54, v162
    v_mul_f32 v55, v55, v163
    v_cvt_pk_bf16_f32 v104, v52, v53
    v_cvt_pk_bf16_f32 v105, v54, v55
    v_mul_f32 v56, v56, v164
    v_mul_f32 v57, v57, v165
    v_mul_f32 v58, v58, v166
    v_mul_f32 v59, v59, v167
    v_cvt_pk_bf16_f32 v106, v56, v57
    v_cvt_pk_bf16_f32 v107, v58, v59
    ds_write_b128 v17, v[104:107] offset:32768
    v_mul_f32 v128, v60, v168
    v_mul_f32 v129, v61, v169
    v_mul_f32 v130, v62, v170
    v_mul_f32 v131, v63, v171
    v_max_f32 v60, 0, v60
    v_max_f32 v61, 0, v61
    v_max_f32 v62, 0, v62
    v_max_f32 v63, 0, v63
    v_exp_f32 v128, v128 clamp
    v_exp_f32 v129, v129 clamp
    v_exp_f32 v130, v130 clamp
    v_exp_f32 v131, v131 clamp
    v_fma_f32 v60, v60, v160, s31
    v_fma_f32 v61, v61, v161, s31
    v_fma_f32 v62, v62, v162, s31
    v_fma_f32 v63, v63, v163, s31
    v_add_f32 v60, v60, v128
    v_add_f32 v61, v61, v129
    v_add_f32 v62, v62, v130
    v_add_f32 v63, v63, v131
    v_cvt_pk_bf16_f32 v108, v60, v61
    v_cvt_pk_bf16_f32 v109, v62, v63
    v_mul_f32 v132, v64, v172
    v_mul_f32 v133, v65, v173
    v_mul_f32 v134, v66, v174
    v_mul_f32 v135, v67, v175
    v_max_f32 v64, 0, v64
    v_max_f32 v65, 0, v65
    v_max_f32 v66, 0, v66
    v_max_f32 v67, 0, v67
    v_exp_f32 v132, v132 clamp
    v_exp_f32 v133, v133 clamp
    v_exp_f32 v134, v134 clamp
    v_exp_f32 v135, v135 clamp
    v_fma_f32 v64, v64, v164, s31
    v_fma_f32 v65, v65, v165, s31
    v_fma_f32 v66, v66, v166, s31
    v_fma_f32 v67, v67, v167, s31
    v_add_f32 v64, v64, v132
    v_add_f32 v65, v65, v133
    v_add_f32 v66, v66, v134
    v_add_f32 v67, v67, v135
    v_cvt_pk_bf16_f32 v110, v64, v65
    v_cvt_pk_bf16_f32 v111, v66, v67
    ds_write_b128 v17, v[108:111] offset:33792
    v_mul_f32 v68, v68, v160
    v_mul_f32 v69, v69, v161
    v_mul_f32 v70, v70, v162
    v_mul_f32 v71, v71, v163
    v_cvt_pk_bf16_f32 v112, v68, v69
    v_cvt_pk_bf16_f32 v113, v70, v71
    v_mul_f32 v72, v72, v164
    v_mul_f32 v73, v73, v165
    v_mul_f32 v74, v74, v166
    v_mul_f32 v75, v75, v167
    v_cvt_pk_bf16_f32 v114, v72, v73
    v_cvt_pk_bf16_f32 v115, v74, v75
    ds_write_b128 v17, v[112:115] offset:34816
    v_mul_f32 v128, v84, v157
    v_mul_f32 v129, v85, v157
    v_mul_f32 v130, v86, v157
    v_mul_f32 v131, v87, v157
    v_max_f32 v84, 0, v84
    v_max_f32 v85, 0, v85
    v_max_f32 v86, 0, v86
    v_max_f32 v87, 0, v87
    v_exp_f32 v128, v128 clamp
    v_exp_f32 v129, v129 clamp
    v_exp_f32 v130, v130 clamp
    v_exp_f32 v131, v131 clamp
    v_fma_f32 v84, v84, v156, s31
    v_fma_f32 v85, v85, v156, s31
    v_fma_f32 v86, v86, v156, s31
    v_fma_f32 v87, v87, v156, s31
    v_add_f32 v84, v84, v128
    v_add_f32 v85, v85, v129
    v_add_f32 v86, v86, v130
    v_add_f32 v87, v87, v131
    v_cvt_pk_bf16_f32 v176, v84, v85
    v_cvt_pk_bf16_f32 v177, v86, v87
    v_cvt_pk_bf16_f32 v178, v144, v145
    v_cvt_pk_bf16_f32 v179, v146, v147
    buffer_store_dwordx4 v[176:179], v5, s[4:7], 0 offen offset:0 sc1
    s_waitcnt lgkmcnt(0)
    s_barrier
    ds_read_b128 a[0:3], v18 offset:31744
    ds_read_b128 a[4:7], v19 offset:31744
    ds_read_b128 a[8:11], v5 offset:35840
    ds_read_b128 a[12:15], v18 offset:36864
    ds_read_b128 a[16:19], v19 offset:36864
    ds_read_b128 a[20:23], v5 offset:40960
    ds_read_b128 a[24:27], v18 offset:41984
    ds_read_b128 a[28:31], v19 offset:41984
    ds_read_b128 a[32:35], v5 offset:46080
    ds_read_b128 a[36:39], v18 offset:47104
    ds_read_b128 a[40:43], v19 offset:47104
    ds_read_b128 a[44:47], v5 offset:51200
    v_mul_f32 v132, v88, v159
    v_mul_f32 v133, v89, v159
    v_mul_f32 v134, v90, v159
    v_mul_f32 v135, v91, v159
    v_max_f32 v88, 0, v88
    v_max_f32 v89, 0, v89
    v_max_f32 v90, 0, v90
    v_max_f32 v91, 0, v91
    v_exp_f32 v132, v132 clamp
    v_exp_f32 v133, v133 clamp
    v_exp_f32 v134, v134 clamp
    v_exp_f32 v135, v135 clamp
    v_fma_f32 v88, v88, v158, s31
    v_fma_f32 v89, v89, v158, s31
    v_fma_f32 v90, v90, v158, s31
    v_fma_f32 v91, v91, v158, s31
    v_add_f32 v88, v88, v132
    v_add_f32 v89, v89, v133
    v_add_f32 v90, v90, v134
    v_add_f32 v91, v91, v135
    v_cvt_pk_bf16_f32 v182, v88, v89
    v_cvt_pk_bf16_f32 v183, v90, v91
    v_cvt_pk_bf16_f32 v181, v148, v149
    v_cvt_pk_bf16_f32 v180, v150, v151
    buffer_store_dwordx4 v[180:183], v5, s[4:7], 0 offen offset:2048 sc1
    s_waitcnt lgkmcnt(10)
    v_mfma_f32_16x16x32_bf16 v[120:123], a[0:3], a[4:7], 0
    s_waitcnt lgkmcnt(9)
    v_mfma_f32_16x16x32_bf16 v[124:127], a[8:11], a[0:3], 0
    s_waitcnt lgkmcnt(7)
    v_mfma_f32_16x16x32_bf16 v[120:123], a[12:15], a[16:19], v[120:123]
    s_waitcnt lgkmcnt(6)
    v_mfma_f32_16x16x32_bf16 v[124:127], a[20:23], a[12:15], v[124:127]
    s_waitcnt lgkmcnt(4)
    v_mfma_f32_16x16x32_bf16 v[120:123], a[24:27], a[28:31], v[120:123]
    s_waitcnt lgkmcnt(3)
    v_mfma_f32_16x16x32_bf16 v[124:127], a[32:35], a[24:27], v[124:127]
    s_waitcnt lgkmcnt(1)
    v_mfma_f32_16x16x32_bf16 v[120:123], a[36:39], a[40:43], v[120:123]
    s_waitcnt lgkmcnt(0)
    v_mfma_f32_16x16x32_bf16 v[124:127], a[44:47], a[36:39], v[124:127]
    v_mul_f32 v128, v92, v157
    v_mul_f32 v129, v93, v157
    v_mul_f32 v130, v94, v157
    v_mul_f32 v131, v95, v157
    v_max_f32 v92, 0, v92
    v_max_f32 v93, 0, v93
    v_max_f32 v94, 0, v94
    v_max_f32 v95, 0, v95
    v_exp_f32 v128, v128 clamp
    v_exp_f32 v129, v129 clamp
    v_exp_f32 v130, v130 clamp
    v_exp_f32 v131, v131 clamp
    v_fma_f32 v92, v92, v156, s31
    v_fma_f32 v93, v93, v156, s31
    v_fma_f32 v94, v94, v156, s31
    v_fma_f32 v95, v95, v156, s31
    v_add_f32 v92, v92, v128
    v_add_f32 v93, v93, v129
    v_add_f32 v94, v94, v130
    v_add_f32 v95, v95, v131
    v_cvt_pk_bf16_f32 v92, v92, v93
    v_cvt_pk_bf16_f32 v93, v94, v95
    buffer_atomic_add_f32 v120, v13, s[48:51], 0 offen sc1
    buffer_atomic_add_f32 v121, v13, s[48:51], 0 offen offset:256 sc1
    buffer_atomic_add_f32 v122, v13, s[48:51], 0 offen offset:512 sc1
    v_cndmask_b32 v136, v120, v122, s[58:59]
    v_cndmask_b32 v137, v121, v123, s[58:59]
    v_cndmask_b32 v138, v124, v126, s[58:59]
    v_cndmask_b32 v139, v125, v127, s[58:59]
    v_permlane16_swap_b32 v136, v137
    s_nop 0
    v_permlane16_swap_b32 v138, v139
    v_cndmask_b32 v136, v136, v123, s[56:57]
    v_cndmask_b32 v138, v138, v139, s[56:57]
    buffer_atomic_add_f32 v136, v15, s[48:51], 0 offen sc1
    buffer_atomic_add_f32 v138, v16, s[48:51], 0 offen sc1
    v_mul_f32 v132, v96, v159
    v_mul_f32 v133, v97, v159
    v_mul_f32 v134, v98, v159
    v_mul_f32 v135, v99, v159
    v_max_f32 v96, 0, v96
    v_max_f32 v97, 0, v97
    v_max_f32 v98, 0, v98
    v_max_f32 v99, 0, v99
    v_exp_f32 v132, v132 clamp
    v_exp_f32 v133, v133 clamp
    v_exp_f32 v134, v134 clamp
    v_exp_f32 v135, v135 clamp
    v_fma_f32 v96, v96, v158, s31
    v_fma_f32 v97, v97, v158, s31
    v_fma_f32 v98, v98, v158, s31
    v_fma_f32 v99, v99, v158, s31
    v_add_f32 v96, v96, v132
    v_add_f32 v97, v97, v133
    v_add_f32 v98, v98, v134
    v_add_f32 v99, v99, v135
    v_cvt_pk_bf16_f32 v94, v96, v97
    v_cvt_pk_bf16_f32 v95, v98, v99
    buffer_store_dwordx4 v[92:95], v5, s[4:7], 0 offen offset:1024 sc1
    s_mov_b32 s3, 0
.L_mlp_l0:
    s_load_dwordx2 s[60:61], s[94:95], 0
    s_load_dwordx2 s[58:59], s[94:95], 48
    s_load_dwordx4 s[48:51], s[94:95], 56
    s_setprio 0
    v_lshrrev_b32 v4, 6, v0
    v_and_b32 v1, 63, v0
    v_readfirstlane_b32 s19, v4
    v_lshrrev_b32 v2, 4, v1
    v_and_b32 v3, 15, v1
    s_and_b32 s21, s2, 4
    s_bfe_u32 s23, s2, 0x20003
    s_add_u32 s21, s21, s23
    s_and_b32 s22, s2, 3
    s_lshl_b32 s22, s22, 3
    s_lshr_b32 s23, s2, 5
    s_add_u32 s22, s22, s23
    s_and_b32 s20, s19, 3
    s_lshl_b32 s23, s22, 2
    s_add_u32 s14, s23, s20
    s_mul_i32 s25, s19, 5632
    s_mul_i32 s26, s3, 0x1220000
    s_add_u32 s25, s25, s26
    v_lshlrev_b32 v5, 4, v1
    v_mov_b32 v16, 0x80000000
    v_cmp_gt_u32 vcc, 32, v1
    s_lshl_b32 s27, s22, 4
    s_add_u32 s27, s27, s19
    v_cndmask_b32 v16, v16, v5, vcc
    s_mul_i32 s27, s27, 6144
    s_mul_i32 s28, s21, 86016
    s_lshl_b32 s30, s19, 11
    s_lshl_b32 s31, s19, 13
    s_add_u32 s31, s31, 86016
    s_mov_b32 s26, 4096
    s_add_u32 s4, s12, 0x14e0000
    s_addc_u32 s5, s13, 0
    s_add_u32 s4, s4, s25
    s_addc_u32 s5, s5, 0
    s_mov_b32 s6, 0x1600
    s_mov_b32 s7, 0x20000
    v_and_b32 v4, 3, v3
    v_lshrrev_b32 v17, 2, v3
    v_lshl_add_u32 v6, v4, 8, s31
    v_lshl_add_u32 v6, v17, 6, v6
    v_lshl_add_u32 v6, v2, 4, v6
    v_lshl_add_u32 v7, v3, 3, s31
    v_cmp_eq_u32 s[52:53], 3, v2
    v_min_u32 v24, 2, v4
    v_lshl_add_u32 v14, v24, 6, s31
    v_lshl_add_u32 v14, v2, 4, v14
    v_add_u32 v14, 1152, v14
    v_lshl_add_u32 v15, v24, 3, s31
    v_add_u32 v15, 1344, v15
    v_cmp_gt_u32 s[54:55], 2, v4
    v_cmp_eq_u32 vcc, 0, v17
    s_add_u32 s33, s31, 5632
    s_and_b64 s[56:57], vcc, s[54:55]
    v_cmp_eq_u32 vcc, 2, v4
    v_mov_b32 v18, s33
    s_or_b64 vcc, vcc, s[56:57]
    v_cndmask_b32 v8, v18, v14, vcc
    s_and_b64 vcc, vcc, s[52:53]
    v_cndmask_b32 v20, v18, v15, vcc
    v_cmp_eq_u32 vcc, 1, v17
    s_add_u32 s33, s31, 4224
    s_and_b64 s[56:57], vcc, s[54:55]
    v_cmp_eq_u32 vcc, 3, v4
    v_mov_b32 v18, s33
    s_or_b64 vcc, vcc, s[56:57]
    v_cndmask_b32 v9, v18, v14, vcc
    s_and_b64 vcc, vcc, s[52:53]
    v_cndmask_b32 v21, v18, v15, vcc
    v_cmp_eq_u32 vcc, 2, v17
    s_add_u32 s33, s31, 2816
    s_and_b64 s[56:57], vcc, s[54:55]
    v_cmp_eq_u32 vcc, 2, v4
    v_mov_b32 v18, s33
    s_or_b64 vcc, vcc, s[56:57]
    v_cndmask_b32 v10, v18, v14, vcc
    s_and_b64 vcc, vcc, s[52:53]
    v_cndmask_b32 v22, v18, v15, vcc
    v_cmp_eq_u32 vcc, 3, v17
    s_add_u32 s33, s31, 1408
    s_and_b64 s[56:57], vcc, s[54:55]
    v_cmp_eq_u32 vcc, 3, v4
    v_mov_b32 v18, s33
    s_or_b64 vcc, vcc, s[56:57]
    v_cndmask_b32 v11, v18, v14, vcc
    s_and_b64 vcc, vcc, s[52:53]
    v_cndmask_b32 v23, v18, v15, vcc
    v_add_u32 v17, s31, v5
    s_lshl_b32 s40, s21, 11
    v_lshl_add_u32 v13, v1, 4, s40
    s_lshl_b32 s40, s21, 8
    s_add_u32 s40, s40, 16384
    v_lshlrev_b32 v4, 4, v3
    v_lshl_add_u32 v4, v2, 3, v4
    v_add_u32 v4, s40, v4
    v_mov_b32 v14, 0x80000000
    v_cmp_gt_u32 vcc, 2, v2
    s_nop 1
    v_cndmask_b32 v14, v14, v4, vcc
    s_lshr_b32 s40, s21, 1
    s_lshl_b32 s40, s40, 8
    s_and_b32 s41, s21, 1
    s_lshl_b32 s41, s41, 3
    s_add_u32 s40, s40, s41
    v_lshl_add_u32 v4, v3, 4, s40
    v_mov_b32 v15, 0x80000000
    v_cmp_eq_u32 vcc, 0, v2
    s_nop 1
    v_cndmask_b32 v15, v15, v4, vcc
    s_lshl_b32 s40, s21, 2
    v_mov_b32 v4, s40
    v_mov_b32 v38, 0x80000000
    v_cmp_eq_u32 vcc, 0, v1
    v_mov_b32 v39, 1
    s_lshr_b32 s25, s19, 2
    v_cndmask_b32 v38, v38, v4, vcc
    s_lshl_b32 s25, s25, 10
    s_lshl_b32 s33, s20, 2
    s_add_u32 s25, s25, s33
    s_add_u32 s25, s25, 151552
    v_add_u32 v18, s25, v5
    s_lshl_b32 s25, s20, 11
    s_add_u32 s25, s25, 86016
    v_add_u32 v19, s25, v5
    v_add_u32 v26, 0x10000, v19
    v_add_u32 v24, 0x10000, v5
    v_and_b32 v4, 7, v3
    v_lshl_add_u32 v4, v2, 3, v4
    v_lshlrev_b32 v4, 4, v4
    v_add_u32 v25, 73728, v4
    v_and_b32 v4, 1, v2
    v_cmp_eq_u32 s[54:55], 1, v4
    v_mov_b32 v40, 0
    v_mov_b32 v41, 0
    v_mov_b32 v42, 0x358637bd
    v_mov_b32 v43, 0x358637bd
    v_mov_b32 v112, 0
    v_mov_b32 v117, 0
    v_mov_b32 v72, 0
    v_mov_b32 v118, 0
    v_mov_b32 v123, 0
    v_mov_b32 v73, 0
    v_mov_b32 v124, 0
    v_mov_b32 v129, 0
    v_mov_b32 v84, 0
    v_mov_b32 v130, 0
    v_mov_b32 v135, 0
    v_mov_b32 v85, 0
    v_mov_b32 v136, 0
    v_mov_b32 v141, 0
    v_mov_b32 v96, 0
    v_mov_b32 v142, 0
    v_mov_b32 v147, 0
    v_mov_b32 v97, 0
    v_mov_b32 v148, 0
    v_mov_b32 v153, 0
    v_mov_b32 v108, 0
    v_mov_b32 v154, 0
    v_mov_b32 v159, 0
    v_mov_b32 v109, 0
    s_add_u32 s8, s12, 0x11e0000
    s_addc_u32 s9, s13, 0
    s_add_u32 s8, s8, s27
    s_addc_u32 s9, s9, 0
    s_mov_b32 s10, 0xd800
    s_mov_b32 s11, 0x20000
    v_mov_b32 v44, 0x80000000
    s_lshl_b32 s25, s22, 3
    s_add_u32 s25, s25, s19
    s_lshl_b32 s25, s25, 7
    s_lshl_b32 s24, s3, 15
    s_add_u32 s40, s12, 0x2728000
    s_addc_u32 s41, s13, 0
    s_add_u32 s40, s40, s24
    s_addc_u32 s41, s41, 0
    s_mov_b32 s42, 0x8000
    s_mov_b32 s43, 0x20000
    s_xor_b32 s32, s3, 1
    s_mul_i32 s32, s32, 18
    s_add_u32 s34, s40, s25
    s_addc_u32 s35, s41, 0
    v_lshl_add_u32 v27, v0, 10, s18
    v_cmp_gt_u32 vcc, 32, v0
    v_mov_b32 v4, 1
    s_nop 0
    v_cndmask_b32 v27, v44, v27, vcc
    s_cmp_lt_u32 s19, 4
    s_cbranch_scc1 .L_mlp_e13
    v_mov_b32 v12, v44
    s_barrier
.L_mlp_e13:
    s_waitcnt vmcnt(0)
    s_barrier
    buffer_atomic_add v4, v27, s[40:43], 0 offen sc1
    v_mov_b32 v27, s25
    v_cmp_eq_u32 vcc, 0, v1
    s_nop 1
    v_cndmask_b32 v27, v44, v27, vcc
    s_cmp_eq_u32 s3, 1
    s_cbranch_scc1 .L_mlp_cwk3
    s_mov_b32 s33, 0x1000
.L_mlp_cw3:
    s_load_dword s24, s[34:35], 4 glc
    s_sub_u32 s33, s33, 1
    s_cbranch_scc1 .L_mlp_cws3
    s_waitcnt lgkmcnt(0)
    s_cmp_eq_u32 s24, s32
    s_cbranch_scc1 .L_mlp_cwk3
    s_sleep 2
    s_branch .L_mlp_cw3
.L_mlp_cws3:
    s_waitcnt lgkmcnt(0)
    s_mov_b32 s33, 0x40000
.L_mlp_cwv3:
    buffer_load_dword v12, v27, s[40:43], 0 offen offset:4 sc1
    s_waitcnt vmcnt(0)
    v_cmp_eq_u32 vcc, s32, v12
    s_sub_u32 s33, s33, 1
    s_cbranch_scc1 .L_mlp_cwk3
    s_cmp_lg_u32 vcc_lo, 1
    s_cbranch_scc1 .L_mlp_cwv3
.L_mlp_cwk3:
    s_add_u32 s36, s12, 0xc70000
    s_addc_u32 s37, s13, 0
    s_add_u32 s36, s36, s28
    s_addc_u32 s37, s37, 0
    s_mov_b32 s38, 0x14400
    s_mov_b32 s39, 0x20000
    s_add_u32 m0, s30, 65536
    s_nop 0
    buffer_load_dwordx4 v5, s[36:39], m0 offen offset:0 lds
    buffer_load_dwordx4 v5, s[36:39], m0 offen offset:1024 lds
    s_mov_b32 m0, 81920
    s_cmp_eq_u32 s19, 7
    s_cselect_b64 exec, -1, 0
    buffer_load_dwordx4 v5, s[36:39], m0 offen offset:0 lds
    s_mov_b64 exec, -1
    s_add_u32 m0, s30, 0
    s_nop 0
    buffer_load_dwordx4 v5, s[36:39], m0 offen offset:0 lds
    buffer_load_dwordx4 v5, s[36:39], m0 offen offset:1024 lds
    s_add_u32 m0, s30, 16384
    s_nop 0
    buffer_load_dwordx4 v5, s[36:39], m0 offen offset:0 lds
    buffer_load_dwordx4 v5, s[36:39], m0 offen offset:1024 lds
    s_add_u32 m0, s30, 32768
    s_nop 0
    buffer_load_dwordx4 v5, s[36:39], m0 offen offset:0 lds
    buffer_load_dwordx4 v5, s[36:39], m0 offen offset:1024 lds
    s_add_u32 m0, s30, 49152
    s_nop 0
    buffer_load_dwordx4 v5, s[36:39], m0 offen offset:0 lds
    buffer_load_dwordx4 v5, s[36:39], m0 offen offset:1024 lds
    s_mov_b32 s33, 0x1000
.L_mlp_cp3:
    s_load_dword s24, s[34:35], 0 glc
    s_sub_u32 s33, s33, 1
    s_cbranch_scc1 .L_mlp_cps3
    s_waitcnt lgkmcnt(0)
    s_cmp_eq_u32 s24, 32
    s_cbranch_scc1 .L_mlp_cpk3
    s_sleep 2
    s_branch .L_mlp_cp3
.L_mlp_cps3:
    s_waitcnt lgkmcnt(0)
    s_mov_b32 s33, 0x40000
.L_mlp_cpv3:
    buffer_load_dword v12, v27, s[40:43], 0 offen offset:0 sc1
    s_waitcnt vmcnt(0)
    v_cmp_eq_u32 vcc, 32, v12
    s_sub_u32 s33, s33, 1
    s_cbranch_scc1 .L_mlp_cpk3
    s_cmp_lg_u32 vcc_lo, 1
    s_cbranch_scc1 .L_mlp_cpv3
.L_mlp_cpk3:
    s_add_u32 m0, s31, 4096
    s_nop 0
    buffer_load_dwordx4 v16, s[4:7], s26 offen offset:1024 sc1 lds
    s_mov_b32 m0, s31
    s_nop 0
    buffer_load_dwordx4 v5, s[4:7], 0 offen offset:0 sc1 lds
    buffer_load_dwordx4 v5, s[4:7], 0 offen offset:1024 sc1 lds
    buffer_load_dwordx4 v5, s[4:7], 0 offen offset:2048 sc1 lds
    buffer_load_dwordx4 v5, s[4:7], 0 offen offset:3072 sc1 lds
    s_add_u32 m0, s31, 4096
    s_nop 0
    buffer_load_dwordx4 v5, s[4:7], s26 offen offset:0 sc1 lds
    buffer_load_dwordx4 a[0:3], v5, s[8:11], 0 offen offset:0 sc1
    buffer_load_dwordx4 a[4:7], v5, s[8:11], 0 offen offset:1024 sc1
    buffer_load_dwordx4 a[8:11], v5, s[8:11], 0 offen offset:2048 sc1
    s_mov_b32 s29, 49152
    buffer_load_dwordx4 a[12:15], v5, s[8:11], s29 offen offset:0 sc1
    buffer_load_dwordx4 a[16:19], v5, s[8:11], s29 offen offset:1024 sc1
    buffer_load_dwordx4 a[20:23], v5, s[8:11], s29 offen offset:2048 sc1
    s_mov_b32 s29, 3072
    buffer_load_dwordx4 a[24:27], v5, s[8:11], s29 offen offset:0 sc1
    buffer_load_dwordx4 a[28:31], v5, s[8:11], s29 offen offset:1024 sc1
    buffer_load_dwordx4 a[32:35], v5, s[8:11], s29 offen offset:2048 sc1
    s_mov_b32 s29, 52224
    buffer_load_dwordx4 a[36:39], v5, s[8:11], s29 offen offset:0 sc1
    buffer_load_dwordx4 a[40:43], v5, s[8:11], s29 offen offset:1024 sc1
    buffer_load_dwordx4 a[44:47], v5, s[8:11], s29 offen offset:2048 sc1
    s_waitcnt vmcnt(14)
    ds_read_b128 v[64:67], v6 offset:0
    ds_read_b128 v[68:71], v8 offset:0
    ds_read_b64 v[74:75], v20 offset:0
    ds_read_b128 v[76:79], v6 offset:1408
    ds_read_b128 v[80:83], v9 offset:1408
    ds_read_b64 v[86:87], v21 offset:1408
    s_mov_b64 exec, s[52:53]
    ds_read_b64 v[72:73], v7 offset:1024
    ds_read_b64 v[84:85], v7 offset:2432
    s_mov_b64 exec, -1
    s_waitcnt vmcnt(12)
    ds_read_b128 v[88:91], v6 offset:2816
    ds_read_b128 v[92:95], v10 offset:2816
    ds_read_b64 v[98:99], v22 offset:2816
    ds_read_b128 v[100:103], v6 offset:4224
    ds_read_b128 v[104:107], v11 offset:4224
    ds_read_b64 v[110:111], v23 offset:4224
    s_mov_b64 exec, s[52:53]
    ds_read_b64 v[96:97], v7 offset:3840
    ds_read_b64 v[108:109], v7 offset:5248
    s_mov_b64 exec, -1
    s_waitcnt lgkmcnt(15)
    v_cvt_pk_bf16_f32 v114, v64, v65
    v_cvt_pk_bf16_f32 v115, v66, v67
    s_waitcnt lgkmcnt(9)
    v_cvt_pk_bf16_f32 v113, v72, v73
    v_cvt_pk_bf16_f32 v116, v72, v73
    v_cvt_pk_bf16_f32 v120, v68, v69
    v_cvt_pk_bf16_f32 v121, v70, v71
    v_cvt_pk_bf16_f32 v119, v74, v75
    v_cvt_pk_bf16_f32 v122, v74, v75
    v_cvt_pk_bf16_f32 v126, v76, v77
    v_cvt_pk_bf16_f32 v127, v78, v79
    s_waitcnt lgkmcnt(8)
    v_cvt_pk_bf16_f32 v125, v84, v85
    v_cvt_pk_bf16_f32 v128, v84, v85
    v_cvt_pk_bf16_f32 v132, v80, v81
    v_cvt_pk_bf16_f32 v133, v82, v83
    v_cvt_pk_bf16_f32 v131, v86, v87
    v_cvt_pk_bf16_f32 v134, v86, v87
    s_waitcnt vmcnt(11)
    v_mfma_f32_16x16x32_bf16 v[168:171], v[120:123], a[0:3], v[40:43]
    s_mul_i32 s25, s14, 18432
    s_add_u32 s44, s12, 0xf60000
    s_addc_u32 s45, s13, 0
    s_add_u32 s44, s44, s25
    s_addc_u32 s45, s45, 0
    s_mov_b32 s46, 0x4800
    s_mov_b32 s47, 0x20000
    s_add_u32 s4, s12, 0xd20000
    s_addc_u32 s5, s13, 0
    s_mul_i32 s34, s21, 144
    v_mul_u32_u24 v6, 1152, v3
    v_add_u32 v6, s34, v6
    v_lshl_add_u32 v7, v2, 3, v6
    v_add_u32 v7, 128, v7
    v_lshl_add_u32 v6, v2, 4, v6
    v_cmp_gt_u32 s[56:57], 2, v2
    s_nop 1
    v_cndmask_b32 v7, v14, v7, s[56:57]
    s_cmp_eq_u32 s3, 0
    s_cselect_b32 s4, s60, s4
    s_cselect_b32 s5, s61, s5
    s_cselect_b32 s34, 64, 1024
    s_cselect_b64 s[56:57], -1, 0
    v_cndmask_b32 v6, v13, v6, s[56:57]
    v_cndmask_b32 v7, v14, v7, s[56:57]
    s_add_u32 s4, s4, s25
    s_addc_u32 s5, s5, 0
    s_mov_b32 s6, 0x4800
    s_mov_b32 s7, 0x20000
    s_cmp_lt_u32 s19, 4
    s_cselect_b64 exec, -1, 0
    buffer_load_dwordx4 v[28:31], v6, s[4:7], 0 offen sc1
    buffer_load_dwordx4 v[32:35], v6, s[4:7], s34 offen sc1
    buffer_load_dwordx2 v[36:37], v7, s[4:7], 0 offen sc1
    s_mov_b64 exec, -1
    v_mfma_f32_16x16x32_bf16 v[160:163], v[114:117], a[0:3], 0
    s_waitcnt vmcnt(13)
    v_mfma_f32_16x16x32_bf16 v[168:171], v[130:133], a[2:5], v[168:171]
    v_mfma_f32_16x16x32_bf16 v[164:167], v[124:127], a[2:5], 0
    s_waitcnt vmcnt(12)
    v_mfma_f32_16x16x32_bf16 v[180:183], v[118:121], a[8:11], v[40:43]
    s_nop 4
    v_rcp_f32 v56, v170
    v_rcp_f32 v57, v171
    v_mul_f32 v160, v160, v56
    v_mul_f32 v161, v161, v56
    v_mul_f32 v162, v162, v56
    v_mfma_f32_16x16x32_bf16 v[172:175], v[112:115], a[8:11], 0
    v_mul_f32 v163, v163, v56
    v_cndmask_b32 v58, v56, v57, s[54:55]
    v_mul_f32 v164, v164, v57
    v_mul_f32 v165, v165, v57
    v_mul_f32 v166, v166, v57
    v_mfma_f32_16x16x32_bf16 v[180:183], v[132:135], a[6:9], v[180:183]
    v_mul_f32 v167, v167, v57
    v_mul_f32 v168, v168, v58
    v_mul_f32 v169, v169, v58
    v_cvt_pk_bf16_f32 v44, v160, v161
    v_cvt_pk_bf16_f32 v45, v162, v163
    v_mfma_f32_16x16x32_bf16 v[176:179], v[126:129], a[6:9], 0
    v_cvt_pk_bf16_f32 v46, v164, v165
    v_cvt_pk_bf16_f32 v47, v166, v167
    v_cvt_pk_bf16_f32 v52, v168, v169
    ds_write_b128 v17, v[44:47] offset:0
    s_waitcnt vmcnt(11)
    v_mfma_f32_16x16x32_bf16 v[168:171], v[120:123], a[12:15], v[40:43]
    v_rcp_f32 v60, v182
    v_rcp_f32 v61, v183
    v_mul_f32 v172, v172, v60
    v_mul_f32 v173, v173, v60
    v_mul_f32 v174, v174, v60
    v_mul_f32 v175, v175, v60
    v_cndmask_b32 v62, v60, v61, s[54:55]
    v_mul_f32 v176, v176, v61
    v_mul_f32 v177, v177, v61
    v_mfma_f32_16x16x32_bf16 v[160:163], v[114:117], a[12:15], 0
    v_mul_f32 v178, v178, v61
    v_mul_f32 v179, v179, v61
    v_mul_f32 v180, v180, v62
    v_mul_f32 v181, v181, v62
    v_cvt_pk_bf16_f32 v48, v172, v173
    v_cvt_pk_bf16_f32 v49, v174, v175
    v_cvt_pk_bf16_f32 v50, v176, v177
    v_cvt_pk_bf16_f32 v51, v178, v179
    v_cvt_pk_bf16_f32 v53, v180, v181
    s_waitcnt vmcnt(10)
    v_mfma_f32_16x16x32_bf16 v[168:171], v[130:133], a[14:17], v[168:171]
    ds_write_b128 v17, v[48:51] offset:2048
    s_waitcnt lgkmcnt(9)
    v_cvt_pk_bf16_f32 v138, v88, v89
    v_cvt_pk_bf16_f32 v139, v90, v91
    s_waitcnt lgkmcnt(3)
    v_cvt_pk_bf16_f32 v137, v96, v97
    v_cvt_pk_bf16_f32 v140, v96, v97
    v_cvt_pk_bf16_f32 v144, v92, v93
    v_cvt_pk_bf16_f32 v145, v94, v95
    v_cvt_pk_bf16_f32 v143, v98, v99
    v_cvt_pk_bf16_f32 v146, v98, v99
    v_mfma_f32_16x16x32_bf16 v[164:167], v[124:127], a[14:17], 0
    v_cvt_pk_bf16_f32 v150, v100, v101
    v_cvt_pk_bf16_f32 v151, v102, v103
    s_waitcnt lgkmcnt(2)
    v_cvt_pk_bf16_f32 v149, v108, v109
    v_cvt_pk_bf16_f32 v152, v108, v109
    v_cvt_pk_bf16_f32 v156, v104, v105
    v_cvt_pk_bf16_f32 v157, v106, v107
    v_cvt_pk_bf16_f32 v155, v110, v111
    v_cvt_pk_bf16_f32 v158, v110, v111
    s_waitcnt vmcnt(9)
    v_mfma_f32_16x16x32_bf16 v[180:183], v[118:121], a[20:23], v[40:43]
    v_rcp_f32 v56, v170
    v_rcp_f32 v57, v171
    v_mul_f32 v160, v160, v56
    v_mul_f32 v161, v161, v56
    v_mul_f32 v162, v162, v56
    v_mfma_f32_16x16x32_bf16 v[172:175], v[112:115], a[20:23], 0
    v_mul_f32 v163, v163, v56
    v_cndmask_b32 v58, v56, v57, s[54:55]
    v_mul_f32 v164, v164, v57
    v_mul_f32 v165, v165, v57
    v_mul_f32 v166, v166, v57
    v_mfma_f32_16x16x32_bf16 v[180:183], v[132:135], a[18:21], v[180:183]
    v_mul_f32 v167, v167, v57
    v_mul_f32 v168, v168, v58
    v_mul_f32 v169, v169, v58
    v_cvt_pk_bf16_f32 v44, v160, v161
    v_cvt_pk_bf16_f32 v45, v162, v163
    v_mfma_f32_16x16x32_bf16 v[176:179], v[126:129], a[18:21], 0
    v_cvt_pk_bf16_f32 v46, v164, v165
    v_cvt_pk_bf16_f32 v47, v166, v167
    v_cvt_pk_bf16_f32 v54, v168, v169
    ds_write_b128 v17, v[44:47] offset:4096
    s_waitcnt vmcnt(8)
    v_mfma_f32_16x16x32_bf16 v[168:171], v[144:147], a[24:27], v[40:43]
    v_rcp_f32 v60, v182
    v_rcp_f32 v61, v183
    v_mul_f32 v172, v172, v60
    v_mul_f32 v173, v173, v60
    v_mul_f32 v174, v174, v60
    v_mfma_f32_16x16x32_bf16 v[160:163], v[138:141], a[24:27], 0
    v_mul_f32 v175, v175, v60
    v_cndmask_b32 v62, v60, v61, s[54:55]
    v_mul_f32 v176, v176, v61
    v_mul_f32 v177, v177, v61
    v_mul_f32 v178, v178, v61
    s_waitcnt vmcnt(7)
    v_mfma_f32_16x16x32_bf16 v[168:171], v[154:157], a[26:29], v[168:171]
    v_mul_f32 v179, v179, v61
    v_mul_f32 v180, v180, v62
    v_mul_f32 v181, v181, v62
    v_cvt_pk_bf16_f32 v48, v172, v173
    v_cvt_pk_bf16_f32 v49, v174, v175
    v_mfma_f32_16x16x32_bf16 v[164:167], v[148:151], a[26:29], 0
    v_cvt_pk_bf16_f32 v50, v176, v177
    v_cvt_pk_bf16_f32 v51, v178, v179
    v_cvt_pk_bf16_f32 v55, v180, v181
    ds_write_b128 v17, v[48:51] offset:6144
    s_waitcnt vmcnt(6)
    v_mfma_f32_16x16x32_bf16 v[180:183], v[142:145], a[32:35], v[40:43]
    v_rcp_f32 v56, v170
    v_rcp_f32 v57, v171
    v_mul_f32 v160, v160, v56
    v_mul_f32 v161, v161, v56
    v_mul_f32 v162, v162, v56
    v_mul_f32 v163, v163, v56
    v_mfma_f32_16x16x32_bf16 v[172:175], v[136:139], a[32:35], 0
    v_cndmask_b32 v58, v56, v57, s[54:55]
    v_mul_f32 v164, v164, v57
    v_mul_f32 v165, v165, v57
    v_mul_f32 v166, v166, v57
    v_mul_f32 v167, v167, v57
    v_mul_f32 v168, v168, v58
    v_mfma_f32_16x16x32_bf16 v[180:183], v[156:159], a[30:33], v[180:183]
    v_mul_f32 v169, v169, v58
    v_cvt_pk_bf16_f32 v44, v160, v161
    v_cvt_pk_bf16_f32 v45, v162, v163
    v_cvt_pk_bf16_f32 v46, v164, v165
    v_cvt_pk_bf16_f32 v47, v166, v167
    v_cvt_pk_bf16_f32 v59, v168, v169
    v_mfma_f32_16x16x32_bf16 v[176:179], v[150:153], a[30:33], 0
    v_or_b32 v52, v52, v59
    ds_write_b128 v17, v[44:47] offset:1024
    ds_write_b32 v18, v52 offset:0
    s_waitcnt vmcnt(5)
    v_mfma_f32_16x16x32_bf16 v[168:171], v[144:147], a[36:39], v[40:43]
    s_lshl_b32 s24, s2, 2
    s_add_u32 s24, s24, s20
    s_mul_i32 s24, s24, 9216
    s_cmp_lt_u32 s2, 144
    s_cselect_b32 s24, s24, 0
    s_cselect_b32 s33, 9216, 0
    s_cmp_eq_u32 s3, 0
    s_cselect_b32 s33, s33, 0
    s_cmp_ge_u32 s19, 4
    s_cselect_b32 s98, s33, 0
    s_add_u32 s96, s58, s24
    s_addc_u32 s97, s59, 0
    v_mfma_f32_16x16x32_bf16 v[160:163], v[138:141], a[36:39], 0
    s_mov_b32 s99, 0x20000
    s_mov_b32 s24, 4096
    s_mov_b32 s33, 8192
    buffer_load_dwordx4 v[64:67], v5, s[96:99], 0 offen offset:0
    buffer_load_dwordx4 v[68:71], v5, s[96:99], 0 offen offset:1024
    buffer_load_dwordx4 v[72:75], v5, s[96:99], 0 offen offset:2048
    buffer_load_dwordx4 v[76:79], v5, s[96:99], 0 offen offset:3072
    buffer_load_dwordx4 v[80:83], v5, s[96:99], s24 offen offset:0
    buffer_load_dwordx4 v[84:87], v5, s[96:99], s24 offen offset:1024
    buffer_load_dwordx4 v[88:91], v5, s[96:99], s24 offen offset:2048
    buffer_load_dwordx4 v[92:95], v5, s[96:99], s24 offen offset:3072
    buffer_load_dwordx4 v[96:99], v5, s[96:99], s33 offen offset:0
    s_waitcnt vmcnt(13)
    v_mfma_f32_16x16x32_bf16 v[168:171], v[154:157], a[38:41], v[168:171]
    v_rcp_f32 v60, v182
    v_rcp_f32 v61, v183
    v_mul_f32 v172, v172, v60
    v_mul_f32 v173, v173, v60
    v_mul_f32 v174, v174, v60
    v_mul_f32 v175, v175, v60
    v_cndmask_b32 v62, v60, v61, s[54:55]
    v_mul_f32 v176, v176, v61
    v_mul_f32 v177, v177, v61
    v_mul_f32 v178, v178, v61
    v_mul_f32 v179, v179, v61
    v_mul_f32 v180, v180, v62
    v_mfma_f32_16x16x32_bf16 v[164:167], v[148:151], a[38:41], 0
    v_mul_f32 v181, v181, v62
    v_cvt_pk_bf16_f32 v48, v172, v173
    v_cvt_pk_bf16_f32 v49, v174, v175
    v_cvt_pk_bf16_f32 v50, v176, v177
    v_cvt_pk_bf16_f32 v51, v178, v179
    v_cvt_pk_bf16_f32 v63, v180, v181
    v_or_b32 v53, v53, v63
    ds_write_b128 v17, v[48:51] offset:3072
    ds_write_b32 v18, v53 offset:2048
    s_waitcnt vmcnt(12)
    v_mfma_f32_16x16x32_bf16 v[180:183], v[142:145], a[44:47], v[40:43]
    v_rcp_f32 v56, v170
    v_rcp_f32 v57, v171
    v_mul_f32 v160, v160, v56
    v_mul_f32 v161, v161, v56
    v_mul_f32 v162, v162, v56
    v_mul_f32 v163, v163, v56
    v_mfma_f32_16x16x32_bf16 v[172:175], v[136:139], a[44:47], 0
    v_cndmask_b32 v58, v56, v57, s[54:55]
    v_mul_f32 v164, v164, v57
    v_mul_f32 v165, v165, v57
    v_mul_f32 v166, v166, v57
    v_mul_f32 v167, v167, v57
    v_mul_f32 v168, v168, v58
    v_mfma_f32_16x16x32_bf16 v[180:183], v[156:159], a[42:45], v[180:183]
    v_mul_f32 v169, v169, v58
    v_cvt_pk_bf16_f32 v44, v160, v161
    v_cvt_pk_bf16_f32 v45, v162, v163
    v_cvt_pk_bf16_f32 v46, v164, v165
    v_cvt_pk_bf16_f32 v47, v166, v167
    v_cvt_pk_bf16_f32 v59, v168, v169
    v_mfma_f32_16x16x32_bf16 v[176:179], v[150:153], a[42:45], 0
    v_or_b32 v54, v54, v59
    ds_write_b128 v17, v[44:47] offset:5120
    ds_write_b32 v18, v54 offset:4096
    v_rcp_f32 v60, v182
    v_rcp_f32 v61, v183
    v_mul_f32 v172, v172, v60
    v_mul_f32 v173, v173, v60
    v_mul_f32 v174, v174, v60
    v_mul_f32 v175, v175, v60
    v_cndmask_b32 v62, v60, v61, s[54:55]
    v_mul_f32 v176, v176, v61
    v_mul_f32 v177, v177, v61
    v_mul_f32 v178, v178, v61
    v_mul_f32 v179, v179, v61
    v_mul_f32 v180, v180, v62
    v_mul_f32 v181, v181, v62
    v_cvt_pk_bf16_f32 v48, v172, v173
    v_cvt_pk_bf16_f32 v49, v174, v175
    v_cvt_pk_bf16_f32 v50, v176, v177
    v_cvt_pk_bf16_f32 v51, v178, v179
    v_cvt_pk_bf16_f32 v63, v180, v181
    v_or_b32 v55, v55, v63
    ds_write_b128 v17, v[48:51] offset:7168
    ds_write_b32 v18, v55 offset:6144
.L_mlp_join:
    s_cmp_ge_u32 s19, 4
    s_cbranch_scc1 .L_mlp_B
    s_waitcnt lgkmcnt(0)
    s_barrier
    s_waitcnt vmcnt(3)
    ds_read_b128 v[84:87], v19 offset:0
    ds_read_b128 v[64:67], v5 offset:0
    ds_read_b128 v[68:71], v5 offset:1024
    ds_read_b128 v[72:75], v5 offset:2048
    ds_read_b128 v[76:79], v5 offset:3072
    ds_read_b128 v[80:83], v25 offset:0
    ds_read_b128 v[108:111], v19 offset:1024
    s_waitcnt lgkmcnt(5)
    v_mfma_f32_16x16x32_bf16 v[44:47], v[64:67], v[84:87], 0
    s_waitcnt vmcnt(2)
    ds_read_b128 v[88:91], v5 offset:4096
    s_and_b32 s21, s2, 6
    s_bfe_u32 s23, s2, 0x10003
    s_waitcnt lgkmcnt(5)
    v_mfma_f32_16x16x32_bf16 v[48:51], v[68:71], v[84:87], 0
    s_waitcnt vmcnt(1)
    ds_read_b128 v[92:95], v5 offset:5120
    s_add_u32 s21, s21, s23
    s_and_b32 s22, s2, 1
    s_waitcnt lgkmcnt(5)
    v_mfma_f32_16x16x32_bf16 v[52:55], v[72:75], v[84:87], 0
    s_waitcnt vmcnt(0)
    ds_read_b128 v[96:99], v5 offset:6144
    s_lshl_b32 s22, s22, 4
    s_lshr_b32 s23, s2, 4
    s_waitcnt lgkmcnt(5)
    v_mfma_f32_16x16x32_bf16 v[56:59], v[76:79], v[84:87], 0
    ds_read_b128 v[100:103], v5 offset:7168
    s_add_u32 s22, s22, s23
    s_lshl_b32 s23, s22, 2
    s_waitcnt lgkmcnt(5)
    v_mfma_f32_16x16x32_bf16 v[60:63], v[80:83], v[84:87], 0
    ds_read_b128 v[104:107], v25 offset:512
    s_lshl_b32 s27, s21, 3
    s_add_u32 s27, s27, s19
    ds_read_b128 v[84:87], v19 offset:8192
    s_waitcnt lgkmcnt(5)
    v_mfma_f32_16x16x32_bf16 v[44:47], v[88:91], v[108:111], v[44:47]
    ds_read_b128 v[64:67], v5 offset:8192
    s_mul_i32 s27, s27, 165888
    s_add_u32 s40, s12, s27
    s_addc_u32 s41, s13, 0
    s_waitcnt lgkmcnt(5)
    v_mfma_f32_16x16x32_bf16 v[48:51], v[92:95], v[108:111], v[48:51]
    ds_read_b128 v[68:71], v5 offset:9216
    s_mov_b32 s42, 0x28800
    s_waitcnt lgkmcnt(5)
    v_mfma_f32_16x16x32_bf16 v[52:55], v[96:99], v[108:111], v[52:55]
    ds_read_b128 v[72:75], v5 offset:10240
    s_mov_b32 s43, 0x20000
    v_mov_b32 v8, 0x80000000
    s_waitcnt lgkmcnt(5)
    v_mfma_f32_16x16x32_bf16 v[56:59], v[100:103], v[108:111], v[56:59]
    ds_read_b128 v[76:79], v5 offset:11264
    v_cmp_gt_u32 vcc, 32, v1
    s_nop 1
    v_cndmask_b32 v6, v8, v5, vcc
    s_waitcnt lgkmcnt(5)
    v_mfma_f32_16x16x32_bf16 v[60:63], v[104:107], v[108:111], v[60:63]
    ds_read_b128 v[80:83], v25 offset:1024
    s_mul_i32 s29, s21, 18432
    s_add_u32 s36, s12, 0xa20000
    s_addc_u32 s37, s13, 0
    ds_read_b128 v[108:111], v19 offset:9216
    s_waitcnt lgkmcnt(5)
    v_mfma_f32_16x16x32_bf16 v[44:47], v[64:67], v[84:87], v[44:47]
    ds_read_b128 v[88:91], v5 offset:12288
    s_add_u32 s36, s36, s29
    s_addc_u32 s37, s37, 0
    s_waitcnt lgkmcnt(5)
    v_mfma_f32_16x16x32_bf16 v[48:51], v[68:71], v[84:87], v[48:51]
    ds_read_b128 v[92:95], v5 offset:13312
    s_mov_b32 s38, 0x4800
    s_waitcnt lgkmcnt(5)
    v_mfma_f32_16x16x32_bf16 v[52:55], v[72:75], v[84:87], v[52:55]
    ds_read_b128 v[96:99], v5 offset:14336
    s_mov_b32 s39, 0x20000
    s_lshl_b32 s29, s20, 11
    s_waitcnt lgkmcnt(5)
    v_mfma_f32_16x16x32_bf16 v[56:59], v[76:79], v[84:87], v[56:59]
    ds_read_b128 v[100:103], v5 offset:15360
    s_add_u32 s33, s29, 10240
    s_lshl_b32 s35, s20, 9
    s_waitcnt lgkmcnt(5)
    v_mfma_f32_16x16x32_bf16 v[60:63], v[80:83], v[84:87], v[60:63]
    ds_read_b128 v[104:107], v25 offset:1536
    s_add_u32 s35, s35, 8192
    v_add_u32 v7, 38912, v5
    ds_read_b128 v[84:87], v19 offset:16384
    s_waitcnt lgkmcnt(5)
    v_mfma_f32_16x16x32_bf16 v[44:47], v[88:91], v[108:111], v[44:47]
    ds_read_b128 v[64:67], v5 offset:16384
    v_add_u32 v8, 77824, v5
    v_add_u32 v9, 114688, v5
    s_waitcnt lgkmcnt(5)
    v_mfma_f32_16x16x32_bf16 v[48:51], v[92:95], v[108:111], v[48:51]
    ds_read_b128 v[68:71], v5 offset:17408
    s_lshl_b32 s32, s20, 13
    s_add_u32 s32, s32, 0
    s_waitcnt lgkmcnt(5)
    v_mfma_f32_16x16x32_bf16 v[52:55], v[96:99], v[108:111], v[52:55]
    ds_read_b128 v[72:75], v5 offset:18432
    v_add_u32 v10, s32, v8
    s_lshr_b32 s32, s20, 1
    s_waitcnt lgkmcnt(5)
    v_mfma_f32_16x16x32_bf16 v[56:59], v[100:103], v[108:111], v[56:59]
    ds_read_b128 v[76:79], v5 offset:19456
    s_lshl_b32 s32, s32, 12
    s_and_b32 s34, s20, 1
    s_waitcnt lgkmcnt(5)
    v_mfma_f32_16x16x32_bf16 v[60:63], v[104:107], v[108:111], v[60:63]
    ds_read_b128 v[80:83], v25 offset:2048
    s_lshl_b32 s34, s34, 3
    s_add_u32 s32, s32, s34
    ds_read_b128 v[108:111], v19 offset:17408
    s_waitcnt lgkmcnt(5)
    v_mfma_f32_16x16x32_bf16 v[44:47], v[64:67], v[84:87], v[44:47]
    ds_read_b128 v[88:91], v5 offset:20480
    s_add_u32 s32, s32, 110592
    v_add_u32 v11, s32, v5
    s_waitcnt lgkmcnt(5)
    v_mfma_f32_16x16x32_bf16 v[48:51], v[68:71], v[84:87], v[48:51]
    ds_read_b128 v[92:95], v5 offset:21504
    s_add_u32 s56, s12, 0x2717000
    s_addc_u32 s57, s13, 0
    s_waitcnt lgkmcnt(5)
    v_mfma_f32_16x16x32_bf16 v[52:55], v[72:75], v[84:87], v[52:55]
    ds_read_b128 v[96:99], v5 offset:22528
    s_mov_b32 s58, 0x400
    s_mov_b32 s59, 0x20000
    s_waitcnt lgkmcnt(5)
    v_mfma_f32_16x16x32_bf16 v[56:59], v[76:79], v[84:87], v[56:59]
    ds_read_b128 v[100:103], v5 offset:23552
    s_lshl_b32 s34, s21, 7
    s_waitcnt lgkmcnt(5)
    v_mfma_f32_16x16x32_bf16 v[60:63], v[80:83], v[84:87], v[60:63]
    ds_read_b128 v[104:107], v25 offset:2560
    ds_read_b128 v[84:87], v19 offset:24576
    s_waitcnt lgkmcnt(5)
    v_mfma_f32_16x16x32_bf16 v[44:47], v[88:91], v[108:111], v[44:47]
    ds_read_b128 v[64:67], v5 offset:24576
    s_waitcnt lgkmcnt(5)
    v_mfma_f32_16x16x32_bf16 v[48:51], v[92:95], v[108:111], v[48:51]
    ds_read_b128 v[68:71], v5 offset:25600
    s_waitcnt lgkmcnt(5)
    v_mfma_f32_16x16x32_bf16 v[52:55], v[96:99], v[108:111], v[52:55]
    ds_read_b128 v[72:75], v5 offset:26624
    s_waitcnt lgkmcnt(5)
    v_mfma_f32_16x16x32_bf16 v[56:59], v[100:103], v[108:111], v[56:59]
    ds_read_b128 v[76:79], v5 offset:27648
    s_waitcnt lgkmcnt(5)
    v_mfma_f32_16x16x32_bf16 v[60:63], v[104:107], v[108:111], v[60:63]
    ds_read_b128 v[80:83], v25 offset:3072
    ds_read_b128 v[108:111], v19 offset:25600
    s_waitcnt lgkmcnt(5)
    v_mfma_f32_16x16x32_bf16 v[44:47], v[64:67], v[84:87], v[44:47]
    ds_read_b128 v[88:91], v5 offset:28672
    s_waitcnt lgkmcnt(5)
    v_mfma_f32_16x16x32_bf16 v[48:51], v[68:71], v[84:87], v[48:51]
    ds_read_b128 v[92:95], v5 offset:29696
    s_waitcnt lgkmcnt(5)
    v_mfma_f32_16x16x32_bf16 v[52:55], v[72:75], v[84:87], v[52:55]
    ds_read_b128 v[96:99], v5 offset:30720
    s_waitcnt lgkmcnt(5)
    v_mfma_f32_16x16x32_bf16 v[56:59], v[76:79], v[84:87], v[56:59]
    ds_read_b128 v[100:103], v5 offset:31744
    s_waitcnt lgkmcnt(5)
    v_mfma_f32_16x16x32_bf16 v[60:63], v[80:83], v[84:87], v[60:63]
    ds_read_b128 v[104:107], v25 offset:3584
    ds_read_b128 v[84:87], v19 offset:32768
    s_waitcnt lgkmcnt(5)
    v_mfma_f32_16x16x32_bf16 v[44:47], v[88:91], v[108:111], v[44:47]
    ds_read_b128 v[64:67], v5 offset:32768
    s_waitcnt lgkmcnt(5)
    v_mfma_f32_16x16x32_bf16 v[48:51], v[92:95], v[108:111], v[48:51]
    ds_read_b128 v[68:71], v5 offset:33792
    s_waitcnt lgkmcnt(5)
    v_mfma_f32_16x16x32_bf16 v[52:55], v[96:99], v[108:111], v[52:55]
    ds_read_b128 v[72:75], v5 offset:34816
    s_waitcnt lgkmcnt(5)
    v_mfma_f32_16x16x32_bf16 v[56:59], v[100:103], v[108:111], v[56:59]
    ds_read_b128 v[76:79], v5 offset:35840
    s_waitcnt lgkmcnt(5)
    v_mfma_f32_16x16x32_bf16 v[60:63], v[104:107], v[108:111], v[60:63]
    ds_read_b128 v[80:83], v25 offset:4096
    ds_read_b128 v[108:111], v19 offset:33792
    s_waitcnt lgkmcnt(5)
    v_mfma_f32_16x16x32_bf16 v[44:47], v[64:67], v[84:87], v[44:47]
    ds_read_b128 v[88:91], v5 offset:36864
    s_waitcnt lgkmcnt(5)
    v_mfma_f32_16x16x32_bf16 v[48:51], v[68:71], v[84:87], v[48:51]
    ds_read_b128 v[92:95], v5 offset:37888
    s_waitcnt lgkmcnt(5)
    v_mfma_f32_16x16x32_bf16 v[52:55], v[72:75], v[84:87], v[52:55]
    ds_read_b128 v[96:99], v5 offset:38912
    s_waitcnt lgkmcnt(5)
    v_mfma_f32_16x16x32_bf16 v[56:59], v[76:79], v[84:87], v[56:59]
    ds_read_b128 v[100:103], v5 offset:39936
    s_waitcnt lgkmcnt(5)
    v_mfma_f32_16x16x32_bf16 v[60:63], v[80:83], v[84:87], v[60:63]
    ds_read_b128 v[104:107], v25 offset:4608
    ds_read_b128 v[84:87], v19 offset:40960
    s_waitcnt lgkmcnt(5)
    v_mfma_f32_16x16x32_bf16 v[44:47], v[88:91], v[108:111], v[44:47]
    ds_read_b128 v[64:67], v5 offset:40960
    s_waitcnt lgkmcnt(5)
    v_mfma_f32_16x16x32_bf16 v[48:51], v[92:95], v[108:111], v[48:51]
    ds_read_b128 v[68:71], v5 offset:41984
    s_waitcnt lgkmcnt(5)
    v_mfma_f32_16x16x32_bf16 v[52:55], v[96:99], v[108:111], v[52:55]
    ds_read_b128 v[72:75], v5 offset:43008
    s_waitcnt lgkmcnt(5)
    v_mfma_f32_16x16x32_bf16 v[56:59], v[100:103], v[108:111], v[56:59]
    ds_read_b128 v[76:79], v5 offset:44032
    s_waitcnt lgkmcnt(5)
    v_mfma_f32_16x16x32_bf16 v[60:63], v[104:107], v[108:111], v[60:63]
    ds_read_b128 v[80:83], v25 offset:5120
    ds_read_b128 v[108:111], v19 offset:41984
    s_waitcnt lgkmcnt(5)
    v_mfma_f32_16x16x32_bf16 v[44:47], v[64:67], v[84:87], v[44:47]
    ds_read_b128 v[88:91], v5 offset:45056
    s_waitcnt lgkmcnt(5)
    v_mfma_f32_16x16x32_bf16 v[48:51], v[68:71], v[84:87], v[48:51]
    ds_read_b128 v[92:95], v5 offset:46080
    s_waitcnt lgkmcnt(5)
    v_mfma_f32_16x16x32_bf16 v[52:55], v[72:75], v[84:87], v[52:55]
    ds_read_b128 v[96:99], v5 offset:47104
    s_waitcnt lgkmcnt(5)
    v_mfma_f32_16x16x32_bf16 v[56:59], v[76:79], v[84:87], v[56:59]
    ds_read_b128 v[100:103], v5 offset:48128
    s_waitcnt lgkmcnt(5)
    v_mfma_f32_16x16x32_bf16 v[60:63], v[80:83], v[84:87], v[60:63]
    ds_read_b128 v[104:107], v25 offset:5632
    ds_read_b128 v[84:87], v19 offset:49152
    s_waitcnt lgkmcnt(5)
    v_mfma_f32_16x16x32_bf16 v[44:47], v[88:91], v[108:111], v[44:47]
    ds_read_b128 v[64:67], v5 offset:49152
    s_waitcnt lgkmcnt(5)
    v_mfma_f32_16x16x32_bf16 v[48:51], v[92:95], v[108:111], v[48:51]
    ds_read_b128 v[68:71], v5 offset:50176
    s_waitcnt lgkmcnt(5)
    v_mfma_f32_16x16x32_bf16 v[52:55], v[96:99], v[108:111], v[52:55]
    ds_read_b128 v[72:75], v5 offset:51200
    s_waitcnt lgkmcnt(5)
    v_mfma_f32_16x16x32_bf16 v[56:59], v[100:103], v[108:111], v[56:59]
    ds_read_b128 v[76:79], v5 offset:52224
    s_waitcnt lgkmcnt(5)
    v_mfma_f32_16x16x32_bf16 v[60:63], v[104:107], v[108:111], v[60:63]
    ds_read_b128 v[80:83], v25 offset:6144
    ds_read_b128 v[108:111], v19 offset:50176
    s_waitcnt lgkmcnt(5)
    v_mfma_f32_16x16x32_bf16 v[44:47], v[64:67], v[84:87], v[44:47]
    ds_read_b128 v[88:91], v5 offset:53248
    s_waitcnt lgkmcnt(5)
    v_mfma_f32_16x16x32_bf16 v[48:51], v[68:71], v[84:87], v[48:51]
    ds_read_b128 v[92:95], v5 offset:54272
    s_waitcnt lgkmcnt(5)
    v_mfma_f32_16x16x32_bf16 v[52:55], v[72:75], v[84:87], v[52:55]
    ds_read_b128 v[96:99], v5 offset:55296
    s_waitcnt lgkmcnt(5)
    v_mfma_f32_16x16x32_bf16 v[56:59], v[76:79], v[84:87], v[56:59]
    ds_read_b128 v[100:103], v5 offset:56320
    s_waitcnt lgkmcnt(5)
    v_mfma_f32_16x16x32_bf16 v[60:63], v[80:83], v[84:87], v[60:63]
    ds_read_b128 v[104:107], v25 offset:6656
    ds_read_b128 v[84:87], v19 offset:57344
    s_waitcnt lgkmcnt(5)
    v_mfma_f32_16x16x32_bf16 v[44:47], v[88:91], v[108:111], v[44:47]
    ds_read_b128 v[64:67], v5 offset:57344
    s_waitcnt lgkmcnt(5)
    v_mfma_f32_16x16x32_bf16 v[48:51], v[92:95], v[108:111], v[48:51]
    ds_read_b128 v[68:71], v5 offset:58368
    s_waitcnt lgkmcnt(5)
    v_mfma_f32_16x16x32_bf16 v[52:55], v[96:99], v[108:111], v[52:55]
    ds_read_b128 v[72:75], v5 offset:59392
    s_waitcnt lgkmcnt(5)
    v_mfma_f32_16x16x32_bf16 v[56:59], v[100:103], v[108:111], v[56:59]
    ds_read_b128 v[76:79], v5 offset:60416
    s_waitcnt lgkmcnt(5)
    v_mfma_f32_16x16x32_bf16 v[60:63], v[104:107], v[108:111], v[60:63]
    ds_read_b128 v[80:83], v25 offset:7168
    ds_read_b128 v[108:111], v19 offset:58368
    s_waitcnt lgkmcnt(5)
    v_mfma_f32_16x16x32_bf16 v[44:47], v[64:67], v[84:87], v[44:47]
    ds_read_b128 v[88:91], v5 offset:61440
    s_waitcnt lgkmcnt(5)
    v_mfma_f32_16x16x32_bf16 v[48:51], v[68:71], v[84:87], v[48:51]
    ds_read_b128 v[92:95], v5 offset:62464
    s_waitcnt lgkmcnt(5)
    v_mfma_f32_16x16x32_bf16 v[52:55], v[72:75], v[84:87], v[52:55]
    ds_read_b128 v[96:99], v5 offset:63488
    s_waitcnt lgkmcnt(5)
    v_mfma_f32_16x16x32_bf16 v[56:59], v[76:79], v[84:87], v[56:59]
    ds_read_b128 v[100:103], v5 offset:64512
    s_waitcnt lgkmcnt(5)
    v_mfma_f32_16x16x32_bf16 v[60:63], v[80:83], v[84:87], v[60:63]
    ds_read_b128 v[104:107], v25 offset:7680
    ds_read_b128 v[84:87], v26 offset:0
    s_waitcnt lgkmcnt(5)
    v_mfma_f32_16x16x32_bf16 v[44:47], v[88:91], v[108:111], v[44:47]
    ds_read_b128 v[64:67], v24 offset:0
    s_waitcnt lgkmcnt(5)
    v_mfma_f32_16x16x32_bf16 v[48:51], v[92:95], v[108:111], v[48:51]
    ds_read_b128 v[68:71], v24 offset:1024
    s_waitcnt lgkmcnt(5)
    v_mfma_f32_16x16x32_bf16 v[52:55], v[96:99], v[108:111], v[52:55]
    ds_read_b128 v[72:75], v24 offset:2048
    s_waitcnt lgkmcnt(5)
    v_mfma_f32_16x16x32_bf16 v[56:59], v[100:103], v[108:111], v[56:59]
    ds_read_b128 v[76:79], v24 offset:3072
    s_waitcnt lgkmcnt(5)
    v_mfma_f32_16x16x32_bf16 v[60:63], v[104:107], v[108:111], v[60:63]
    ds_read_b128 v[80:83], v25 offset:8192
    ds_read_b128 v[108:111], v26 offset:1024
    s_waitcnt lgkmcnt(5)
    v_mfma_f32_16x16x32_bf16 v[44:47], v[64:67], v[84:87], v[44:47]
    ds_read_b128 v[88:91], v24 offset:4096
    s_waitcnt lgkmcnt(5)
    v_mfma_f32_16x16x32_bf16 v[48:51], v[68:71], v[84:87], v[48:51]
    ds_read_b128 v[92:95], v24 offset:5120
    s_waitcnt lgkmcnt(5)
    v_mfma_f32_16x16x32_bf16 v[52:55], v[72:75], v[84:87], v[52:55]
    ds_read_b128 v[96:99], v24 offset:6144
    s_waitcnt lgkmcnt(5)
    v_mfma_f32_16x16x32_bf16 v[56:59], v[76:79], v[84:87], v[56:59]
    ds_read_b128 v[100:103], v24 offset:7168
    s_waitcnt lgkmcnt(5)
    v_mfma_f32_16x16x32_bf16 v[60:63], v[80:83], v[84:87], v[60:63]
    ds_read_b128 v[104:107], v25 offset:8704
    s_waitcnt lgkmcnt(4)
    v_mfma_f32_16x16x32_bf16 v[44:47], v[88:91], v[108:111], v[44:47]
    s_waitcnt lgkmcnt(3)
    v_mfma_f32_16x16x32_bf16 v[48:51], v[92:95], v[108:111], v[48:51]
    s_waitcnt lgkmcnt(2)
    v_mfma_f32_16x16x32_bf16 v[52:55], v[96:99], v[108:111], v[52:55]
    s_waitcnt lgkmcnt(1)
    v_mfma_f32_16x16x32_bf16 v[56:59], v[100:103], v[108:111], v[56:59]
    s_waitcnt lgkmcnt(0)
    v_mfma_f32_16x16x32_bf16 v[60:63], v[104:107], v[108:111], v[60:63]
    s_lshl_b32 s25, s14, 10
    s_add_u32 s4, s12, 0x11c0000
    s_addc_u32 s5, s13, 0
    s_add_u32 s4, s4, s25
    s_addc_u32 s5, s5, 0
    s_mov_b32 s6, 0x400
    s_mov_b32 s7, 0x20000
    s_mov_b32 s16, 0xffff0000
    v_lshlrev_b32 v112, 16, v28
    v_and_b32 v113, s16, v28
    v_lshlrev_b32 v114, 16, v29
    v_and_b32 v115, s16, v29
    v_lshlrev_b32 v116, 16, v30
    v_and_b32 v117, s16, v30
    v_lshlrev_b32 v118, 16, v31
    v_and_b32 v119, s16, v31
    v_lshlrev_b32 v120, 16, v32
    v_and_b32 v121, s16, v32
    v_lshlrev_b32 v122, 16, v33
    v_and_b32 v123, s16, v33
    v_lshlrev_b32 v124, 16, v34
    v_and_b32 v125, s16, v34
    v_lshlrev_b32 v126, 16, v35
    v_and_b32 v127, s16, v35
    v_lshlrev_b32 v128, 16, v36
    v_and_b32 v129, s16, v36
    v_lshlrev_b32 v130, 16, v37
    v_and_b32 v131, s16, v37
    v_cmp_gt_u32 vcc, 2, v2
    s_nop 1
    v_cndmask_b32 v60, v40, v60, vcc
    v_cndmask_b32 v61, v40, v61, vcc
    v_cndmask_b32 v62, v40, v62, vcc
    v_cndmask_b32 v63, v40, v63, vcc
    v_add_f32 v112, v112, v44
    v_add_f32 v113, v113, v45
    v_add_f32 v114, v114, v46
    v_add_f32 v115, v115, v47
    v_add_f32 v116, v116, v48
    v_add_f32 v117, v117, v49
    v_add_f32 v118, v118, v50
    v_add_f32 v119, v119, v51
    v_add_f32 v120, v120, v52
    v_add_f32 v121, v121, v53
    v_add_f32 v122, v122, v54
    v_add_f32 v123, v123, v55
    v_add_f32 v124, v124, v56
    v_add_f32 v125, v125, v57
    v_add_f32 v126, v126, v58
    v_add_f32 v127, v127, v59
    v_add_f32 v128, v128, v60
    v_add_f32 v129, v129, v61
    v_add_f32 v130, v130, v62
    v_add_f32 v131, v131, v63
    v_cvt_pk_bf16_f32 v28, v112, v113
    v_cvt_pk_bf16_f32 v29, v114, v115
    v_cvt_pk_bf16_f32 v30, v116, v117
    v_cvt_pk_bf16_f32 v31, v118, v119
    v_cvt_pk_bf16_f32 v32, v120, v121
    v_cvt_pk_bf16_f32 v33, v122, v123
    v_cvt_pk_bf16_f32 v34, v124, v125
    v_cvt_pk_bf16_f32 v35, v126, v127
    v_cvt_pk_bf16_f32 v36, v128, v129
    v_cvt_pk_bf16_f32 v37, v130, v131
    buffer_store_dwordx4 v[28:31], v13, s[44:47], 0 offen sc1
    buffer_store_dwordx4 v[32:35], v13, s[44:47], 0 offen offset:1024 sc1
    buffer_store_dwordx2 v[36:37], v14, s[44:47], 0 offen sc1
    v_add_f32 v168, v112, v113
    v_mul_f32 v169, v112, v112
    v_mul_f32 v170, v113, v113
    v_add_f32 v168, v168, v114
    v_fmac_f32 v170, v114, v114
    v_add_f32 v168, v168, v115
    v_fmac_f32 v169, v115, v115
    v_add_f32 v168, v168, v116
    v_fmac_f32 v170, v116, v116
    v_add_f32 v168, v168, v117
    v_fmac_f32 v169, v117, v117
    v_add_f32 v168, v168, v118
    v_fmac_f32 v170, v118, v118
    v_add_f32 v168, v168, v119
    v_fmac_f32 v169, v119, v119
    v_add_f32 v168, v168, v120
    v_fmac_f32 v170, v120, v120
    v_add_f32 v168, v168, v121
    v_fmac_f32 v169, v121, v121
    v_add_f32 v168, v168, v122
    v_fmac_f32 v170, v122, v122
    v_add_f32 v168, v168, v123
    v_fmac_f32 v169, v123, v123
    v_add_f32 v168, v168, v124
    v_fmac_f32 v170, v124, v124
    v_add_f32 v168, v168, v125
    v_fmac_f32 v169, v125, v125
    v_add_f32 v168, v168, v126
    v_fmac_f32 v170, v126, v126
    v_add_f32 v168, v168, v127
    v_fmac_f32 v169, v127, v127
    v_add_f32 v168, v168, v128
    v_fmac_f32 v170, v128, v128
    v_add_f32 v168, v168, v129
    v_fmac_f32 v169, v129, v129
    v_add_f32 v168, v168, v130
    v_fmac_f32 v170, v130, v130
    v_add_f32 v168, v168, v131
    v_fmac_f32 v169, v131, v131
    v_add_f32 v169, v169, v170
    v_mov_b32 v170, v168
    s_nop 1
    v_permlane32_swap_b32 v168, v170
    v_add_f32 v168, v168, v170
    v_mov_b32 v170, v168
    s_nop 1
    v_permlane16_swap_b32 v168, v170
    v_add_f32 v168, v168, v170
    v_mov_b32 v171, v169
    s_nop 1
    v_permlane32_swap_b32 v169, v171
    v_add_f32 v169, v169, v171
    v_mov_b32 v171, v169
    s_nop 1
    v_permlane16_swap_b32 v169, v171
    v_add_f32 v169, v169, v171
    buffer_store_dwordx2 v[168:169], v15, s[4:7], 0 offen sc1
    s_lshl_b32 s25, s3, 7
    s_add_u32 s25, s25, s14
    s_lshl_b32 s25, s25, 7
    s_add_u32 s4, s12, 0x270f000
    s_addc_u32 s5, s13, 0
    s_add_u32 s4, s4, s25
    s_addc_u32 s5, s5, 0
    s_mov_b32 s6, 0x20
    s_mov_b32 s7, 0x20000
    s_waitcnt vmcnt(0)
    buffer_store_dword v39, v38, s[4:7], 0 offen sc1
    s_barrier
    buffer_load_dwordx4 a[0:3], v5, s[40:43], 0 offen offset:0
    buffer_load_dwordx4 a[4:7], v5, s[40:43], 0 offen offset:1024
    buffer_load_dwordx4 a[8:11], v5, s[40:43], 0 offen offset:2048
    buffer_load_dwordx4 a[12:15], v5, s[40:43], 0 offen offset:3072
    s_mov_b32 s28, 4096
    buffer_load_dwordx4 a[16:19], v5, s[40:43], s28 offen offset:0
    buffer_load_dwordx4 a[20:23], v5, s[40:43], s28 offen offset:1024
    buffer_load_dwordx4 a[24:27], v5, s[40:43], s28 offen offset:2048
    buffer_load_dwordx4 a[28:31], v5, s[40:43], s28 offen offset:3072
    s_mov_b32 s28, 8192
    buffer_load_dwordx4 a[32:35], v5, s[40:43], s28 offen offset:0
    buffer_load_dwordx4 a[36:39], v5, s[40:43], s28 offen offset:1024
    buffer_load_dwordx4 a[40:43], v5, s[40:43], s28 offen offset:2048
    buffer_load_dwordx4 a[44:47], v5, s[40:43], s28 offen offset:3072
    s_mov_b32 s28, 12288
    buffer_load_dwordx4 a[48:51], v5, s[40:43], s28 offen offset:0
    buffer_load_dwordx4 a[52:55], v5, s[40:43], s28 offen offset:1024
    buffer_load_dwordx4 a[56:59], v5, s[40:43], s28 offen offset:2048
    buffer_load_dwordx4 a[60:63], v5, s[40:43], s28 offen offset:3072
    s_mov_b32 s28, 16384
    buffer_load_dwordx4 a[64:67], v5, s[40:43], s28 offen offset:0
    buffer_load_dwordx4 a[68:71], v5, s[40:43], s28 offen offset:1024
    s_waitcnt lgkmcnt(0)
    s_barrier
    ds_read_b128 v[144:147], v5 offset:0
    ds_read_b128 v[148:151], v5 offset:19456
    ds_read_b128 v[152:155], v7 offset:0
    ds_read_b128 v[156:159], v7 offset:19456
    s_setprio 3
    s_waitcnt vmcnt(17) lgkmcnt(3)
    v_mfma_f32_16x16x32_bf16 v[32:35], a[0:3], v[144:147], 0
    ds_read_b128 v[160:163], v5 offset:1024
    s_waitcnt lgkmcnt(3)
    v_mfma_f32_16x16x32_bf16 v[36:39], a[0:3], v[148:151], 0
    s_waitcnt lgkmcnt(2)
    v_mfma_f32_16x16x32_bf16 v[40:43], a[0:3], v[152:155], 0
    ds_read_b128 v[164:167], v5 offset:20480
    s_waitcnt lgkmcnt(2)
    v_mfma_f32_16x16x32_bf16 v[44:47], a[0:3], v[156:159], 0
    s_waitcnt vmcnt(16)
    v_mfma_f32_16x16x32_bf16 v[48:51], a[4:7], v[144:147], 0
    ds_read_b128 v[168:171], v7 offset:1024
    v_mfma_f32_16x16x32_bf16 v[52:55], a[4:7], v[148:151], 0
    v_mfma_f32_16x16x32_bf16 v[56:59], a[4:7], v[152:155], 0
    ds_read_b128 v[172:175], v7 offset:20480
    v_mfma_f32_16x16x32_bf16 v[60:63], a[4:7], v[156:159], 0
    buffer_load_dwordx4 a[0:3], v5, s[40:43], s28 offen offset:2048
    s_waitcnt vmcnt(16)
    v_mfma_f32_16x16x32_bf16 v[64:67], a[8:11], v[144:147], 0
    v_mfma_f32_16x16x32_bf16 v[68:71], a[8:11], v[148:151], 0
    v_mfma_f32_16x16x32_bf16 v[72:75], a[8:11], v[152:155], 0
    v_mfma_f32_16x16x32_bf16 v[76:79], a[8:11], v[156:159], 0
    buffer_load_dwordx4 a[4:7], v5, s[40:43], s28 offen offset:3072
    s_setprio 1
    s_waitcnt vmcnt(16) lgkmcnt(3)
    v_mfma_f32_16x16x32_bf16 v[32:35], a[12:15], v[160:163], v[32:35]
    ds_read_b128 v[144:147], v5 offset:2048
    s_waitcnt lgkmcnt(3)
    v_mfma_f32_16x16x32_bf16 v[36:39], a[12:15], v[164:167], v[36:39]
    s_waitcnt lgkmcnt(2)
    v_mfma_f32_16x16x32_bf16 v[40:43], a[12:15], v[168:171], v[40:43]
    ds_read_b128 v[148:151], v5 offset:21504
    s_waitcnt lgkmcnt(2)
    v_mfma_f32_16x16x32_bf16 v[44:47], a[12:15], v[172:175], v[44:47]
    s_mov_b32 s28, 20480
    buffer_load_dwordx4 a[8:11], v5, s[40:43], s28 offen offset:0
    s_waitcnt vmcnt(16)
    v_mfma_f32_16x16x32_bf16 v[48:51], a[16:19], v[160:163], v[48:51]
    ds_read_b128 v[152:155], v7 offset:2048
    v_mfma_f32_16x16x32_bf16 v[52:55], a[16:19], v[164:167], v[52:55]
    v_mfma_f32_16x16x32_bf16 v[56:59], a[16:19], v[168:171], v[56:59]
    ds_read_b128 v[156:159], v7 offset:21504
    v_mfma_f32_16x16x32_bf16 v[60:63], a[16:19], v[172:175], v[60:63]
    buffer_load_dwordx4 a[12:15], v5, s[40:43], s28 offen offset:1024
    s_waitcnt vmcnt(16)
    v_mfma_f32_16x16x32_bf16 v[64:67], a[20:23], v[160:163], v[64:67]
    v_mfma_f32_16x16x32_bf16 v[68:71], a[20:23], v[164:167], v[68:71]
    v_mfma_f32_16x16x32_bf16 v[72:75], a[20:23], v[168:171], v[72:75]
    v_mfma_f32_16x16x32_bf16 v[76:79], a[20:23], v[172:175], v[76:79]
    buffer_load_dwordx4 a[16:19], v5, s[40:43], s28 offen offset:2048
    s_setprio 3
    s_barrier
    s_waitcnt vmcnt(16) lgkmcnt(3)
    v_mfma_f32_16x16x32_bf16 v[32:35], a[24:27], v[144:147], v[32:35]
    ds_read_b128 v[160:163], v5 offset:3072
    s_waitcnt lgkmcnt(3)
    v_mfma_f32_16x16x32_bf16 v[36:39], a[24:27], v[148:151], v[36:39]
    s_waitcnt lgkmcnt(2)
    v_mfma_f32_16x16x32_bf16 v[40:43], a[24:27], v[152:155], v[40:43]
    ds_read_b128 v[164:167], v5 offset:22528
    s_waitcnt lgkmcnt(2)
    v_mfma_f32_16x16x32_bf16 v[44:47], a[24:27], v[156:159], v[44:47]
    buffer_load_dwordx4 a[20:23], v5, s[40:43], s28 offen offset:3072
    s_waitcnt vmcnt(16)
    v_mfma_f32_16x16x32_bf16 v[48:51], a[28:31], v[144:147], v[48:51]
    ds_read_b128 v[168:171], v7 offset:3072
    v_mfma_f32_16x16x32_bf16 v[52:55], a[28:31], v[148:151], v[52:55]
    v_mfma_f32_16x16x32_bf16 v[56:59], a[28:31], v[152:155], v[56:59]
    ds_read_b128 v[172:175], v7 offset:22528
    v_mfma_f32_16x16x32_bf16 v[60:63], a[28:31], v[156:159], v[60:63]
    s_mov_b32 s28, 24576
    buffer_load_dwordx4 a[24:27], v5, s[40:43], s28 offen offset:0
    s_waitcnt vmcnt(16)
    v_mfma_f32_16x16x32_bf16 v[64:67], a[32:35], v[144:147], v[64:67]
    v_mfma_f32_16x16x32_bf16 v[68:71], a[32:35], v[148:151], v[68:71]
    v_mfma_f32_16x16x32_bf16 v[72:75], a[32:35], v[152:155], v[72:75]
    v_mfma_f32_16x16x32_bf16 v[76:79], a[32:35], v[156:159], v[76:79]
    buffer_load_dwordx4 a[28:31], v5, s[40:43], s28 offen offset:1024
    s_setprio 2
    s_waitcnt vmcnt(16) lgkmcnt(3)
    v_mfma_f32_16x16x32_bf16 v[32:35], a[36:39], v[160:163], v[32:35]
    ds_read_b128 v[144:147], v5 offset:4096
    s_waitcnt lgkmcnt(3)
    v_mfma_f32_16x16x32_bf16 v[36:39], a[36:39], v[164:167], v[36:39]
    s_waitcnt lgkmcnt(2)
    v_mfma_f32_16x16x32_bf16 v[40:43], a[36:39], v[168:171], v[40:43]
    ds_read_b128 v[148:151], v5 offset:23552
    s_waitcnt lgkmcnt(2)
    v_mfma_f32_16x16x32_bf16 v[44:47], a[36:39], v[172:175], v[44:47]
    buffer_load_dwordx4 a[32:35], v5, s[40:43], s28 offen offset:2048
    s_waitcnt vmcnt(16)
    v_mfma_f32_16x16x32_bf16 v[48:51], a[40:43], v[160:163], v[48:51]
    ds_read_b128 v[152:155], v7 offset:4096
    v_mfma_f32_16x16x32_bf16 v[52:55], a[40:43], v[164:167], v[52:55]
    v_mfma_f32_16x16x32_bf16 v[56:59], a[40:43], v[168:171], v[56:59]
    ds_read_b128 v[156:159], v7 offset:23552
    v_mfma_f32_16x16x32_bf16 v[60:63], a[40:43], v[172:175], v[60:63]
    buffer_load_dwordx4 a[36:39], v5, s[40:43], s28 offen offset:3072
    s_waitcnt vmcnt(16)
    v_mfma_f32_16x16x32_bf16 v[64:67], a[44:47], v[160:163], v[64:67]
    v_mfma_f32_16x16x32_bf16 v[68:71], a[44:47], v[164:167], v[68:71]
    v_mfma_f32_16x16x32_bf16 v[72:75], a[44:47], v[168:171], v[72:75]
    v_mfma_f32_16x16x32_bf16 v[76:79], a[44:47], v[172:175], v[76:79]
    s_mov_b32 s28, 28672
    buffer_load_dwordx4 a[40:43], v5, s[40:43], s28 offen offset:0
    s_setprio 1
    s_waitcnt vmcnt(16) lgkmcnt(3)
    v_mfma_f32_16x16x32_bf16 v[32:35], a[48:51], v[144:147], v[32:35]
    ds_read_b128 v[160:163], v5 offset:5120
    s_waitcnt lgkmcnt(3)
    v_mfma_f32_16x16x32_bf16 v[36:39], a[48:51], v[148:151], v[36:39]
    s_waitcnt lgkmcnt(2)
    v_mfma_f32_16x16x32_bf16 v[40:43], a[48:51], v[152:155], v[40:43]
    ds_read_b128 v[164:167], v5 offset:24576
    s_waitcnt lgkmcnt(2)
    v_mfma_f32_16x16x32_bf16 v[44:47], a[48:51], v[156:159], v[44:47]
    buffer_load_dwordx4 a[44:47], v5, s[40:43], s28 offen offset:1024
    s_waitcnt vmcnt(16)
    v_mfma_f32_16x16x32_bf16 v[48:51], a[52:55], v[144:147], v[48:51]
    ds_read_b128 v[168:171], v7 offset:5120
    v_mfma_f32_16x16x32_bf16 v[52:55], a[52:55], v[148:151], v[52:55]
    v_mfma_f32_16x16x32_bf16 v[56:59], a[52:55], v[152:155], v[56:59]
    ds_read_b128 v[172:175], v7 offset:24576
    v_mfma_f32_16x16x32_bf16 v[60:63], a[52:55], v[156:159], v[60:63]
    buffer_load_dwordx4 a[48:51], v5, s[40:43], s28 offen offset:2048
    s_waitcnt vmcnt(16)
    v_mfma_f32_16x16x32_bf16 v[64:67], a[56:59], v[144:147], v[64:67]
    v_mfma_f32_16x16x32_bf16 v[68:71], a[56:59], v[148:151], v[68:71]
    v_mfma_f32_16x16x32_bf16 v[72:75], a[56:59], v[152:155], v[72:75]
    v_mfma_f32_16x16x32_bf16 v[76:79], a[56:59], v[156:159], v[76:79]
    buffer_load_dwordx4 a[52:55], v5, s[40:43], s28 offen offset:3072
    s_setprio 3
    s_barrier
    s_waitcnt vmcnt(16) lgkmcnt(3)
    v_mfma_f32_16x16x32_bf16 v[32:35], a[60:63], v[160:163], v[32:35]
    ds_read_b128 v[144:147], v5 offset:6144
    v_lshlrev_b32 v12, 2, v3
    v_add_u32 v12, 151552, v12
    s_waitcnt lgkmcnt(3)
    v_mfma_f32_16x16x32_bf16 v[36:39], a[60:63], v[164:167], v[36:39]
    ds_read_b32 v24, v12 offset:0
    s_waitcnt lgkmcnt(3)
    v_mfma_f32_16x16x32_bf16 v[40:43], a[60:63], v[168:171], v[40:43]
    ds_read_b128 v[148:151], v5 offset:25600
    ds_read_b32 v25, v12 offset:64
    ds_read_b32 v26, v12 offset:128
    s_waitcnt lgkmcnt(5)
    v_mfma_f32_16x16x32_bf16 v[44:47], a[60:63], v[172:175], v[44:47]
    s_mov_b32 s28, 32768
    buffer_load_dwordx4 a[56:59], v5, s[40:43], s28 offen offset:0
    ds_read_b32 v27, v12 offset:192
    s_waitcnt vmcnt(16)
    v_mfma_f32_16x16x32_bf16 v[48:51], a[64:67], v[160:163], v[48:51]
    ds_read_b128 v[152:155], v7 offset:6144
    s_waitcnt lgkmcnt(5)
    v_mul_f32 v16, 0xc0135761, v24
    v_mul_f32 v20, v24, v24
    v_mfma_f32_16x16x32_bf16 v[52:55], a[64:67], v[164:167], v[52:55]
    v_mul_f32 v20, v20, v24
    v_mfma_f32_16x16x32_bf16 v[56:59], a[64:67], v[168:171], v[56:59]
    ds_read_b128 v[156:159], v7 offset:25600
    v_mul_f32 v20, 0xbdd2d3e8, v20
    v_mfma_f32_16x16x32_bf16 v[60:63], a[64:67], v[172:175], v[60:63]
    buffer_load_dwordx4 a[60:63], v5, s[40:43], s28 offen offset:1024
    v_rcp_f32 v24, v24
    s_waitcnt vmcnt(16)
    v_mfma_f32_16x16x32_bf16 v[64:67], a[68:71], v[160:163], v[64:67]
    s_waitcnt lgkmcnt(4)
    v_mul_f32 v17, 0xc0135761, v25
    v_mul_f32 v21, v25, v25
    v_mfma_f32_16x16x32_bf16 v[68:71], a[68:71], v[164:167], v[68:71]
    v_mul_f32 v21, v21, v25
    v_mfma_f32_16x16x32_bf16 v[72:75], a[68:71], v[168:171], v[72:75]
    v_mul_f32 v21, 0xbdd2d3e8, v21
    v_mfma_f32_16x16x32_bf16 v[76:79], a[68:71], v[172:175], v[76:79]
    buffer_load_dwordx4 a[64:67], v5, s[40:43], s28 offen offset:2048
    v_rcp_f32 v25, v25
    s_setprio 2
    s_waitcnt vmcnt(16)
    v_mfma_f32_16x16x32_bf16 v[32:35], a[0:3], v[144:147], v[32:35]
    ds_read_b128 v[160:163], v5 offset:7168
    s_waitcnt lgkmcnt(4)
    v_mul_f32 v18, 0xc0135761, v26
    v_mul_f32 v22, v26, v26
    v_mfma_f32_16x16x32_bf16 v[36:39], a[0:3], v[148:151], v[36:39]
    v_mul_f32 v22, v22, v26
    s_waitcnt lgkmcnt(2)
    v_mfma_f32_16x16x32_bf16 v[40:43], a[0:3], v[152:155], v[40:43]
    ds_read_b128 v[164:167], v5 offset:26624
    v_mul_f32 v22, 0xbdd2d3e8, v22
    s_waitcnt lgkmcnt(2)
    v_mfma_f32_16x16x32_bf16 v[44:47], a[0:3], v[156:159], v[44:47]
    buffer_load_dwordx4 a[68:71], v5, s[40:43], s28 offen offset:3072
    v_rcp_f32 v26, v26
    s_waitcnt vmcnt(16)
    v_mfma_f32_16x16x32_bf16 v[48:51], a[4:7], v[144:147], v[48:51]
    ds_read_b128 v[168:171], v7 offset:7168
    v_mul_f32 v19, 0xc0135761, v27
    v_mul_f32 v23, v27, v27
    v_mfma_f32_16x16x32_bf16 v[52:55], a[4:7], v[148:151], v[52:55]
    v_mul_f32 v23, v23, v27
    v_mfma_f32_16x16x32_bf16 v[56:59], a[4:7], v[152:155], v[56:59]
    ds_read_b128 v[172:175], v7 offset:26624
    v_mul_f32 v23, 0xbdd2d3e8, v23
    v_mfma_f32_16x16x32_bf16 v[60:63], a[4:7], v[156:159], v[60:63]
    s_mov_b32 s28, 36864
    buffer_load_dwordx4 a[0:3], v5, s[40:43], s28 offen offset:0
    v_rcp_f32 v27, v27
    s_waitcnt vmcnt(16)
    v_mfma_f32_16x16x32_bf16 v[64:67], a[8:11], v[144:147], v[64:67]
    v_min_u32 v29, 31, v1
    v_lshlrev_b32 v29, 2, v29
    v_mfma_f32_16x16x32_bf16 v[68:71], a[8:11], v[148:151], v[68:71]
    v_mfma_f32_16x16x32_bf16 v[72:75], a[8:11], v[152:155], v[72:75]
    v_mfma_f32_16x16x32_bf16 v[76:79], a[8:11], v[156:159], v[76:79]
    buffer_load_dwordx4 a[4:7], v5, s[40:43], s28 offen offset:1024
    s_setprio 1
    s_waitcnt vmcnt(16) lgkmcnt(3)
    v_mfma_f32_16x16x32_bf16 v[32:35], a[12:15], v[160:163], v[32:35]
    ds_read_b128 v[144:147], v5 offset:8192
    s_waitcnt lgkmcnt(3)
    v_mfma_f32_16x16x32_bf16 v[36:39], a[12:15], v[164:167], v[36:39]
    s_waitcnt lgkmcnt(2)
    v_mfma_f32_16x16x32_bf16 v[40:43], a[12:15], v[168:171], v[40:43]
    ds_read_b128 v[148:151], v5 offset:27648
    s_waitcnt lgkmcnt(2)
    v_mfma_f32_16x16x32_bf16 v[44:47], a[12:15], v[172:175], v[44:47]
    buffer_load_dwordx4 a[8:11], v5, s[40:43], s28 offen offset:2048
    s_waitcnt vmcnt(16)
    v_mfma_f32_16x16x32_bf16 v[48:51], a[16:19], v[160:163], v[48:51]
    ds_read_b128 v[152:155], v7 offset:8192
    v_mfma_f32_16x16x32_bf16 v[52:55], a[16:19], v[164:167], v[52:55]
    v_mfma_f32_16x16x32_bf16 v[56:59], a[16:19], v[168:171], v[56:59]
    ds_read_b128 v[156:159], v7 offset:27648
    v_mfma_f32_16x16x32_bf16 v[60:63], a[16:19], v[172:175], v[60:63]
    buffer_load_dwordx4 a[12:15], v5, s[40:43], s28 offen offset:3072
    s_waitcnt vmcnt(16)
    v_mfma_f32_16x16x32_bf16 v[64:67], a[20:23], v[160:163], v[64:67]
    v_mfma_f32_16x16x32_bf16 v[68:71], a[20:23], v[164:167], v[68:71]
    v_mfma_f32_16x16x32_bf16 v[72:75], a[20:23], v[168:171], v[72:75]
    v_mfma_f32_16x16x32_bf16 v[76:79], a[20:23], v[172:175], v[76:79]
    s_mov_b32 s28, 40960
    buffer_load_dwordx4 a[16:19], v5, s[40:43], s28 offen offset:0
    s_setprio 3
    s_barrier
    s_waitcnt vmcnt(16) lgkmcnt(3)
    v_mfma_f32_16x16x32_bf16 v[32:35], a[24:27], v[144:147], v[32:35]
    ds_read_b128 v[160:163], v5 offset:9216
    s_waitcnt lgkmcnt(3)
    v_mfma_f32_16x16x32_bf16 v[36:39], a[24:27], v[148:151], v[36:39]
    s_waitcnt lgkmcnt(2)
    v_mfma_f32_16x16x32_bf16 v[40:43], a[24:27], v[152:155], v[40:43]
    ds_read_b128 v[164:167], v5 offset:28672
    s_waitcnt lgkmcnt(2)
    v_mfma_f32_16x16x32_bf16 v[44:47], a[24:27], v[156:159], v[44:47]
    buffer_load_dwordx4 a[20:23], v5, s[40:43], s28 offen offset:1024
    s_waitcnt vmcnt(16)
    v_mfma_f32_16x16x32_bf16 v[48:51], a[28:31], v[144:147], v[48:51]
    ds_read_b128 v[168:171], v7 offset:9216
    v_mfma_f32_16x16x32_bf16 v[52:55], a[28:31], v[148:151], v[52:55]
    v_mfma_f32_16x16x32_bf16 v[56:59], a[28:31], v[152:155], v[56:59]
    ds_read_b128 v[172:175], v7 offset:28672
    v_mfma_f32_16x16x32_bf16 v[60:63], a[28:31], v[156:159], v[60:63]
    buffer_load_dwordx4 a[24:27], v5, s[40:43], s28 offen offset:2048
    s_waitcnt vmcnt(16)
    v_mfma_f32_16x16x32_bf16 v[64:67], a[32:35], v[144:147], v[64:67]
    v_mfma_f32_16x16x32_bf16 v[68:71], a[32:35], v[148:151], v[68:71]
    v_mfma_f32_16x16x32_bf16 v[72:75], a[32:35], v[152:155], v[72:75]
    v_mfma_f32_16x16x32_bf16 v[76:79], a[32:35], v[156:159], v[76:79]
    buffer_load_dwordx4 a[28:31], v5, s[40:43], s28 offen offset:3072
    s_setprio 2
    s_waitcnt vmcnt(16) lgkmcnt(3)
    v_mfma_f32_16x16x32_bf16 v[32:35], a[36:39], v[160:163], v[32:35]
    ds_read_b128 v[144:147], v5 offset:10240
    s_waitcnt lgkmcnt(3)
    v_mfma_f32_16x16x32_bf16 v[36:39], a[36:39], v[164:167], v[36:39]
    s_waitcnt lgkmcnt(2)
    v_mfma_f32_16x16x32_bf16 v[40:43], a[36:39], v[168:171], v[40:43]
    ds_read_b128 v[148:151], v5 offset:29696
    s_waitcnt lgkmcnt(2)
    v_mfma_f32_16x16x32_bf16 v[44:47], a[36:39], v[172:175], v[44:47]
    s_mov_b32 s28, 45056
    buffer_load_dwordx4 a[32:35], v5, s[40:43], s28 offen offset:0
    s_waitcnt vmcnt(16)
    v_mfma_f32_16x16x32_bf16 v[48:51], a[40:43], v[160:163], v[48:51]
    ds_read_b128 v[152:155], v7 offset:10240
    v_mfma_f32_16x16x32_bf16 v[52:55], a[40:43], v[164:167], v[52:55]
    v_mfma_f32_16x16x32_bf16 v[56:59], a[40:43], v[168:171], v[56:59]
    ds_read_b128 v[156:159], v7 offset:29696
    v_mfma_f32_16x16x32_bf16 v[60:63], a[40:43], v[172:175], v[60:63]
    buffer_load_dwordx4 a[36:39], v5, s[40:43], s28 offen offset:1024
    s_waitcnt vmcnt(16)
    v_mfma_f32_16x16x32_bf16 v[64:67], a[44:47], v[160:163], v[64:67]
    v_mfma_f32_16x16x32_bf16 v[68:71], a[44:47], v[164:167], v[68:71]
    v_mfma_f32_16x16x32_bf16 v[72:75], a[44:47], v[168:171], v[72:75]
    v_mfma_f32_16x16x32_bf16 v[76:79], a[44:47], v[172:175], v[76:79]
    buffer_load_dwordx4 a[40:43], v5, s[40:43], s28 offen offset:2048
    s_setprio 1
    s_waitcnt vmcnt(16) lgkmcnt(3)
    v_mfma_f32_16x16x32_bf16 v[32:35], a[48:51], v[144:147], v[32:35]
    ds_read_b128 v[160:163], v5 offset:11264
    s_waitcnt lgkmcnt(3)
    v_mfma_f32_16x16x32_bf16 v[36:39], a[48:51], v[148:151], v[36:39]
    s_waitcnt lgkmcnt(2)
    v_mfma_f32_16x16x32_bf16 v[40:43], a[48:51], v[152:155], v[40:43]
    ds_read_b128 v[164:167], v5 offset:30720
    s_waitcnt lgkmcnt(2)
    v_mfma_f32_16x16x32_bf16 v[44:47], a[48:51], v[156:159], v[44:47]
    buffer_load_dwordx4 a[44:47], v5, s[40:43], s28 offen offset:3072
    s_waitcnt vmcnt(16)
    v_mfma_f32_16x16x32_bf16 v[48:51], a[52:55], v[144:147], v[48:51]
    ds_read_b128 v[168:171], v7 offset:11264
    v_mfma_f32_16x16x32_bf16 v[52:55], a[52:55], v[148:151], v[52:55]
    v_mfma_f32_16x16x32_bf16 v[56:59], a[52:55], v[152:155], v[56:59]
    ds_read_b128 v[172:175], v7 offset:30720
    v_mfma_f32_16x16x32_bf16 v[60:63], a[52:55], v[156:159], v[60:63]
    s_mov_b32 s28, 49152
    buffer_load_dwordx4 a[48:51], v5, s[40:43], s28 offen offset:0
    s_waitcnt vmcnt(16)
    v_mfma_f32_16x16x32_bf16 v[64:67], a[56:59], v[144:147], v[64:67]
    v_mfma_f32_16x16x32_bf16 v[68:71], a[56:59], v[148:151], v[68:71]
    v_mfma_f32_16x16x32_bf16 v[72:75], a[56:59], v[152:155], v[72:75]
    v_mfma_f32_16x16x32_bf16 v[76:79], a[56:59], v[156:159], v[76:79]
    buffer_load_dwordx4 a[52:55], v5, s[40:43], s28 offen offset:1024
    s_setprio 3
    s_barrier
    s_waitcnt vmcnt(16) lgkmcnt(3)
    v_mfma_f32_16x16x32_bf16 v[32:35], a[60:63], v[160:163], v[32:35]
    ds_read_b128 v[144:147], v5 offset:12288
    s_waitcnt lgkmcnt(3)
    v_mfma_f32_16x16x32_bf16 v[36:39], a[60:63], v[164:167], v[36:39]
    s_waitcnt lgkmcnt(2)
    v_mfma_f32_16x16x32_bf16 v[40:43], a[60:63], v[168:171], v[40:43]
    ds_read_b128 v[148:151], v5 offset:31744
    s_waitcnt lgkmcnt(2)
    v_mfma_f32_16x16x32_bf16 v[44:47], a[60:63], v[172:175], v[44:47]
    buffer_load_dwordx4 a[56:59], v5, s[40:43], s28 offen offset:2048
    s_waitcnt vmcnt(16)
    v_mfma_f32_16x16x32_bf16 v[48:51], a[64:67], v[160:163], v[48:51]
    ds_read_b128 v[152:155], v7 offset:12288
    v_mfma_f32_16x16x32_bf16 v[52:55], a[64:67], v[164:167], v[52:55]
    v_mfma_f32_16x16x32_bf16 v[56:59], a[64:67], v[168:171], v[56:59]
    ds_read_b128 v[156:159], v7 offset:31744
    v_mfma_f32_16x16x32_bf16 v[60:63], a[64:67], v[172:175], v[60:63]
    buffer_load_dwordx4 a[60:63], v5, s[40:43], s28 offen offset:3072
    s_waitcnt vmcnt(16)
    v_mfma_f32_16x16x32_bf16 v[64:67], a[68:71], v[160:163], v[64:67]
    v_mfma_f32_16x16x32_bf16 v[68:71], a[68:71], v[164:167], v[68:71]
    v_mfma_f32_16x16x32_bf16 v[72:75], a[68:71], v[168:171], v[72:75]
    v_mfma_f32_16x16x32_bf16 v[76:79], a[68:71], v[172:175], v[76:79]
    s_mov_b32 s28, 53248
    buffer_load_dwordx4 a[64:67], v5, s[40:43], s28 offen offset:0
    s_setprio 2
    s_waitcnt vmcnt(16) lgkmcnt(3)
    v_mfma_f32_16x16x32_bf16 v[32:35], a[0:3], v[144:147], v[32:35]
    ds_read_b128 v[160:163], v5 offset:13312
    s_waitcnt lgkmcnt(3)
    v_mfma_f32_16x16x32_bf16 v[36:39], a[0:3], v[148:151], v[36:39]
    s_waitcnt lgkmcnt(2)
    v_mfma_f32_16x16x32_bf16 v[40:43], a[0:3], v[152:155], v[40:43]
    ds_read_b128 v[164:167], v5 offset:32768
    s_waitcnt lgkmcnt(2)
    v_mfma_f32_16x16x32_bf16 v[44:47], a[0:3], v[156:159], v[44:47]
    buffer_load_dwordx4 a[68:71], v5, s[40:43], s28 offen offset:1024
    s_waitcnt vmcnt(16)
    v_mfma_f32_16x16x32_bf16 v[48:51], a[4:7], v[144:147], v[48:51]
    ds_read_b128 v[168:171], v7 offset:13312
    v_mfma_f32_16x16x32_bf16 v[52:55], a[4:7], v[148:151], v[52:55]
    v_mfma_f32_16x16x32_bf16 v[56:59], a[4:7], v[152:155], v[56:59]
    ds_read_b128 v[172:175], v7 offset:32768
    v_mfma_f32_16x16x32_bf16 v[60:63], a[4:7], v[156:159], v[60:63]
    buffer_load_dwordx4 a[0:3], v6, s[36:39], s29 offen offset:0
    s_waitcnt vmcnt(16)
    v_mfma_f32_16x16x32_bf16 v[64:67], a[8:11], v[144:147], v[64:67]
    v_mfma_f32_16x16x32_bf16 v[68:71], a[8:11], v[148:151], v[68:71]
    v_mfma_f32_16x16x32_bf16 v[72:75], a[8:11], v[152:155], v[72:75]
    v_mfma_f32_16x16x32_bf16 v[76:79], a[8:11], v[156:159], v[76:79]
    buffer_load_dwordx4 a[4:7], v6, s[36:39], s29 offen offset:512
    s_setprio 1
    s_waitcnt vmcnt(16) lgkmcnt(3)
    v_mfma_f32_16x16x32_bf16 v[32:35], a[12:15], v[160:163], v[32:35]
    ds_read_b128 v[144:147], v5 offset:14336
    s_waitcnt lgkmcnt(3)
    v_mfma_f32_16x16x32_bf16 v[36:39], a[12:15], v[164:167], v[36:39]
    s_waitcnt lgkmcnt(2)
    v_mfma_f32_16x16x32_bf16 v[40:43], a[12:15], v[168:171], v[40:43]
    ds_read_b128 v[148:151], v5 offset:33792
    s_waitcnt lgkmcnt(2)
    v_mfma_f32_16x16x32_bf16 v[44:47], a[12:15], v[172:175], v[44:47]
    buffer_load_dwordx4 a[8:11], v6, s[36:39], s35 offen offset:0
    s_waitcnt vmcnt(16)
    v_mfma_f32_16x16x32_bf16 v[48:51], a[16:19], v[160:163], v[48:51]
    ds_read_b128 v[152:155], v7 offset:14336
    v_mfma_f32_16x16x32_bf16 v[52:55], a[16:19], v[164:167], v[52:55]
    v_mfma_f32_16x16x32_bf16 v[56:59], a[16:19], v[168:171], v[56:59]
    ds_read_b128 v[156:159], v7 offset:33792
    v_mfma_f32_16x16x32_bf16 v[60:63], a[16:19], v[172:175], v[60:63]
    buffer_load_dwordx4 a[12:15], v5, s[40:43], s28 offen offset:2048
    s_waitcnt vmcnt(16)
    v_mfma_f32_16x16x32_bf16 v[64:67], a[20:23], v[160:163], v[64:67]
    v_mfma_f32_16x16x32_bf16 v[68:71], a[20:23], v[164:167], v[68:71]
    v_mfma_f32_16x16x32_bf16 v[72:75], a[20:23], v[168:171], v[72:75]
    v_mfma_f32_16x16x32_bf16 v[76:79], a[20:23], v[172:175], v[76:79]
    buffer_load_dwordx4 a[16:19], v5, s[40:43], s28 offen offset:3072
    s_setprio 3
    s_barrier
    s_waitcnt vmcnt(16) lgkmcnt(3)
    v_mfma_f32_16x16x32_bf16 v[32:35], a[24:27], v[144:147], v[32:35]
    ds_read_b128 v[160:163], v5 offset:15360
    s_waitcnt lgkmcnt(3)
    v_mfma_f32_16x16x32_bf16 v[36:39], a[24:27], v[148:151], v[36:39]
    s_waitcnt lgkmcnt(2)
    v_mfma_f32_16x16x32_bf16 v[40:43], a[24:27], v[152:155], v[40:43]
    ds_read_b128 v[164:167], v5 offset:34816
    s_waitcnt lgkmcnt(2)
    v_mfma_f32_16x16x32_bf16 v[44:47], a[24:27], v[156:159], v[44:47]
    s_mov_b32 s28, 57344
    buffer_load_dwordx4 a[20:23], v5, s[40:43], s28 offen offset:0
    s_waitcnt vmcnt(16)
    v_mfma_f32_16x16x32_bf16 v[48:51], a[28:31], v[144:147], v[48:51]
    ds_read_b128 v[168:171], v7 offset:15360
    v_mfma_f32_16x16x32_bf16 v[52:55], a[28:31], v[148:151], v[52:55]
    v_mfma_f32_16x16x32_bf16 v[56:59], a[28:31], v[152:155], v[56:59]
    ds_read_b128 v[172:175], v7 offset:34816
    v_mfma_f32_16x16x32_bf16 v[60:63], a[28:31], v[156:159], v[60:63]
    buffer_load_dwordx4 a[24:27], v5, s[40:43], s28 offen offset:1024
    s_waitcnt vmcnt(16)
    v_mfma_f32_16x16x32_bf16 v[64:67], a[32:35], v[144:147], v[64:67]
    v_mfma_f32_16x16x32_bf16 v[68:71], a[32:35], v[148:151], v[68:71]
    v_mfma_f32_16x16x32_bf16 v[72:75], a[32:35], v[152:155], v[72:75]
    v_mfma_f32_16x16x32_bf16 v[76:79], a[32:35], v[156:159], v[76:79]
    buffer_load_dwordx4 a[28:31], v5, s[40:43], s28 offen offset:2048
    s_waitcnt vmcnt(16) lgkmcnt(3)
    v_mfma_f32_16x16x32_bf16 v[32:35], a[36:39], v[160:163], v[32:35]
    ds_read_b128 v[144:147], v5 offset:16384
    s_mul_i32 s32, s21, 2359296
    s_mul_i32 s31, s22, 73728
    s_waitcnt lgkmcnt(3)
    v_mfma_f32_16x16x32_bf16 v[36:39], a[36:39], v[164:167], v[36:39]
    s_add_u32 s32, s32, s31
    s_waitcnt lgkmcnt(2)
    v_mfma_f32_16x16x32_bf16 v[40:43], a[36:39], v[168:171], v[40:43]
    ds_read_b128 v[148:151], v5 offset:35840
    s_add_u32 s4, s12, 0x14f0000
    s_addc_u32 s5, s13, 0
    s_waitcnt lgkmcnt(2)
    v_mfma_f32_16x16x32_bf16 v[44:47], a[36:39], v[172:175], v[44:47]
    buffer_load_dwordx4 a[32:35], v5, s[40:43], s28 offen offset:3072
    s_add_u32 s4, s4, s32
    s_addc_u32 s5, s5, 0
    s_waitcnt vmcnt(16)
    v_mfma_f32_16x16x32_bf16 v[48:51], a[40:43], v[160:163], v[48:51]
    ds_read_b128 v[152:155], v7 offset:16384
    s_mov_b32 s6, 0x12000
    v_mfma_f32_16x16x32_bf16 v[52:55], a[40:43], v[164:167], v[52:55]
    s_mov_b32 s7, 0x20000
    v_mfma_f32_16x16x32_bf16 v[56:59], a[40:43], v[168:171], v[56:59]
    ds_read_b128 v[156:159], v7 offset:35840
    s_lshl_b32 s32, s20, 12
    v_add_u32 v15, s32, v5
    v_mfma_f32_16x16x32_bf16 v[60:63], a[40:43], v[172:175], v[60:63]
    s_mov_b32 s28, 61440
    buffer_load_dwordx4 a[36:39], v5, s[40:43], s28 offen offset:0
    s_lshl_b32 s32, s20, 8
    s_waitcnt vmcnt(16)
    v_mfma_f32_16x16x32_bf16 v[64:67], a[44:47], v[160:163], v[64:67]
    s_add_u32 s32, s32, 16384
    v_and_b32 v12, 1, v2
    v_mfma_f32_16x16x32_bf16 v[68:71], a[44:47], v[164:167], v[68:71]
    v_lshl_add_u32 v4, v12, 7, s32
    v_mfma_f32_16x16x32_bf16 v[72:75], a[44:47], v[168:171], v[72:75]
    v_and_b32 v12, 7, v3
    v_lshl_add_u32 v4, v12, 4, v4
    v_mfma_f32_16x16x32_bf16 v[76:79], a[44:47], v[172:175], v[76:79]
    buffer_load_dwordx4 a[40:43], v5, s[40:43], s28 offen offset:1024
    v_lshrrev_b32 v12, 3, v3
    s_waitcnt vmcnt(16) lgkmcnt(3)
    v_mfma_f32_16x16x32_bf16 v[32:35], a[48:51], v[144:147], v[32:35]
    ds_read_b128 v[160:163], v5 offset:17408
    v_lshl_add_u32 v4, v12, 10, v4
    v_lshrrev_b32 v12, 5, v1
    s_waitcnt lgkmcnt(3)
    v_mfma_f32_16x16x32_bf16 v[36:39], a[48:51], v[148:151], v[36:39]
    s_bfe_u32 s32, s21, 0x10001
    s_waitcnt lgkmcnt(2)
    v_mfma_f32_16x16x32_bf16 v[40:43], a[48:51], v[152:155], v[40:43]
    ds_read_b128 v[164:167], v5 offset:36864
    v_xor_b32 v12, s32, v12
    v_mul_u32_u24 v12, 18432, v12
    s_waitcnt lgkmcnt(2)
    v_mfma_f32_16x16x32_bf16 v[44:47], a[48:51], v[156:159], v[44:47]
    buffer_load_dwordx4 a[44:47], v5, s[40:43], s28 offen offset:2048
    v_add_u32 v4, v4, v12
    s_waitcnt vmcnt(16)
    v_mfma_f32_16x16x32_bf16 v[48:51], a[52:55], v[144:147], v[48:51]
    ds_read_b128 v[168:171], v7 offset:17408
    s_lshr_b32 s32, s21, 1
    s_xor_b32 s44, s32, 0
    v_mfma_f32_16x16x32_bf16 v[52:55], a[52:55], v[148:151], v[52:55]
    s_xor_b32 s45, s32, 1
    v_mfma_f32_16x16x32_bf16 v[56:59], a[52:55], v[152:155], v[56:59]
    ds_read_b128 v[172:175], v7 offset:36864
    s_xor_b32 s46, s32, 2
    s_xor_b32 s47, s32, 3
    v_mfma_f32_16x16x32_bf16 v[60:63], a[52:55], v[156:159], v[60:63]
    buffer_load_dwordx4 a[48:51], v5, s[40:43], s28 offen offset:3072
    s_and_b32 s48, s44, 2
    s_waitcnt vmcnt(16)
    v_mfma_f32_16x16x32_bf16 v[64:67], a[56:59], v[144:147], v[64:67]
    s_xor_b32 s49, s48, 2
    s_mul_i32 s44, s44, 18432
    v_mfma_f32_16x16x32_bf16 v[68:71], a[56:59], v[148:151], v[68:71]
    s_mul_i32 s45, s45, 18432
    v_mfma_f32_16x16x32_bf16 v[72:75], a[56:59], v[152:155], v[72:75]
    s_mul_i32 s46, s46, 18432
    s_mul_i32 s47, s47, 18432
    v_mfma_f32_16x16x32_bf16 v[76:79], a[56:59], v[156:159], v[76:79]
    s_mov_b32 s28, 65536
    buffer_load_dwordx4 a[52:55], v5, s[40:43], s28 offen offset:0
    s_mul_i32 s48, s48, 18432
    s_waitcnt vmcnt(16) lgkmcnt(3)
    v_mfma_f32_16x16x32_bf16 v[32:35], a[60:63], v[160:163], v[32:35]
    ds_read_b128 v[144:147], v5 offset:18432
    s_mul_i32 s49, s49, 18432
    s_waitcnt lgkmcnt(3)
    v_mfma_f32_16x16x32_bf16 v[36:39], a[60:63], v[164:167], v[36:39]
    s_waitcnt lgkmcnt(2)
    v_mfma_f32_16x16x32_bf16 v[40:43], a[60:63], v[168:171], v[40:43]
    ds_read_b128 v[148:151], v5 offset:37888
    s_waitcnt lgkmcnt(2)
    v_mfma_f32_16x16x32_bf16 v[44:47], a[60:63], v[172:175], v[44:47]
    buffer_load_dwordx4 a[56:59], v5, s[40:43], s28 offen offset:1024
    s_waitcnt vmcnt(16)
    v_mfma_f32_16x16x32_bf16 v[48:51], a[64:67], v[160:163], v[48:51]
    ds_read_b128 v[152:155], v7 offset:18432
    v_mfma_f32_16x16x32_bf16 v[52:55], a[64:67], v[164:167], v[52:55]
    v_mfma_f32_16x16x32_bf16 v[56:59], a[64:67], v[168:171], v[56:59]
    ds_read_b128 v[156:159], v7 offset:37888
    v_mfma_f32_16x16x32_bf16 v[60:63], a[64:67], v[172:175], v[60:63]
    buffer_load_dwordx4 a[60:63], v5, s[40:43], s28 offen offset:2048
    s_waitcnt vmcnt(16)
    v_mfma_f32_16x16x32_bf16 v[64:67], a[68:71], v[160:163], v[64:67]
    v_mfma_f32_16x16x32_bf16 v[68:71], a[68:71], v[164:167], v[68:71]
    v_mfma_f32_16x16x32_bf16 v[72:75], a[68:71], v[168:171], v[72:75]
    v_mfma_f32_16x16x32_bf16 v[76:79], a[68:71], v[172:175], v[76:79]
    buffer_load_dwordx4 a[64:67], v5, s[40:43], s28 offen offset:3072
    s_waitcnt vmcnt(16) lgkmcnt(3)
    v_mfma_f32_16x16x32_bf16 v[32:35], a[0:3], v[144:147], v[32:35]
    ds_read_b128 v[160:163], v5 offset:0
    s_waitcnt lgkmcnt(3)
    v_mfma_f32_16x16x32_bf16 v[36:39], a[0:3], v[148:151], v[36:39]
    s_waitcnt lgkmcnt(2)
    v_mfma_f32_16x16x32_bf16 v[40:43], a[0:3], v[152:155], v[40:43]
    ds_read_b128 v[164:167], v5 offset:19456
    s_waitcnt lgkmcnt(2)
    v_mfma_f32_16x16x32_bf16 v[44:47], a[0:3], v[156:159], v[44:47]
    s_mov_b32 s28, 69632
    buffer_load_dwordx4 a[68:71], v5, s[40:43], s28 offen offset:0
    s_waitcnt vmcnt(16)
    v_mfma_f32_16x16x32_bf16 v[48:51], a[4:7], v[144:147], v[48:51]
    ds_read_b128 v[168:171], v7 offset:0
    v_mfma_f32_16x16x32_bf16 v[52:55], a[4:7], v[148:151], v[52:55]
    v_mfma_f32_16x16x32_bf16 v[56:59], a[4:7], v[152:155], v[56:59]
    ds_read_b128 v[172:175], v7 offset:19456
    v_mfma_f32_16x16x32_bf16 v[60:63], a[4:7], v[156:159], v[60:63]
    buffer_load_dwordx4 a[0:3], v5, s[40:43], s28 offen offset:1024
    s_waitcnt vmcnt(16)
    v_mfma_f32_16x16x32_bf16 v[64:67], a[8:11], v[144:147], v[64:67]
    v_mfma_f32_16x16x32_bf16 v[68:71], a[8:11], v[148:151], v[68:71]
    v_mfma_f32_16x16x32_bf16 v[72:75], a[8:11], v[152:155], v[72:75]
    v_mfma_f32_16x16x32_bf16 v[76:79], a[8:11], v[156:159], v[76:79]
    buffer_load_dwordx4 a[4:7], v5, s[40:43], s28 offen offset:2048
    s_setprio 2
    s_waitcnt vmcnt(16) lgkmcnt(3)
    v_mfma_f32_16x16x32_bf16 v[96:99], a[12:15], v[160:163], 0
    ds_read_b128 v[144:147], v5 offset:1024
    v_mul_f32 v176, v32, v32
    v_mul_f32 v177, v33, v33
    v_mul_f32 v178, v34, v34
    v_mul_f32 v179, v35, v35
    s_waitcnt lgkmcnt(3)
    v_mfma_f32_16x16x32_bf16 v[100:103], a[12:15], v[164:167], 0
    v_fma_f32 v176, v176, v20, v16
    v_fma_f32 v177, v177, v20, v16
    v_fma_f32 v178, v178, v20, v16
    s_waitcnt lgkmcnt(2)
    v_mfma_f32_16x16x32_bf16 v[104:107], a[12:15], v[168:171], 0
    ds_read_b128 v[148:151], v5 offset:20480
    v_fma_f32 v179, v179, v20, v16
    v_mul_f32 v176, v176, v32
    v_mul_f32 v177, v177, v33
    s_waitcnt lgkmcnt(2)
    v_mfma_f32_16x16x32_bf16 v[108:111], a[12:15], v[172:175], 0
    buffer_load_dwordx4 a[8:11], v5, s[40:43], s28 offen offset:3072
    v_mul_f32 v178, v178, v34
    v_mul_f32 v179, v179, v35
    v_exp_f32 v176, v176
    s_waitcnt vmcnt(16)
    v_mfma_f32_16x16x32_bf16 v[112:115], a[16:19], v[160:163], 0
    ds_read_b128 v[152:155], v7 offset:1024
    v_exp_f32 v177, v177
    v_exp_f32 v178, v178
    v_mfma_f32_16x16x32_bf16 v[116:119], a[16:19], v[164:167], 0
    v_exp_f32 v179, v179
    v_fma_f32 v176, v176, v24, v24
    v_mfma_f32_16x16x32_bf16 v[120:123], a[16:19], v[168:171], 0
    ds_read_b128 v[156:159], v7 offset:20480
    v_fma_f32 v177, v177, v24, v24
    v_fma_f32 v178, v178, v24, v24
    v_fma_f32 v179, v179, v24, v24
    v_mfma_f32_16x16x32_bf16 v[124:127], a[16:19], v[172:175], 0
    s_mov_b32 s28, 73728
    buffer_load_dwordx4 a[12:15], v5, s[40:43], s28 offen offset:0
    v_rcp_f32 v176, v176
    v_rcp_f32 v177, v177
    s_waitcnt vmcnt(16) lgkmcnt(3)
    v_mfma_f32_16x16x32_bf16 v[96:99], a[20:23], v[144:147], v[96:99]
    ds_read_b128 v[160:163], v5 offset:2048
    v_rcp_f32 v178, v178
    v_rcp_f32 v179, v179
    s_waitcnt lgkmcnt(3)
    v_mfma_f32_16x16x32_bf16 v[100:103], a[20:23], v[148:151], v[100:103]
    v_mul_f32 v176, v176, v32
    v_mul_f32 v177, v177, v33
    v_mul_f32 v178, v178, v34
    s_waitcnt lgkmcnt(2)
    v_mfma_f32_16x16x32_bf16 v[104:107], a[20:23], v[152:155], v[104:107]
    ds_read_b128 v[164:167], v5 offset:21504
    v_mul_f32 v179, v179, v35
    v_cvt_pk_bf16_f32 v32, v176, v177
    v_cvt_pk_bf16_f32 v33, v178, v179
    s_waitcnt lgkmcnt(2)
    v_mfma_f32_16x16x32_bf16 v[108:111], a[20:23], v[156:159], v[108:111]
    buffer_load_dwordx4 a[16:19], v5, s[40:43], s28 offen offset:1024
    v_mul_f32 v180, v48, v48
    v_mul_f32 v181, v49, v49
    v_mul_f32 v182, v50, v50
    v_mul_f32 v183, v51, v51
    s_waitcnt vmcnt(16)
    v_mfma_f32_16x16x32_bf16 v[112:115], a[24:27], v[144:147], v[112:115]
    ds_read_b128 v[168:171], v7 offset:2048
    v_fma_f32 v180, v180, v20, v16
    v_fma_f32 v181, v181, v20, v16
    v_fma_f32 v182, v182, v20, v16
    v_mfma_f32_16x16x32_bf16 v[116:119], a[24:27], v[148:151], v[116:119]
    v_fma_f32 v183, v183, v20, v16
    v_mul_f32 v180, v180, v48
    v_mul_f32 v181, v181, v49
    v_mfma_f32_16x16x32_bf16 v[120:123], a[24:27], v[152:155], v[120:123]
    ds_read_b128 v[172:175], v7 offset:21504
    v_mul_f32 v182, v182, v50
    v_mul_f32 v183, v183, v51
    v_exp_f32 v180, v180
    v_mfma_f32_16x16x32_bf16 v[124:127], a[24:27], v[156:159], v[124:127]
    buffer_load_dwordx4 a[20:23], v5, s[40:43], s28 offen offset:2048
    v_exp_f32 v181, v181
    v_exp_f32 v182, v182
    s_waitcnt vmcnt(16) lgkmcnt(3)
    v_mfma_f32_16x16x32_bf16 v[96:99], a[28:31], v[160:163], v[96:99]
    ds_read_b128 v[144:147], v5 offset:3072
    v_exp_f32 v183, v183
    v_fma_f32 v180, v180, v24, v24
    s_waitcnt lgkmcnt(3)
    v_mfma_f32_16x16x32_bf16 v[100:103], a[28:31], v[164:167], v[100:103]
    v_fma_f32 v181, v181, v24, v24
    v_fma_f32 v182, v182, v24, v24
    v_fma_f32 v183, v183, v24, v24
    s_waitcnt lgkmcnt(2)
    v_mfma_f32_16x16x32_bf16 v[104:107], a[28:31], v[168:171], v[104:107]
    ds_read_b128 v[148:151], v5 offset:22528
    v_rcp_f32 v180, v180
    v_rcp_f32 v181, v181
    s_waitcnt lgkmcnt(2)
    v_mfma_f32_16x16x32_bf16 v[108:111], a[28:31], v[172:175], v[108:111]
    buffer_load_dwordx4 a[24:27], v5, s[40:43], s28 offen offset:3072
    v_rcp_f32 v182, v182
    v_rcp_f32 v183, v183
    s_waitcnt vmcnt(16)
    v_mfma_f32_16x16x32_bf16 v[112:115], a[32:35], v[160:163], v[112:115]
    ds_read_b128 v[152:155], v7 offset:3072
    v_mul_f32 v180, v180, v48
    v_mul_f32 v181, v181, v49
    v_mul_f32 v182, v182, v50
    v_mfma_f32_16x16x32_bf16 v[116:119], a[32:35], v[164:167], v[116:119]
    v_mul_f32 v183, v183, v51
    v_cvt_pk_bf16_f32 v34, v180, v181
    v_cvt_pk_bf16_f32 v35, v182, v183
    v_mfma_f32_16x16x32_bf16 v[120:123], a[32:35], v[168:171], v[120:123]
    ds_read_b128 v[156:159], v7 offset:22528
    ds_write_b128 v10, v[32:35] offset:0
    v_mul_f32 v176, v36, v36
    v_mfma_f32_16x16x32_bf16 v[124:127], a[32:35], v[172:175], v[124:127]
    s_mov_b32 s28, 77824
    buffer_load_dwordx4 a[28:31], v5, s[40:43], s28 offen offset:0
    v_mul_f32 v177, v37, v37
    v_mul_f32 v178, v38, v38
    v_mul_f32 v179, v39, v39
    v_fma_f32 v176, v176, v21, v17
    buffer_load_dword v30, v29, s[56:59], s34 offen sc1
    s_waitcnt vmcnt(17) lgkmcnt(4)
    v_mfma_f32_16x16x32_bf16 v[96:99], a[36:39], v[144:147], v[96:99]
    ds_read_b128 v[160:163], v5 offset:4096
    v_fma_f32 v177, v177, v21, v17
    v_fma_f32 v178, v178, v21, v17
    v_fma_f32 v179, v179, v21, v17
    s_waitcnt lgkmcnt(4)
    v_mfma_f32_16x16x32_bf16 v[100:103], a[36:39], v[148:151], v[100:103]
    v_mul_f32 v176, v176, v36
    v_mul_f32 v177, v177, v37
    v_mul_f32 v178, v178, v38
    s_waitcnt lgkmcnt(3)
    v_mfma_f32_16x16x32_bf16 v[104:107], a[36:39], v[152:155], v[104:107]
    ds_read_b128 v[164:167], v5 offset:23552
    v_mul_f32 v179, v179, v39
    v_exp_f32 v176, v176
    v_exp_f32 v177, v177
    s_waitcnt lgkmcnt(3)
    v_mfma_f32_16x16x32_bf16 v[108:111], a[36:39], v[156:159], v[108:111]
    buffer_load_dwordx4 a[32:35], v5, s[40:43], s28 offen offset:1024
    v_exp_f32 v178, v178
    s_waitcnt vmcnt(17)
    v_mfma_f32_16x16x32_bf16 v[112:115], a[40:43], v[144:147], v[112:115]
    ds_read_b128 v[168:171], v7 offset:4096
    v_exp_f32 v179, v179
    v_fma_f32 v176, v176, v25, v25
    v_fma_f32 v177, v177, v25, v25
    v_mfma_f32_16x16x32_bf16 v[116:119], a[40:43], v[148:151], v[116:119]
    v_fma_f32 v178, v178, v25, v25
    v_fma_f32 v179, v179, v25, v25
    v_rcp_f32 v176, v176
    v_mfma_f32_16x16x32_bf16 v[120:123], a[40:43], v[152:155], v[120:123]
    ds_read_b128 v[172:175], v7 offset:23552
    v_rcp_f32 v177, v177
    v_mfma_f32_16x16x32_bf16 v[124:127], a[40:43], v[156:159], v[124:127]
    buffer_load_dwordx4 a[36:39], v5, s[40:43], s28 offen offset:2048
    v_rcp_f32 v178, v178
    v_rcp_f32 v179, v179
    v_mul_f32 v176, v176, v36
    s_waitcnt vmcnt(17) lgkmcnt(3)
    v_mfma_f32_16x16x32_bf16 v[96:99], a[44:47], v[160:163], v[96:99]
    ds_read_b128 v[144:147], v5 offset:5120
    v_mul_f32 v177, v177, v37
    v_mul_f32 v178, v178, v38
    v_mul_f32 v179, v179, v39
    s_waitcnt lgkmcnt(3)
    v_mfma_f32_16x16x32_bf16 v[100:103], a[44:47], v[164:167], v[100:103]
    v_cvt_pk_bf16_f32 v36, v176, v177
    v_cvt_pk_bf16_f32 v37, v178, v179
    v_mul_f32 v180, v52, v52
    v_mul_f32 v181, v53, v53
    s_waitcnt lgkmcnt(2)
    v_mfma_f32_16x16x32_bf16 v[104:107], a[44:47], v[168:171], v[104:107]
    ds_read_b128 v[148:151], v5 offset:24576
    v_mul_f32 v182, v54, v54
    v_mul_f32 v183, v55, v55
    v_fma_f32 v180, v180, v21, v17
    s_waitcnt lgkmcnt(2)
    v_mfma_f32_16x16x32_bf16 v[108:111], a[44:47], v[172:175], v[108:111]
    buffer_load_dwordx4 a[40:43], v5, s[40:43], s28 offen offset:3072
    v_fma_f32 v181, v181, v21, v17
    v_fma_f32 v182, v182, v21, v17
    v_fma_f32 v183, v183, v21, v17
    s_waitcnt vmcnt(17)
    v_mfma_f32_16x16x32_bf16 v[112:115], a[48:51], v[160:163], v[112:115]
    ds_read_b128 v[152:155], v7 offset:5120
    v_mul_f32 v180, v180, v52
    v_mul_f32 v181, v181, v53
    v_mul_f32 v182, v182, v54
    v_mul_f32 v183, v183, v55
    v_mfma_f32_16x16x32_bf16 v[116:119], a[48:51], v[164:167], v[116:119]
    v_exp_f32 v180, v180
    v_exp_f32 v181, v181
    v_mfma_f32_16x16x32_bf16 v[120:123], a[48:51], v[168:171], v[120:123]
    ds_read_b128 v[156:159], v7 offset:24576
    v_exp_f32 v182, v182
    v_exp_f32 v183, v183
    v_mfma_f32_16x16x32_bf16 v[124:127], a[48:51], v[172:175], v[124:127]
    s_mov_b32 s28, 81920
    buffer_load_dwordx4 a[44:47], v5, s[40:43], s28 offen offset:0
    v_fma_f32 v180, v180, v25, v25
    v_fma_f32 v181, v181, v25, v25
    s_waitcnt vmcnt(17) lgkmcnt(3)
    v_mfma_f32_16x16x32_bf16 v[96:99], a[52:55], v[144:147], v[96:99]
    ds_read_b128 v[160:163], v5 offset:6144
    v_fma_f32 v182, v182, v25, v25
    v_fma_f32 v183, v183, v25, v25
    v_rcp_f32 v180, v180
    s_waitcnt lgkmcnt(3)
    v_mfma_f32_16x16x32_bf16 v[100:103], a[52:55], v[148:151], v[100:103]
    v_rcp_f32 v181, v181
    v_rcp_f32 v182, v182
    s_waitcnt lgkmcnt(2)
    v_mfma_f32_16x16x32_bf16 v[104:107], a[52:55], v[152:155], v[104:107]
    ds_read_b128 v[164:167], v5 offset:25600
    v_rcp_f32 v183, v183
    v_mul_f32 v180, v180, v52
    s_waitcnt lgkmcnt(2)
    v_mfma_f32_16x16x32_bf16 v[108:111], a[52:55], v[156:159], v[108:111]
    buffer_load_dwordx4 a[48:51], v5, s[40:43], s28 offen offset:1024
    v_mul_f32 v181, v181, v53
    v_mul_f32 v182, v182, v54
    v_mul_f32 v183, v183, v55
    s_waitcnt vmcnt(17)
    v_mfma_f32_16x16x32_bf16 v[112:115], a[56:59], v[144:147], v[112:115]
    ds_read_b128 v[168:171], v7 offset:6144
    v_cvt_pk_bf16_f32 v38, v180, v181
    v_cvt_pk_bf16_f32 v39, v182, v183
    ds_write_b128 v10, v[36:39] offset:1024
    v_mfma_f32_16x16x32_bf16 v[116:119], a[56:59], v[148:151], v[116:119]
    v_mul_f32 v176, v40, v40
    v_mul_f32 v177, v41, v41
    v_mfma_f32_16x16x32_bf16 v[120:123], a[56:59], v[152:155], v[120:123]
    ds_read_b128 v[172:175], v7 offset:25600
    v_mul_f32 v178, v42, v42
    v_mul_f32 v179, v43, v43
    v_fma_f32 v176, v176, v22, v18
    v_fma_f32 v177, v177, v22, v18
    v_mfma_f32_16x16x32_bf16 v[124:127], a[56:59], v[156:159], v[124:127]
    buffer_load_dwordx4 a[52:55], v5, s[40:43], s28 offen offset:2048
    v_fma_f32 v178, v178, v22, v18
    v_fma_f32 v179, v179, v22, v18
    v_mul_f32 v176, v176, v40
    s_setprio 1
    s_waitcnt vmcnt(17) lgkmcnt(4)
    v_mfma_f32_16x16x32_bf16 v[96:99], a[60:63], v[160:163], v[96:99]
    ds_read_b128 v[144:147], v5 offset:7168
    v_mul_f32 v177, v177, v41
    v_mul_f32 v178, v178, v42
    v_mul_f32 v179, v179, v43
    s_waitcnt lgkmcnt(4)
    v_mfma_f32_16x16x32_bf16 v[100:103], a[60:63], v[164:167], v[100:103]
    v_exp_f32 v176, v176
    v_exp_f32 v177, v177
    s_waitcnt lgkmcnt(3)
    v_mfma_f32_16x16x32_bf16 v[104:107], a[60:63], v[168:171], v[104:107]
    ds_read_b128 v[148:151], v5 offset:26624
    v_exp_f32 v178, v178
    v_exp_f32 v179, v179
    s_waitcnt lgkmcnt(2)
    v_mfma_f32_16x16x32_bf16 v[108:111], a[60:63], v[172:175], v[108:111]
    buffer_load_dwordx4 a[56:59], v5, s[40:43], s28 offen offset:3072
    v_fma_f32 v176, v176, v26, v26
    v_fma_f32 v177, v177, v26, v26
    v_fma_f32 v178, v178, v26, v26
    s_waitcnt vmcnt(17)
    v_mfma_f32_16x16x32_bf16 v[112:115], a[64:67], v[160:163], v[112:115]
    ds_read_b128 v[152:155], v7 offset:7168
    v_fma_f32 v179, v179, v26, v26
    v_rcp_f32 v176, v176
    v_mfma_f32_16x16x32_bf16 v[116:119], a[64:67], v[164:167], v[116:119]
    v_rcp_f32 v177, v177
    v_rcp_f32 v178, v178
    v_mfma_f32_16x16x32_bf16 v[120:123], a[64:67], v[168:171], v[120:123]
    ds_read_b128 v[156:159], v7 offset:26624
    v_rcp_f32 v179, v179
    v_mul_f32 v176, v176, v40
    v_mul_f32 v177, v177, v41
    v_mfma_f32_16x16x32_bf16 v[124:127], a[64:67], v[172:175], v[124:127]
    s_mov_b32 s28, 86016
    buffer_load_dwordx4 a[60:63], v5, s[40:43], s28 offen offset:0
    v_mul_f32 v178, v178, v42
    v_mul_f32 v179, v179, v43
    v_cvt_pk_bf16_f32 v40, v176, v177
    s_waitcnt vmcnt(17) lgkmcnt(3)
    v_mfma_f32_16x16x32_bf16 v[96:99], a[68:71], v[144:147], v[96:99]
    ds_read_b128 v[160:163], v5 offset:8192
    v_cvt_pk_bf16_f32 v41, v178, v179
    v_mul_f32 v180, v56, v56
    v_mul_f32 v181, v57, v57
    v_mul_f32 v182, v58, v58
    s_waitcnt lgkmcnt(3)
    v_mfma_f32_16x16x32_bf16 v[100:103], a[68:71], v[148:151], v[100:103]
    v_mul_f32 v183, v59, v59
    v_fma_f32 v180, v180, v22, v18
    v_fma_f32 v181, v181, v22, v18
    s_waitcnt lgkmcnt(2)
    v_mfma_f32_16x16x32_bf16 v[104:107], a[68:71], v[152:155], v[104:107]
    ds_read_b128 v[164:167], v5 offset:27648
    v_fma_f32 v182, v182, v22, v18
    v_fma_f32 v183, v183, v22, v18
    v_mul_f32 v180, v180, v56
    s_waitcnt lgkmcnt(2)
    v_mfma_f32_16x16x32_bf16 v[108:111], a[68:71], v[156:159], v[108:111]
    buffer_load_dwordx4 a[64:67], v5, s[40:43], s28 offen offset:1024
    v_mul_f32 v181, v181, v57
    v_mul_f32 v182, v182, v58
    v_mul_f32 v183, v183, v59
    s_waitcnt vmcnt(17)
    v_mfma_f32_16x16x32_bf16 v[112:115], a[0:3], v[144:147], v[112:115]
    ds_read_b128 v[168:171], v7 offset:8192
    v_exp_f32 v180, v180
    v_exp_f32 v181, v181
    v_mfma_f32_16x16x32_bf16 v[116:119], a[0:3], v[148:151], v[116:119]
    v_exp_f32 v182, v182
    v_exp_f32 v183, v183
    v_mfma_f32_16x16x32_bf16 v[120:123], a[0:3], v[152:155], v[120:123]
    ds_read_b128 v[172:175], v7 offset:27648
    v_fma_f32 v180, v180, v26, v26
    v_fma_f32 v181, v181, v26, v26
    v_fma_f32 v182, v182, v26, v26
    v_mfma_f32_16x16x32_bf16 v[124:127], a[0:3], v[156:159], v[124:127]
    buffer_load_dwordx4 a[68:71], v5, s[40:43], s28 offen offset:2048
    v_fma_f32 v183, v183, v26, v26
    v_rcp_f32 v180, v180
    s_waitcnt vmcnt(17) lgkmcnt(3)
    v_mfma_f32_16x16x32_bf16 v[96:99], a[4:7], v[160:163], v[96:99]
    ds_read_b128 v[144:147], v5 offset:9216
    v_rcp_f32 v181, v181
    v_rcp_f32 v182, v182
    s_waitcnt lgkmcnt(3)
    v_mfma_f32_16x16x32_bf16 v[100:103], a[4:7], v[164:167], v[100:103]
    v_rcp_f32 v183, v183
    v_mul_f32 v180, v180, v56
    v_mul_f32 v181, v181, v57
    s_waitcnt lgkmcnt(2)
    v_mfma_f32_16x16x32_bf16 v[104:107], a[4:7], v[168:171], v[104:107]
    ds_read_b128 v[148:151], v5 offset:28672
    v_mul_f32 v182, v182, v58
    v_mul_f32 v183, v183, v59
    v_cvt_pk_bf16_f32 v42, v180, v181
    s_waitcnt lgkmcnt(2)
    v_mfma_f32_16x16x32_bf16 v[108:111], a[4:7], v[172:175], v[108:111]
    buffer_load_dwordx4 a[0:3], v5, s[40:43], s28 offen offset:3072
    v_cvt_pk_bf16_f32 v43, v182, v183
    ds_write_b128 v10, v[40:43] offset:2048
    s_waitcnt vmcnt(17)
    v_mfma_f32_16x16x32_bf16 v[112:115], a[8:11], v[160:163], v[112:115]
    ds_read_b128 v[152:155], v7 offset:9216
    v_mul_f32 v176, v44, v44
    v_mul_f32 v177, v45, v45
    v_mul_f32 v178, v46, v46
    v_mul_f32 v179, v47, v47
    v_mfma_f32_16x16x32_bf16 v[116:119], a[8:11], v[164:167], v[116:119]
    v_fma_f32 v176, v176, v23, v19
    v_fma_f32 v177, v177, v23, v19
    v_fma_f32 v178, v178, v23, v19
    v_mfma_f32_16x16x32_bf16 v[120:123], a[8:11], v[168:171], v[120:123]
    ds_read_b128 v[156:159], v7 offset:28672
    v_fma_f32 v179, v179, v23, v19
    v_mul_f32 v176, v176, v44
    v_mul_f32 v177, v177, v45
    v_mfma_f32_16x16x32_bf16 v[124:127], a[8:11], v[172:175], v[124:127]
    s_mov_b32 s28, 90112
    buffer_load_dwordx4 a[4:7], v5, s[40:43], s28 offen offset:0
    v_mul_f32 v178, v178, v46
    v_mul_f32 v179, v179, v47
    v_exp_f32 v176, v176
    s_waitcnt vmcnt(17) lgkmcnt(4)
    v_mfma_f32_16x16x32_bf16 v[96:99], a[12:15], v[144:147], v[96:99]
    ds_read_b128 v[160:163], v5 offset:10240
    v_exp_f32 v177, v177
    v_exp_f32 v178, v178
    s_waitcnt lgkmcnt(4)
    v_mfma_f32_16x16x32_bf16 v[100:103], a[12:15], v[148:151], v[100:103]
    v_exp_f32 v179, v179
    v_fma_f32 v176, v176, v27, v27
    s_waitcnt lgkmcnt(2)
    v_mfma_f32_16x16x32_bf16 v[104:107], a[12:15], v[152:155], v[104:107]
    ds_read_b128 v[164:167], v5 offset:29696
    v_fma_f32 v177, v177, v27, v27
    v_fma_f32 v178, v178, v27, v27
    v_fma_f32 v179, v179, v27, v27
    s_waitcnt lgkmcnt(2)
    v_mfma_f32_16x16x32_bf16 v[108:111], a[12:15], v[156:159], v[108:111]
    buffer_load_dwordx4 a[8:11], v5, s[40:43], s28 offen offset:1024
    v_rcp_f32 v176, v176
    v_rcp_f32 v177, v177
    s_waitcnt vmcnt(17)
    v_mfma_f32_16x16x32_bf16 v[112:115], a[16:19], v[144:147], v[112:115]
    ds_read_b128 v[168:171], v7 offset:10240
    v_rcp_f32 v178, v178
    v_rcp_f32 v179, v179
    v_mfma_f32_16x16x32_bf16 v[116:119], a[16:19], v[148:151], v[116:119]
    v_mul_f32 v176, v176, v44
    v_mul_f32 v177, v177, v45
    v_mul_f32 v178, v178, v46
    v_mfma_f32_16x16x32_bf16 v[120:123], a[16:19], v[152:155], v[120:123]
    ds_read_b128 v[172:175], v7 offset:29696
    v_mul_f32 v179, v179, v47
    v_cvt_pk_bf16_f32 v44, v176, v177
    v_cvt_pk_bf16_f32 v45, v178, v179
    v_mfma_f32_16x16x32_bf16 v[124:127], a[16:19], v[156:159], v[124:127]
    buffer_load_dwordx4 a[12:15], v6, s[36:39], s33 offen offset:0
    v_mul_f32 v180, v60, v60
    v_mul_f32 v181, v61, v61
    v_mul_f32 v182, v62, v62
    v_mul_f32 v183, v63, v63
    s_waitcnt vmcnt(17) lgkmcnt(3)
    v_mfma_f32_16x16x32_bf16 v[96:99], a[20:23], v[160:163], v[96:99]
    ds_read_b128 v[144:147], v5 offset:11264
    v_fma_f32 v180, v180, v23, v19
    v_fma_f32 v181, v181, v23, v19
    v_fma_f32 v182, v182, v23, v19
    s_waitcnt lgkmcnt(3)
    v_mfma_f32_16x16x32_bf16 v[100:103], a[20:23], v[164:167], v[100:103]
    v_fma_f32 v183, v183, v23, v19
    v_mul_f32 v180, v180, v60
    v_mul_f32 v181, v181, v61
    s_waitcnt lgkmcnt(2)
    v_mfma_f32_16x16x32_bf16 v[104:107], a[20:23], v[168:171], v[104:107]
    ds_read_b128 v[148:151], v5 offset:30720
    v_mul_f32 v182, v182, v62
    v_mul_f32 v183, v183, v63
    v_exp_f32 v180, v180
    s_waitcnt lgkmcnt(2)
    v_mfma_f32_16x16x32_bf16 v[108:111], a[20:23], v[172:175], v[108:111]
    buffer_load_dwordx4 a[16:19], v6, s[36:39], s33 offen offset:512
    v_exp_f32 v181, v181
    v_exp_f32 v182, v182
    s_waitcnt vmcnt(17)
    v_mfma_f32_16x16x32_bf16 v[112:115], a[24:27], v[160:163], v[112:115]
    ds_read_b128 v[152:155], v7 offset:11264
    v_exp_f32 v183, v183
    v_fma_f32 v180, v180, v27, v27
    v_mfma_f32_16x16x32_bf16 v[116:119], a[24:27], v[164:167], v[116:119]
    v_fma_f32 v181, v181, v27, v27
    v_fma_f32 v182, v182, v27, v27
    v_fma_f32 v183, v183, v27, v27
    v_mfma_f32_16x16x32_bf16 v[120:123], a[24:27], v[168:171], v[120:123]
    ds_read_b128 v[156:159], v7 offset:30720
    v_rcp_f32 v180, v180
    v_rcp_f32 v181, v181
    v_mfma_f32_16x16x32_bf16 v[124:127], a[24:27], v[172:175], v[124:127]
    s_waitcnt vmcnt(15)
    v_cmp_ne_u32 vcc, 0, v30
    s_nop 0
    s_cmp_eq_u32 vcc_lo, 0x3ffff
    s_cbranch_scc1 .L_mlp_wk0x
    v_add_u32 v29, s34, v29
    s_mov_b32 s32, 0x40000
.L_mlp_wk0:
    buffer_load_dword v30, v29, s[56:59], 0 offen sc1
    s_waitcnt vmcnt(0)
    v_cmp_ne_u32 vcc, 0, v30
    s_sub_u32 s32, s32, 1
    s_cbranch_scc1 .L_mlp_wk0x
    s_cmp_lg_u32 vcc_lo, 0x3ffff
    s_cbranch_scc1 .L_mlp_wk0
.L_mlp_wk0x:
    buffer_load_dwordx4 a[20:23], v5, s[40:43], s28 offen offset:2048 sc1
    v_rcp_f32 v182, v182
    v_rcp_f32 v183, v183
    s_waitcnt lgkmcnt(3)
    v_mfma_f32_16x16x32_bf16 v[96:99], a[28:31], v[144:147], v[96:99]
    ds_read_b128 v[160:163], v5 offset:12288
    v_mul_f32 v180, v180, v60
    v_mul_f32 v181, v181, v61
    v_mul_f32 v182, v182, v62
    s_waitcnt lgkmcnt(3)
    v_mfma_f32_16x16x32_bf16 v[100:103], a[28:31], v[148:151], v[100:103]
    v_mul_f32 v183, v183, v63
    v_cvt_pk_bf16_f32 v46, v180, v181
    v_cvt_pk_bf16_f32 v47, v182, v183
    s_waitcnt lgkmcnt(2)
    v_mfma_f32_16x16x32_bf16 v[104:107], a[28:31], v[152:155], v[104:107]
    ds_read_b128 v[164:167], v5 offset:31744
    ds_write_b128 v10, v[44:47] offset:3072
    v_mul_f32 v176, v64, v64
    s_waitcnt lgkmcnt(3)
    v_mfma_f32_16x16x32_bf16 v[108:111], a[28:31], v[156:159], v[108:111]
    buffer_load_dwordx4 a[24:27], v5, s[40:43], s28 offen offset:3072 sc1
    v_mul_f32 v177, v65, v65
    v_mul_f32 v178, v66, v66
    v_mul_f32 v179, v67, v67
    v_fma_f32 v176, v176, v20, v16
    s_waitcnt vmcnt(16)
    v_mfma_f32_16x16x32_bf16 v[112:115], a[32:35], v[144:147], v[112:115]
    ds_read_b128 v[168:171], v7 offset:12288
    v_fma_f32 v177, v177, v20, v16
    v_fma_f32 v178, v178, v20, v16
    v_fma_f32 v179, v179, v20, v16
    v_mfma_f32_16x16x32_bf16 v[116:119], a[32:35], v[148:151], v[116:119]
    v_mul_f32 v176, v176, v64
    v_mul_f32 v177, v177, v65
    v_mul_f32 v178, v178, v66
    v_mfma_f32_16x16x32_bf16 v[120:123], a[32:35], v[152:155], v[120:123]
    ds_read_b128 v[172:175], v7 offset:31744
    v_mul_f32 v179, v179, v67
    v_exp_f32 v176, v176
    v_exp_f32 v177, v177
    v_mfma_f32_16x16x32_bf16 v[124:127], a[32:35], v[156:159], v[124:127]
    s_mov_b32 s28, 94208
    buffer_load_dwordx4 a[28:31], v5, s[40:43], s28 offen offset:0 sc1
    v_exp_f32 v178, v178
    s_setprio 0
    s_waitcnt vmcnt(16) lgkmcnt(4)
    v_mfma_f32_16x16x32_bf16 v[96:99], a[36:39], v[160:163], v[96:99]
    ds_read_b128 v[144:147], v5 offset:13312
    v_exp_f32 v179, v179
    v_fma_f32 v176, v176, v24, v24
    v_fma_f32 v177, v177, v24, v24
    s_waitcnt lgkmcnt(4)
    v_mfma_f32_16x16x32_bf16 v[100:103], a[36:39], v[164:167], v[100:103]
    v_fma_f32 v178, v178, v24, v24
    v_fma_f32 v179, v179, v24, v24
    v_rcp_f32 v176, v176
    s_waitcnt lgkmcnt(2)
    v_mfma_f32_16x16x32_bf16 v[104:107], a[36:39], v[168:171], v[104:107]
    ds_read_b128 v[148:151], v5 offset:32768
    v_rcp_f32 v177, v177
    s_waitcnt lgkmcnt(2)
    v_mfma_f32_16x16x32_bf16 v[108:111], a[36:39], v[172:175], v[108:111]
    buffer_load_dwordx4 a[32:35], v5, s[40:43], s28 offen offset:1024 sc1
    v_rcp_f32 v178, v178
    v_rcp_f32 v179, v179
    v_mul_f32 v176, v176, v64
    s_waitcnt vmcnt(16)
    v_mfma_f32_16x16x32_bf16 v[112:115], a[40:43], v[160:163], v[112:115]
    ds_read_b128 v[152:155], v7 offset:13312
    v_mul_f32 v177, v177, v65
    v_mul_f32 v178, v178, v66
    v_mul_f32 v179, v179, v67
    v_mfma_f32_16x16x32_bf16 v[116:119], a[40:43], v[164:167], v[116:119]
    v_cvt_pk_bf16_f32 v64, v176, v177
    v_cvt_pk_bf16_f32 v65, v178, v179
    ds_write_b64 v11, v[64:65] offset:0
    v_mfma_f32_16x16x32_bf16 v[120:123], a[40:43], v[168:171], v[120:123]
    ds_read_b128 v[156:159], v7 offset:32768
    v_mul_f32 v180, v68, v68
    v_mul_f32 v181, v69, v69
    v_mul_f32 v182, v70, v70
    v_mul_f32 v183, v71, v71
    v_mfma_f32_16x16x32_bf16 v[124:127], a[40:43], v[172:175], v[124:127]
    buffer_load_dwordx4 a[36:39], v5, s[40:43], s28 offen offset:2048 sc1
    v_fma_f32 v180, v180, v21, v17
    v_fma_f32 v181, v181, v21, v17
    v_fma_f32 v182, v182, v21, v17
    s_waitcnt vmcnt(16) lgkmcnt(4)
    v_mfma_f32_16x16x32_bf16 v[96:99], a[44:47], v[144:147], v[96:99]
    ds_read_b128 v[160:163], v5 offset:14336
    v_fma_f32 v183, v183, v21, v17
    v_mul_f32 v180, v180, v68
    v_mul_f32 v181, v181, v69
    s_waitcnt lgkmcnt(4)
    v_mfma_f32_16x16x32_bf16 v[100:103], a[44:47], v[148:151], v[100:103]
    v_mul_f32 v182, v182, v70
    v_mul_f32 v183, v183, v71
    v_exp_f32 v180, v180
    s_waitcnt lgkmcnt(3)
    v_mfma_f32_16x16x32_bf16 v[104:107], a[44:47], v[152:155], v[104:107]
    ds_read_b128 v[164:167], v5 offset:33792
    v_exp_f32 v181, v181
    v_exp_f32 v182, v182
    s_waitcnt lgkmcnt(2)
    v_mfma_f32_16x16x32_bf16 v[108:111], a[44:47], v[156:159], v[108:111]
    buffer_load_dwordx4 a[40:43], v5, s[40:43], s28 offen offset:3072 sc1
    v_exp_f32 v183, v183
    v_fma_f32 v180, v180, v25, v25
    s_waitcnt vmcnt(16)
    v_mfma_f32_16x16x32_bf16 v[112:115], a[48:51], v[144:147], v[112:115]
    ds_read_b128 v[168:171], v7 offset:14336
    v_fma_f32 v181, v181, v25, v25
    v_fma_f32 v182, v182, v25, v25
    v_fma_f32 v183, v183, v25, v25
    v_mfma_f32_16x16x32_bf16 v[116:119], a[48:51], v[148:151], v[116:119]
    v_rcp_f32 v180, v180
    v_rcp_f32 v181, v181
    v_mfma_f32_16x16x32_bf16 v[120:123], a[48:51], v[152:155], v[120:123]
    ds_read_b128 v[172:175], v7 offset:33792
    v_rcp_f32 v182, v182
    v_rcp_f32 v183, v183
    v_mfma_f32_16x16x32_bf16 v[124:127], a[48:51], v[156:159], v[124:127]
    s_mov_b32 s28, 98304
    buffer_load_dwordx4 a[44:47], v5, s[40:43], s28 offen offset:0 sc1
    v_mul_f32 v180, v180, v68
    v_mul_f32 v181, v181, v69
    v_mul_f32 v182, v182, v70
    s_waitcnt vmcnt(16) lgkmcnt(3)
    v_mfma_f32_16x16x32_bf16 v[96:99], a[52:55], v[160:163], v[96:99]
    ds_read_b128 v[144:147], v5 offset:15360
    v_mul_f32 v183, v183, v71
    v_cvt_pk_bf16_f32 v68, v180, v181
    v_cvt_pk_bf16_f32 v69, v182, v183
    s_waitcnt lgkmcnt(3)
    v_mfma_f32_16x16x32_bf16 v[100:103], a[52:55], v[164:167], v[100:103]
    ds_write_b64 v11, v[68:69] offset:1024
    v_mul_f32 v176, v72, v72
    v_mul_f32 v177, v73, v73
    s_waitcnt lgkmcnt(3)
    v_mfma_f32_16x16x32_bf16 v[104:107], a[52:55], v[168:171], v[104:107]
    ds_read_b128 v[148:151], v5 offset:34816
    v_mul_f32 v178, v74, v74
    v_mul_f32 v179, v75, v75
    v_fma_f32 v176, v176, v22, v18
    v_fma_f32 v177, v177, v22, v18
    s_waitcnt lgkmcnt(3)
    v_mfma_f32_16x16x32_bf16 v[108:111], a[52:55], v[172:175], v[108:111]
    buffer_load_dwordx4 a[48:51], v5, s[40:43], s28 offen offset:1024 sc1
    v_fma_f32 v178, v178, v22, v18
    v_fma_f32 v179, v179, v22, v18
    v_mul_f32 v176, v176, v72
    s_waitcnt vmcnt(16)
    v_mfma_f32_16x16x32_bf16 v[112:115], a[56:59], v[160:163], v[112:115]
    ds_read_b128 v[152:155], v7 offset:15360
    v_mul_f32 v177, v177, v73
    v_mul_f32 v178, v178, v74
    v_mul_f32 v179, v179, v75
    v_mfma_f32_16x16x32_bf16 v[116:119], a[56:59], v[164:167], v[116:119]
    v_exp_f32 v176, v176
    v_exp_f32 v177, v177
    v_mfma_f32_16x16x32_bf16 v[120:123], a[56:59], v[168:171], v[120:123]
    ds_read_b128 v[156:159], v7 offset:34816
    v_exp_f32 v178, v178
    v_exp_f32 v179, v179
    v_mfma_f32_16x16x32_bf16 v[124:127], a[56:59], v[172:175], v[124:127]
    buffer_load_dwordx4 a[52:55], v5, s[40:43], s28 offen offset:2048 sc1
    v_fma_f32 v176, v176, v26, v26
    v_fma_f32 v177, v177, v26, v26
    v_fma_f32 v178, v178, v26, v26
    s_waitcnt vmcnt(16) lgkmcnt(4)
    v_mfma_f32_16x16x32_bf16 v[96:99], a[60:63], v[144:147], v[96:99]
    ds_read_b128 v[160:163], v5 offset:16384
    v_fma_f32 v179, v179, v26, v26
    v_rcp_f32 v176, v176
    s_waitcnt lgkmcnt(3)
    v_mfma_f32_16x16x32_bf16 v[100:103], a[60:63], v[148:151], v[100:103]
    v_rcp_f32 v177, v177
    v_rcp_f32 v178, v178
    s_waitcnt lgkmcnt(2)
    v_mfma_f32_16x16x32_bf16 v[104:107], a[60:63], v[152:155], v[104:107]
    ds_read_b128 v[164:167], v5 offset:35840
    v_rcp_f32 v179, v179
    v_mul_f32 v176, v176, v72
    v_mul_f32 v177, v177, v73
    s_waitcnt lgkmcnt(2)
    v_mfma_f32_16x16x32_bf16 v[108:111], a[60:63], v[156:159], v[108:111]
    buffer_load_dwordx4 a[56:59], v5, s[40:43], s28 offen offset:3072 sc1
    v_mul_f32 v178, v178, v74
    v_mul_f32 v179, v179, v75
    v_cvt_pk_bf16_f32 v72, v176, v177
    s_waitcnt vmcnt(16)
    v_mfma_f32_16x16x32_bf16 v[112:115], a[64:67], v[144:147], v[112:115]
    ds_read_b128 v[168:171], v7 offset:16384
    v_cvt_pk_bf16_f32 v73, v178, v179
    ds_write_b64 v11, v[72:73] offset:2048
    v_mul_f32 v180, v76, v76
    v_mfma_f32_16x16x32_bf16 v[116:119], a[64:67], v[148:151], v[116:119]
    v_mul_f32 v181, v77, v77
    v_mul_f32 v182, v78, v78
    v_mul_f32 v183, v79, v79
    v_fma_f32 v180, v180, v23, v19
    v_mfma_f32_16x16x32_bf16 v[120:123], a[64:67], v[152:155], v[120:123]
    ds_read_b128 v[172:175], v7 offset:35840
    v_fma_f32 v181, v181, v23, v19
    v_fma_f32 v182, v182, v23, v19
    v_fma_f32 v183, v183, v23, v19
    v_mfma_f32_16x16x32_bf16 v[124:127], a[64:67], v[156:159], v[124:127]
    s_mov_b32 s28, 102400
    buffer_load_dwordx4 a[60:63], v5, s[40:43], s28 offen offset:0 sc1
    v_mul_f32 v180, v180, v76
    v_mul_f32 v181, v181, v77
    v_mul_f32 v182, v182, v78
    s_waitcnt vmcnt(16) lgkmcnt(4)
    v_mfma_f32_16x16x32_bf16 v[96:99], a[68:71], v[160:163], v[96:99]
    ds_read_b128 v[144:147], v5 offset:17408
    v_mul_f32 v183, v183, v79
    v_exp_f32 v180, v180
    v_exp_f32 v181, v181
    s_waitcnt lgkmcnt(4)
    v_mfma_f32_16x16x32_bf16 v[100:103], a[68:71], v[164:167], v[100:103]
    v_exp_f32 v182, v182
    s_waitcnt lgkmcnt(3)
    v_mfma_f32_16x16x32_bf16 v[104:107], a[68:71], v[168:171], v[104:107]
    ds_read_b128 v[148:151], v5 offset:36864
    v_exp_f32 v183, v183
    v_fma_f32 v180, v180, v27, v27
    v_fma_f32 v181, v181, v27, v27
    s_waitcnt lgkmcnt(2)
    v_mfma_f32_16x16x32_bf16 v[108:111], a[68:71], v[172:175], v[108:111]
    buffer_load_dwordx4 a[64:67], v5, s[40:43], s28 offen offset:1024 sc1
    v_fma_f32 v182, v182, v27, v27
    v_fma_f32 v183, v183, v27, v27
    v_rcp_f32 v180, v180
    s_waitcnt vmcnt(16)
    v_mfma_f32_16x16x32_bf16 v[112:115], a[0:3], v[160:163], v[112:115]
    ds_read_b128 v[152:155], v7 offset:17408
    v_rcp_f32 v181, v181
    v_mfma_f32_16x16x32_bf16 v[116:119], a[0:3], v[164:167], v[116:119]
    v_rcp_f32 v182, v182
    v_rcp_f32 v183, v183
    v_mul_f32 v180, v180, v76
    v_mfma_f32_16x16x32_bf16 v[120:123], a[0:3], v[168:171], v[120:123]
    ds_read_b128 v[156:159], v7 offset:36864
    v_mul_f32 v181, v181, v77
    v_mul_f32 v182, v182, v78
    v_mul_f32 v183, v183, v79
    v_mfma_f32_16x16x32_bf16 v[124:127], a[0:3], v[172:175], v[124:127]
    buffer_load_dwordx4 a[68:71], v5, s[40:43], s28 offen offset:2048 sc1
    v_cvt_pk_bf16_f32 v76, v180, v181
    v_cvt_pk_bf16_f32 v77, v182, v183
    ds_write_b64 v11, v[76:77] offset:3072
    s_waitcnt vmcnt(16) lgkmcnt(4)
    v_mfma_f32_16x16x32_bf16 v[96:99], a[4:7], v[144:147], v[96:99]
    ds_read_b128 v[160:163], v5 offset:18432
    s_waitcnt lgkmcnt(4)
    v_mfma_f32_16x16x32_bf16 v[100:103], a[4:7], v[148:151], v[100:103]
    s_waitcnt lgkmcnt(3)
    v_mfma_f32_16x16x32_bf16 v[104:107], a[4:7], v[152:155], v[104:107]
    ds_read_b128 v[164:167], v5 offset:37888
    s_waitcnt lgkmcnt(3)
    v_mfma_f32_16x16x32_bf16 v[108:111], a[4:7], v[156:159], v[108:111]
    buffer_load_dwordx4 a[0:3], v5, s[40:43], s28 offen offset:3072 sc1
    s_waitcnt vmcnt(16)
    v_mfma_f32_16x16x32_bf16 v[112:115], a[8:11], v[144:147], v[112:115]
    ds_read_b128 v[168:171], v7 offset:18432
    v_mfma_f32_16x16x32_bf16 v[116:119], a[8:11], v[148:151], v[116:119]
    v_mfma_f32_16x16x32_bf16 v[120:123], a[8:11], v[152:155], v[120:123]
    ds_read_b128 v[172:175], v7 offset:37888
    v_mfma_f32_16x16x32_bf16 v[124:127], a[8:11], v[156:159], v[124:127]
    s_mov_b32 s28, 106496
    buffer_load_dwordx4 a[4:7], v5, s[40:43], s28 offen offset:0 sc1
    s_setprio 3
    s_waitcnt lgkmcnt(4)
    s_barrier
    s_waitcnt vmcnt(16) lgkmcnt(3)
    v_mfma_f32_16x16x32_bf16 v[96:99], a[12:15], v[160:163], v[96:99]
    ds_read_b128 v[144:147], v8 offset:0
    s_waitcnt lgkmcnt(3)
    v_mfma_f32_16x16x32_bf16 v[100:103], a[12:15], v[164:167], v[100:103]
    s_waitcnt lgkmcnt(2)
    v_mfma_f32_16x16x32_bf16 v[104:107], a[12:15], v[168:171], v[104:107]
    ds_read_b128 v[148:151], v8 offset:1024
    s_waitcnt lgkmcnt(2)
    v_mfma_f32_16x16x32_bf16 v[108:111], a[12:15], v[172:175], v[108:111]
    buffer_load_dwordx4 a[8:11], v5, s[40:43], s28 offen offset:1024 sc1
    s_waitcnt vmcnt(16)
    v_mfma_f32_16x16x32_bf16 v[112:115], a[16:19], v[160:163], v[112:115]
    ds_read_b128 v[152:155], v8 offset:2048
    v_mfma_f32_16x16x32_bf16 v[116:119], a[16:19], v[164:167], v[116:119]
    v_mfma_f32_16x16x32_bf16 v[120:123], a[16:19], v[168:171], v[120:123]
    ds_read_b128 v[156:159], v8 offset:3072
    v_mfma_f32_16x16x32_bf16 v[124:127], a[16:19], v[172:175], v[124:127]
    buffer_load_dwordx4 a[12:15], v5, s[40:43], s28 offen offset:2048 sc1
    s_waitcnt vmcnt(16) lgkmcnt(3)
    v_mfma_f32_16x16x32_bf16 v[32:35], a[20:23], v[144:147], 0
    ds_read_b128 v[160:163], v8 offset:4096
    v_mul_f32 v176, v96, v96
    v_mul_f32 v177, v97, v97
    s_waitcnt lgkmcnt(3)
    v_mfma_f32_16x16x32_bf16 v[36:39], a[20:23], v[148:151], 0
    v_mul_f32 v178, v98, v98
    v_mul_f32 v179, v99, v99
    v_fma_f32 v176, v176, v20, v16
    s_waitcnt lgkmcnt(2)
    v_mfma_f32_16x16x32_bf16 v[40:43], a[20:23], v[152:155], 0
    ds_read_b128 v[164:167], v8 offset:5120
    v_fma_f32 v177, v177, v20, v16
    v_fma_f32 v178, v178, v20, v16
    s_waitcnt lgkmcnt(2)
    v_mfma_f32_16x16x32_bf16 v[44:47], a[20:23], v[156:159], 0
    buffer_load_dwordx4 a[16:19], v5, s[40:43], s28 offen offset:3072 sc1
    v_fma_f32 v179, v179, v20, v16
    v_mul_f32 v176, v176, v96
    s_waitcnt vmcnt(16)
    v_mfma_f32_16x16x32_bf16 v[48:51], a[24:27], v[144:147], 0
    ds_read_b128 v[168:171], v8 offset:6144
    v_mul_f32 v177, v177, v97
    v_mul_f32 v178, v178, v98
    v_mfma_f32_16x16x32_bf16 v[52:55], a[24:27], v[148:151], 0
    v_mul_f32 v179, v179, v99
    v_exp_f32 v176, v176
    v_mfma_f32_16x16x32_bf16 v[56:59], a[24:27], v[152:155], 0
    ds_read_b128 v[172:175], v8 offset:7168
    v_exp_f32 v177, v177
    v_mfma_f32_16x16x32_bf16 v[60:63], a[24:27], v[156:159], 0
    s_mov_b32 s28, 110592
    buffer_load_dwordx4 a[20:23], v5, s[40:43], s28 offen offset:0 sc1
    v_exp_f32 v178, v178
    s_waitcnt vmcnt(16)
    v_mfma_f32_16x16x32_bf16 v[64:67], a[28:31], v[144:147], 0
    v_exp_f32 v179, v179
    v_fma_f32 v176, v176, v24, v24
    v_mfma_f32_16x16x32_bf16 v[68:71], a[28:31], v[148:151], 0
    v_fma_f32 v177, v177, v24, v24
    v_fma_f32 v178, v178, v24, v24
    v_mfma_f32_16x16x32_bf16 v[72:75], a[28:31], v[152:155], 0
    v_fma_f32 v179, v179, v24, v24
    v_rcp_f32 v176, v176
    v_mfma_f32_16x16x32_bf16 v[76:79], a[28:31], v[156:159], 0
    buffer_load_dwordx4 a[24:27], v5, s[40:43], s28 offen offset:1024 sc1
    v_rcp_f32 v177, v177
    s_waitcnt vmcnt(16)
    v_mfma_f32_16x16x32_bf16 v[80:83], a[32:35], v[144:147], 0
    v_rcp_f32 v178, v178
    v_mfma_f32_16x16x32_bf16 v[84:87], a[32:35], v[148:151], 0
    v_rcp_f32 v179, v179
    v_mul_f32 v176, v176, v96
    v_mfma_f32_16x16x32_bf16 v[88:91], a[32:35], v[152:155], 0
    v_mul_f32 v177, v177, v97
    v_mul_f32 v178, v178, v98
    v_mfma_f32_16x16x32_bf16 v[92:95], a[32:35], v[156:159], 0
    buffer_load_dwordx4 a[28:31], v5, s[40:43], s28 offen offset:2048 sc1
    v_mul_f32 v179, v179, v99
    v_cvt_pk_bf16_f32 v96, v176, v177
    s_waitcnt vmcnt(16) lgkmcnt(3)
    v_mfma_f32_16x16x32_bf16 v[32:35], a[36:39], v[160:163], v[32:35]
    ds_read_b128 v[144:147], v8 offset:8192
    v_cvt_pk_bf16_f32 v97, v178, v179
    v_mul_f32 v180, v112, v112
    v_mul_f32 v181, v113, v113
    s_waitcnt lgkmcnt(3)
    v_mfma_f32_16x16x32_bf16 v[36:39], a[36:39], v[164:167], v[36:39]
    v_mul_f32 v182, v114, v114
    v_mul_f32 v183, v115, v115
    s_waitcnt lgkmcnt(2)
    v_mfma_f32_16x16x32_bf16 v[40:43], a[36:39], v[168:171], v[40:43]
    ds_read_b128 v[148:151], v8 offset:9216
    v_fma_f32 v180, v180, v20, v16
    v_fma_f32 v181, v181, v20, v16
    s_waitcnt lgkmcnt(2)
    v_mfma_f32_16x16x32_bf16 v[44:47], a[36:39], v[172:175], v[44:47]
    buffer_load_dwordx4 a[32:35], v5, s[40:43], s28 offen offset:3072 sc1
    v_fma_f32 v182, v182, v20, v16
    v_fma_f32 v183, v183, v20, v16
    s_waitcnt vmcnt(16)
    v_mfma_f32_16x16x32_bf16 v[48:51], a[40:43], v[160:163], v[48:51]
    ds_read_b128 v[152:155], v8 offset:10240
    v_mul_f32 v180, v180, v112
    v_mul_f32 v181, v181, v113
    v_mfma_f32_16x16x32_bf16 v[52:55], a[40:43], v[164:167], v[52:55]
    v_mul_f32 v182, v182, v114
    v_mul_f32 v183, v183, v115
    v_mfma_f32_16x16x32_bf16 v[56:59], a[40:43], v[168:171], v[56:59]
    ds_read_b128 v[156:159], v8 offset:11264
    v_exp_f32 v180, v180
    v_exp_f32 v181, v181
    v_mfma_f32_16x16x32_bf16 v[60:63], a[40:43], v[172:175], v[60:63]
    s_mov_b32 s28, 114688
    buffer_load_dwordx4 a[36:39], v5, s[40:43], s28 offen offset:0 sc1
    v_exp_f32 v182, v182
    s_waitcnt vmcnt(16)
    v_mfma_f32_16x16x32_bf16 v[64:67], a[44:47], v[160:163], v[64:67]
    v_exp_f32 v183, v183
    v_mfma_f32_16x16x32_bf16 v[68:71], a[44:47], v[164:167], v[68:71]
    v_fma_f32 v180, v180, v24, v24
    v_fma_f32 v181, v181, v24, v24
    v_mfma_f32_16x16x32_bf16 v[72:75], a[44:47], v[168:171], v[72:75]
    v_fma_f32 v182, v182, v24, v24
    v_fma_f32 v183, v183, v24, v24
    v_mfma_f32_16x16x32_bf16 v[76:79], a[44:47], v[172:175], v[76:79]
    buffer_load_dwordx4 a[40:43], v5, s[40:43], s28 offen offset:1024 sc1
    v_rcp_f32 v180, v180
    s_waitcnt vmcnt(16)
    v_mfma_f32_16x16x32_bf16 v[80:83], a[48:51], v[160:163], v[80:83]
    v_rcp_f32 v181, v181
    v_rcp_f32 v182, v182
    v_mfma_f32_16x16x32_bf16 v[84:87], a[48:51], v[164:167], v[84:87]
    v_rcp_f32 v183, v183
    v_mfma_f32_16x16x32_bf16 v[88:91], a[48:51], v[168:171], v[88:91]
    v_mul_f32 v180, v180, v112
    v_mul_f32 v181, v181, v113
    v_mfma_f32_16x16x32_bf16 v[92:95], a[48:51], v[172:175], v[92:95]
    buffer_load_dwordx4 a[44:47], v5, s[40:43], s28 offen offset:2048 sc1
    v_mul_f32 v182, v182, v114
    v_mul_f32 v183, v183, v115
    s_setprio 2
    s_waitcnt vmcnt(16) lgkmcnt(3)
    v_mfma_f32_16x16x32_bf16 v[32:35], a[52:55], v[144:147], v[32:35]
    ds_read_b128 v[160:163], v8 offset:12288
    v_cvt_pk_bf16_f32 v98, v180, v181
    v_cvt_pk_bf16_f32 v99, v182, v183
    s_waitcnt lgkmcnt(3)
    v_mfma_f32_16x16x32_bf16 v[36:39], a[52:55], v[148:151], v[36:39]
    ds_write_b128 v10, v[96:99] offset:40960
    s_waitcnt lgkmcnt(3)
    v_mfma_f32_16x16x32_bf16 v[40:43], a[52:55], v[152:155], v[40:43]
    ds_read_b128 v[164:167], v8 offset:13312
    v_mul_f32 v176, v100, v100
    v_mul_f32 v177, v101, v101
    s_waitcnt lgkmcnt(3)
    v_mfma_f32_16x16x32_bf16 v[44:47], a[52:55], v[156:159], v[44:47]
    buffer_load_dwordx4 a[48:51], v5, s[40:43], s28 offen offset:3072 sc1
    v_mul_f32 v178, v102, v102
    v_mul_f32 v179, v103, v103
    v_fma_f32 v176, v176, v21, v17
    s_waitcnt vmcnt(16)
    v_mfma_f32_16x16x32_bf16 v[48:51], a[56:59], v[144:147], v[48:51]
    ds_read_b128 v[168:171], v8 offset:14336
    v_fma_f32 v177, v177, v21, v17
    v_fma_f32 v178, v178, v21, v17
    v_mfma_f32_16x16x32_bf16 v[52:55], a[56:59], v[148:151], v[52:55]
    v_fma_f32 v179, v179, v21, v17
    v_mul_f32 v176, v176, v100
    v_mfma_f32_16x16x32_bf16 v[56:59], a[56:59], v[152:155], v[56:59]
    ds_read_b128 v[172:175], v8 offset:15360
    v_mul_f32 v177, v177, v101
    v_mul_f32 v178, v178, v102
    v_mfma_f32_16x16x32_bf16 v[60:63], a[56:59], v[156:159], v[60:63]
    s_mov_b32 s28, 118784
    buffer_load_dwordx4 a[52:55], v5, s[40:43], s28 offen offset:0 sc1
    v_mul_f32 v179, v179, v103
    v_exp_f32 v176, v176
    s_waitcnt vmcnt(16)
    v_mfma_f32_16x16x32_bf16 v[64:67], a[60:63], v[144:147], v[64:67]
    v_exp_f32 v177, v177
    v_mfma_f32_16x16x32_bf16 v[68:71], a[60:63], v[148:151], v[68:71]
    v_exp_f32 v178, v178
    v_mfma_f32_16x16x32_bf16 v[72:75], a[60:63], v[152:155], v[72:75]
    v_exp_f32 v179, v179
    v_fma_f32 v176, v176, v25, v25
    v_mfma_f32_16x16x32_bf16 v[76:79], a[60:63], v[156:159], v[76:79]
    buffer_load_dwordx4 a[56:59], v5, s[40:43], s28 offen offset:1024 sc1
    v_fma_f32 v177, v177, v25, v25
    v_fma_f32 v178, v178, v25, v25
    s_waitcnt vmcnt(16)
    v_mfma_f32_16x16x32_bf16 v[80:83], a[64:67], v[144:147], v[80:83]
    v_fma_f32 v179, v179, v25, v25
    v_rcp_f32 v176, v176
    v_mfma_f32_16x16x32_bf16 v[84:87], a[64:67], v[148:151], v[84:87]
    v_rcp_f32 v177, v177
    v_mfma_f32_16x16x32_bf16 v[88:91], a[64:67], v[152:155], v[88:91]
    v_rcp_f32 v178, v178
    v_mfma_f32_16x16x32_bf16 v[92:95], a[64:67], v[156:159], v[92:95]
    buffer_load_dwordx4 a[60:63], v5, s[40:43], s28 offen offset:2048 sc1
    v_rcp_f32 v179, v179
    v_mul_f32 v176, v176, v100
    s_waitcnt vmcnt(16) lgkmcnt(4)
    v_mfma_f32_16x16x32_bf16 v[32:35], a[68:71], v[160:163], v[32:35]
    ds_read_b128 v[144:147], v8 offset:16384
    v_mul_f32 v177, v177, v101
    v_mul_f32 v178, v178, v102
    s_waitcnt lgkmcnt(3)
    v_mfma_f32_16x16x32_bf16 v[36:39], a[68:71], v[164:167], v[36:39]
    v_mul_f32 v179, v179, v103
    v_cvt_pk_bf16_f32 v100, v176, v177
    s_waitcnt lgkmcnt(2)
    v_mfma_f32_16x16x32_bf16 v[40:43], a[68:71], v[168:171], v[40:43]
    ds_read_b128 v[148:151], v8 offset:17408
    v_cvt_pk_bf16_f32 v101, v178, v179
    v_mul_f32 v180, v116, v116
    v_mul_f32 v181, v117, v117
    s_waitcnt lgkmcnt(2)
    v_mfma_f32_16x16x32_bf16 v[44:47], a[68:71], v[172:175], v[44:47]
    buffer_load_dwordx4 a[64:67], v5, s[40:43], s28 offen offset:3072 sc1
    v_mul_f32 v182, v118, v118
    v_mul_f32 v183, v119, v119
    s_waitcnt vmcnt(16)
    v_mfma_f32_16x16x32_bf16 v[48:51], a[0:3], v[160:163], v[48:51]
    ds_read_b128 v[152:155], v8 offset:18432
    v_fma_f32 v180, v180, v21, v17
    v_fma_f32 v181, v181, v21, v17
    v_mfma_f32_16x16x32_bf16 v[52:55], a[0:3], v[164:167], v[52:55]
    v_fma_f32 v182, v182, v21, v17
    v_fma_f32 v183, v183, v21, v17
    v_mfma_f32_16x16x32_bf16 v[56:59], a[0:3], v[168:171], v[56:59]
    ds_read_b128 v[156:159], v8 offset:19456
    v_mul_f32 v180, v180, v116
    v_mul_f32 v181, v181, v117
    v_mfma_f32_16x16x32_bf16 v[60:63], a[0:3], v[172:175], v[60:63]
    s_mov_b32 s28, 122880
    buffer_load_dwordx4 a[68:71], v5, s[40:43], s28 offen offset:0 sc1
    v_mul_f32 v182, v182, v118
    v_mul_f32 v183, v183, v119
    s_waitcnt vmcnt(16)
    v_mfma_f32_16x16x32_bf16 v[64:67], a[4:7], v[160:163], v[64:67]
    v_exp_f32 v180, v180
    v_exp_f32 v181, v181
    v_mfma_f32_16x16x32_bf16 v[68:71], a[4:7], v[164:167], v[68:71]
    v_exp_f32 v182, v182
    v_mfma_f32_16x16x32_bf16 v[72:75], a[4:7], v[168:171], v[72:75]
    v_exp_f32 v183, v183
    v_mfma_f32_16x16x32_bf16 v[76:79], a[4:7], v[172:175], v[76:79]
    buffer_load_dwordx4 a[0:3], v5, s[40:43], s28 offen offset:1024 sc1
    v_fma_f32 v180, v180, v25, v25
    v_fma_f32 v181, v181, v25, v25
    s_waitcnt vmcnt(16)
    v_mfma_f32_16x16x32_bf16 v[80:83], a[8:11], v[160:163], v[80:83]
    v_fma_f32 v182, v182, v25, v25
    v_fma_f32 v183, v183, v25, v25
    v_mfma_f32_16x16x32_bf16 v[84:87], a[8:11], v[164:167], v[84:87]
    v_rcp_f32 v180, v180
    v_mfma_f32_16x16x32_bf16 v[88:91], a[8:11], v[168:171], v[88:91]
    v_rcp_f32 v181, v181
    v_rcp_f32 v182, v182
    v_mfma_f32_16x16x32_bf16 v[92:95], a[8:11], v[172:175], v[92:95]
    buffer_load_dwordx4 a[4:7], v5, s[40:43], s28 offen offset:2048 sc1
    v_rcp_f32 v183, v183
    s_waitcnt vmcnt(16) lgkmcnt(3)
    v_mfma_f32_16x16x32_bf16 v[32:35], a[12:15], v[144:147], v[32:35]
    ds_read_b128 v[160:163], v8 offset:20480
    v_mul_f32 v180, v180, v116
    v_mul_f32 v181, v181, v117
    s_waitcnt lgkmcnt(3)
    v_mfma_f32_16x16x32_bf16 v[36:39], a[12:15], v[148:151], v[36:39]
    v_mul_f32 v182, v182, v118
    v_mul_f32 v183, v183, v119
    s_waitcnt lgkmcnt(2)
    v_mfma_f32_16x16x32_bf16 v[40:43], a[12:15], v[152:155], v[40:43]
    ds_read_b128 v[164:167], v8 offset:21504
    v_cvt_pk_bf16_f32 v102, v180, v181
    v_cvt_pk_bf16_f32 v103, v182, v183
    s_waitcnt lgkmcnt(2)
    v_mfma_f32_16x16x32_bf16 v[44:47], a[12:15], v[156:159], v[44:47]
    buffer_load_dwordx4 a[8:11], v5, s[40:43], s28 offen offset:3072 sc1
    ds_write_b128 v10, v[100:103] offset:41984
    s_waitcnt vmcnt(16)
    v_mfma_f32_16x16x32_bf16 v[48:51], a[16:19], v[144:147], v[48:51]
    ds_read_b128 v[168:171], v8 offset:22528
    v_mul_f32 v176, v104, v104
    v_mul_f32 v177, v105, v105
    v_mfma_f32_16x16x32_bf16 v[52:55], a[16:19], v[148:151], v[52:55]
    v_mul_f32 v178, v106, v106
    v_mul_f32 v179, v107, v107
    v_fma_f32 v176, v176, v22, v18
    v_mfma_f32_16x16x32_bf16 v[56:59], a[16:19], v[152:155], v[56:59]
    ds_read_b128 v[172:175], v8 offset:23552
    v_fma_f32 v177, v177, v22, v18
    v_fma_f32 v178, v178, v22, v18
    v_mfma_f32_16x16x32_bf16 v[60:63], a[16:19], v[156:159], v[60:63]
    s_mov_b32 s28, 126976
    buffer_load_dwordx4 a[12:15], v5, s[40:43], s28 offen offset:0 sc1
    v_fma_f32 v179, v179, v22, v18
    v_mul_f32 v176, v176, v104
    s_waitcnt vmcnt(16)
    v_mfma_f32_16x16x32_bf16 v[64:67], a[20:23], v[144:147], v[64:67]
    v_mul_f32 v177, v177, v105
    v_mul_f32 v178, v178, v106
    v_mfma_f32_16x16x32_bf16 v[68:71], a[20:23], v[148:151], v[68:71]
    v_mul_f32 v179, v179, v107
    v_exp_f32 v176, v176
    v_mfma_f32_16x16x32_bf16 v[72:75], a[20:23], v[152:155], v[72:75]
    v_exp_f32 v177, v177
    v_mfma_f32_16x16x32_bf16 v[76:79], a[20:23], v[156:159], v[76:79]
    buffer_load_dwordx4 a[16:19], v5, s[40:43], s28 offen offset:1024 sc1
    v_exp_f32 v178, v178
    s_waitcnt vmcnt(16)
    v_mfma_f32_16x16x32_bf16 v[80:83], a[24:27], v[144:147], v[80:83]
    v_exp_f32 v179, v179
    v_fma_f32 v176, v176, v26, v26
    v_mfma_f32_16x16x32_bf16 v[84:87], a[24:27], v[148:151], v[84:87]
    v_fma_f32 v177, v177, v26, v26
    v_fma_f32 v178, v178, v26, v26
    v_mfma_f32_16x16x32_bf16 v[88:91], a[24:27], v[152:155], v[88:91]
    v_fma_f32 v179, v179, v26, v26
    v_rcp_f32 v176, v176
    v_mfma_f32_16x16x32_bf16 v[92:95], a[24:27], v[156:159], v[92:95]
    buffer_load_dwordx4 a[20:23], v5, s[40:43], s28 offen offset:2048 sc1
    v_rcp_f32 v177, v177
    s_setprio 1
    s_waitcnt vmcnt(16) lgkmcnt(4)
    v_mfma_f32_16x16x32_bf16 v[32:35], a[28:31], v[160:163], v[32:35]
    ds_read_b128 v[144:147], v8 offset:24576
    v_rcp_f32 v178, v178
    s_waitcnt lgkmcnt(4)
    v_mfma_f32_16x16x32_bf16 v[36:39], a[28:31], v[164:167], v[36:39]
    v_rcp_f32 v179, v179
    v_mul_f32 v176, v176, v104
    s_waitcnt lgkmcnt(2)
    v_mfma_f32_16x16x32_bf16 v[40:43], a[28:31], v[168:171], v[40:43]
    ds_read_b128 v[148:151], v8 offset:25600
    v_mul_f32 v177, v177, v105
    v_mul_f32 v178, v178, v106
    s_waitcnt lgkmcnt(2)
    v_mfma_f32_16x16x32_bf16 v[44:47], a[28:31], v[172:175], v[44:47]
    buffer_load_dwordx4 a[24:27], v5, s[40:43], s28 offen offset:3072 sc1
    v_mul_f32 v179, v179, v107
    v_cvt_pk_bf16_f32 v104, v176, v177
    s_waitcnt vmcnt(16)
    v_mfma_f32_16x16x32_bf16 v[48:51], a[32:35], v[160:163], v[48:51]
    ds_read_b128 v[152:155], v8 offset:26624
    v_cvt_pk_bf16_f32 v105, v178, v179
    v_mul_f32 v180, v120, v120
    v_mul_f32 v181, v121, v121
    v_mfma_f32_16x16x32_bf16 v[52:55], a[32:35], v[164:167], v[52:55]
    v_mul_f32 v182, v122, v122
    v_mul_f32 v183, v123, v123
    v_mfma_f32_16x16x32_bf16 v[56:59], a[32:35], v[168:171], v[56:59]
    ds_read_b128 v[156:159], v8 offset:27648
    v_fma_f32 v180, v180, v22, v18
    v_fma_f32 v181, v181, v22, v18
    v_mfma_f32_16x16x32_bf16 v[60:63], a[32:35], v[172:175], v[60:63]
    s_mov_b32 s28, 131072
    buffer_load_dwordx4 a[28:31], v5, s[40:43], s28 offen offset:0 sc1
    v_fma_f32 v182, v182, v22, v18
    v_fma_f32 v183, v183, v22, v18
    s_waitcnt vmcnt(16)
    v_mfma_f32_16x16x32_bf16 v[64:67], a[36:39], v[160:163], v[64:67]
    v_mul_f32 v180, v180, v120
    v_mul_f32 v181, v181, v121
    v_mfma_f32_16x16x32_bf16 v[68:71], a[36:39], v[164:167], v[68:71]
    v_mul_f32 v182, v182, v122
    v_mul_f32 v183, v183, v123
    v_mfma_f32_16x16x32_bf16 v[72:75], a[36:39], v[168:171], v[72:75]
    v_exp_f32 v180, v180
    v_exp_f32 v181, v181
    v_mfma_f32_16x16x32_bf16 v[76:79], a[36:39], v[172:175], v[76:79]
    buffer_load_dwordx4 a[32:35], v5, s[40:43], s28 offen offset:1024 sc1
    v_exp_f32 v182, v182
    s_waitcnt vmcnt(16)
    v_mfma_f32_16x16x32_bf16 v[80:83], a[40:43], v[160:163], v[80:83]
    v_exp_f32 v183, v183
    v_mfma_f32_16x16x32_bf16 v[84:87], a[40:43], v[164:167], v[84:87]
    v_fma_f32 v180, v180, v26, v26
    v_fma_f32 v181, v181, v26, v26
    v_mfma_f32_16x16x32_bf16 v[88:91], a[40:43], v[168:171], v[88:91]
    v_fma_f32 v182, v182, v26, v26
    v_fma_f32 v183, v183, v26, v26
    v_mfma_f32_16x16x32_bf16 v[92:95], a[40:43], v[172:175], v[92:95]
    buffer_load_dwordx4 a[36:39], v5, s[40:43], s28 offen offset:2048 sc1
    v_rcp_f32 v180, v180
    s_waitcnt vmcnt(16) lgkmcnt(3)
    v_mfma_f32_16x16x32_bf16 v[32:35], a[44:47], v[144:147], v[32:35]
    ds_read_b128 v[160:163], v8 offset:28672
    v_rcp_f32 v181, v181
    v_rcp_f32 v182, v182
    s_waitcnt lgkmcnt(3)
    v_mfma_f32_16x16x32_bf16 v[36:39], a[44:47], v[148:151], v[36:39]
    v_rcp_f32 v183, v183
    s_waitcnt lgkmcnt(2)
    v_mfma_f32_16x16x32_bf16 v[40:43], a[44:47], v[152:155], v[40:43]
    ds_read_b128 v[164:167], v8 offset:29696
    v_mul_f32 v180, v180, v120
    v_mul_f32 v181, v181, v121
    s_waitcnt lgkmcnt(2)
    v_mfma_f32_16x16x32_bf16 v[44:47], a[44:47], v[156:159], v[44:47]
    buffer_load_dwordx4 a[40:43], v5, s[40:43], s28 offen offset:3072 sc1
    v_mul_f32 v182, v182, v122
    v_mul_f32 v183, v183, v123
    s_waitcnt vmcnt(16)
    v_mfma_f32_16x16x32_bf16 v[48:51], a[48:51], v[144:147], v[48:51]
    ds_read_b128 v[168:171], v8 offset:30720
    v_cvt_pk_bf16_f32 v106, v180, v181
    v_cvt_pk_bf16_f32 v107, v182, v183
    v_mfma_f32_16x16x32_bf16 v[52:55], a[48:51], v[148:151], v[52:55]
    ds_write_b128 v10, v[104:107] offset:43008
    v_mfma_f32_16x16x32_bf16 v[56:59], a[48:51], v[152:155], v[56:59]
    ds_read_b128 v[172:175], v8 offset:31744
    v_mul_f32 v176, v108, v108
    v_mul_f32 v177, v109, v109
    v_mfma_f32_16x16x32_bf16 v[60:63], a[48:51], v[156:159], v[60:63]
    s_mov_b32 s28, 135168
    buffer_load_dwordx4 a[44:47], v5, s[40:43], s28 offen offset:0 sc1
    v_mul_f32 v178, v110, v110
    v_mul_f32 v179, v111, v111
    v_fma_f32 v176, v176, v23, v19
    s_waitcnt vmcnt(16)
    v_mfma_f32_16x16x32_bf16 v[64:67], a[52:55], v[144:147], v[64:67]
    v_fma_f32 v177, v177, v23, v19
    v_fma_f32 v178, v178, v23, v19
    v_mfma_f32_16x16x32_bf16 v[68:71], a[52:55], v[148:151], v[68:71]
    v_fma_f32 v179, v179, v23, v19
    v_mul_f32 v176, v176, v108
    v_mfma_f32_16x16x32_bf16 v[72:75], a[52:55], v[152:155], v[72:75]
    v_mul_f32 v177, v177, v109
    v_mul_f32 v178, v178, v110
    v_mfma_f32_16x16x32_bf16 v[76:79], a[52:55], v[156:159], v[76:79]
    buffer_load_dwordx4 a[48:51], v5, s[40:43], s28 offen offset:1024 sc1
    v_mul_f32 v179, v179, v111
    v_exp_f32 v176, v176
    s_waitcnt vmcnt(16)
    v_mfma_f32_16x16x32_bf16 v[80:83], a[56:59], v[144:147], v[80:83]
    v_exp_f32 v177, v177
    v_mfma_f32_16x16x32_bf16 v[84:87], a[56:59], v[148:151], v[84:87]
    v_exp_f32 v178, v178
    v_mfma_f32_16x16x32_bf16 v[88:91], a[56:59], v[152:155], v[88:91]
    v_exp_f32 v179, v179
    v_fma_f32 v176, v176, v27, v27
    v_mfma_f32_16x16x32_bf16 v[92:95], a[56:59], v[156:159], v[92:95]
    buffer_load_dwordx4 a[52:55], v5, s[40:43], s28 offen offset:2048 sc1
    v_fma_f32 v177, v177, v27, v27
    v_fma_f32 v178, v178, v27, v27
    s_setprio 0
    s_waitcnt vmcnt(16) lgkmcnt(4)
    v_mfma_f32_16x16x32_bf16 v[32:35], a[60:63], v[160:163], v[32:35]
    ds_read_b128 v[144:147], v8 offset:32768
    v_fma_f32 v179, v179, v27, v27
    v_rcp_f32 v176, v176
    s_waitcnt lgkmcnt(4)
    v_mfma_f32_16x16x32_bf16 v[36:39], a[60:63], v[164:167], v[36:39]
    v_rcp_f32 v177, v177
    s_waitcnt lgkmcnt(3)
    v_mfma_f32_16x16x32_bf16 v[40:43], a[60:63], v[168:171], v[40:43]
    ds_read_b128 v[148:151], v8 offset:33792
    v_rcp_f32 v178, v178
    s_waitcnt lgkmcnt(2)
    v_mfma_f32_16x16x32_bf16 v[44:47], a[60:63], v[172:175], v[44:47]
    buffer_load_dwordx4 a[56:59], v5, s[40:43], s28 offen offset:3072 sc1
    v_rcp_f32 v179, v179
    v_mul_f32 v176, v176, v108
    s_waitcnt vmcnt(16)
    v_mfma_f32_16x16x32_bf16 v[48:51], a[64:67], v[160:163], v[48:51]
    ds_read_b128 v[152:155], v8 offset:34816
    v_mul_f32 v177, v177, v109
    v_mul_f32 v178, v178, v110
    v_mfma_f32_16x16x32_bf16 v[52:55], a[64:67], v[164:167], v[52:55]
    v_mul_f32 v179, v179, v111
    v_cvt_pk_bf16_f32 v108, v176, v177
    v_mfma_f32_16x16x32_bf16 v[56:59], a[64:67], v[168:171], v[56:59]
    ds_read_b128 v[156:159], v8 offset:35840
    v_cvt_pk_bf16_f32 v109, v178, v179
    v_mul_f32 v180, v124, v124
    v_mul_f32 v181, v125, v125
    v_mfma_f32_16x16x32_bf16 v[60:63], a[64:67], v[172:175], v[60:63]
    s_mov_b32 s28, 139264
    buffer_load_dwordx4 a[60:63], v5, s[40:43], s28 offen offset:0 sc1
    v_mul_f32 v182, v126, v126
    v_mul_f32 v183, v127, v127
    s_waitcnt vmcnt(16)
    v_mfma_f32_16x16x32_bf16 v[64:67], a[68:71], v[160:163], v[64:67]
    v_fma_f32 v180, v180, v23, v19
    v_fma_f32 v181, v181, v23, v19
    v_mfma_f32_16x16x32_bf16 v[68:71], a[68:71], v[164:167], v[68:71]
    v_fma_f32 v182, v182, v23, v19
    v_fma_f32 v183, v183, v23, v19
    v_mfma_f32_16x16x32_bf16 v[72:75], a[68:71], v[168:171], v[72:75]
    v_mul_f32 v180, v180, v124
    v_mul_f32 v181, v181, v125
    v_mfma_f32_16x16x32_bf16 v[76:79], a[68:71], v[172:175], v[76:79]
    buffer_load_dwordx4 a[64:67], v5, s[40:43], s28 offen offset:1024 sc1
    v_mul_f32 v182, v182, v126
    v_mul_f32 v183, v183, v127
    s_waitcnt vmcnt(16)
    v_mfma_f32_16x16x32_bf16 v[80:83], a[0:3], v[160:163], v[80:83]
    v_exp_f32 v180, v180
    v_exp_f32 v181, v181
    v_mfma_f32_16x16x32_bf16 v[84:87], a[0:3], v[164:167], v[84:87]
    v_exp_f32 v182, v182
    v_mfma_f32_16x16x32_bf16 v[88:91], a[0:3], v[168:171], v[88:91]
    v_exp_f32 v183, v183
    v_mfma_f32_16x16x32_bf16 v[92:95], a[0:3], v[172:175], v[92:95]
    buffer_load_dwordx4 a[68:71], v5, s[40:43], s28 offen offset:2048 sc1
    v_fma_f32 v180, v180, v27, v27
    v_fma_f32 v181, v181, v27, v27
    s_waitcnt vmcnt(16) lgkmcnt(3)
    v_mfma_f32_16x16x32_bf16 v[32:35], a[4:7], v[144:147], v[32:35]
    ds_read_b128 v[160:163], v9 offset:0
    v_fma_f32 v182, v182, v27, v27
    v_fma_f32 v183, v183, v27, v27
    s_waitcnt lgkmcnt(3)
    v_mfma_f32_16x16x32_bf16 v[36:39], a[4:7], v[148:151], v[36:39]
    v_rcp_f32 v180, v180
    s_waitcnt lgkmcnt(2)
    v_mfma_f32_16x16x32_bf16 v[40:43], a[4:7], v[152:155], v[40:43]
    ds_read_b128 v[164:167], v9 offset:1024
    v_rcp_f32 v181, v181
    v_rcp_f32 v182, v182
    s_waitcnt lgkmcnt(2)
    v_mfma_f32_16x16x32_bf16 v[44:47], a[4:7], v[156:159], v[44:47]
    buffer_load_dwordx4 a[0:3], v5, s[40:43], s28 offen offset:3072 sc1
    v_rcp_f32 v183, v183
    s_waitcnt vmcnt(16)
    v_mfma_f32_16x16x32_bf16 v[48:51], a[8:11], v[144:147], v[48:51]
    ds_read_b128 v[168:171], v9 offset:2048
    v_mul_f32 v180, v180, v124
    v_mul_f32 v181, v181, v125
    v_mfma_f32_16x16x32_bf16 v[52:55], a[8:11], v[148:151], v[52:55]
    v_mul_f32 v182, v182, v126
    v_mul_f32 v183, v183, v127
    v_mfma_f32_16x16x32_bf16 v[56:59], a[8:11], v[152:155], v[56:59]
    ds_read_b128 v[172:175], v9 offset:3072
    v_cvt_pk_bf16_f32 v110, v180, v181
    v_cvt_pk_bf16_f32 v111, v182, v183
    v_mfma_f32_16x16x32_bf16 v[60:63], a[8:11], v[156:159], v[60:63]
    s_mov_b32 s28, 143360
    buffer_load_dwordx4 a[4:7], v5, s[40:43], s28 offen offset:0 sc1
    ds_write_b128 v10, v[108:111] offset:44032
    s_waitcnt vmcnt(16)
    v_mfma_f32_16x16x32_bf16 v[64:67], a[12:15], v[144:147], v[64:67]
    v_mfma_f32_16x16x32_bf16 v[68:71], a[12:15], v[148:151], v[68:71]
    v_mfma_f32_16x16x32_bf16 v[72:75], a[12:15], v[152:155], v[72:75]
    v_mfma_f32_16x16x32_bf16 v[76:79], a[12:15], v[156:159], v[76:79]
    buffer_load_dwordx4 a[8:11], v5, s[40:43], s28 offen offset:1024 sc1
    s_waitcnt vmcnt(16)
    v_mfma_f32_16x16x32_bf16 v[80:83], a[16:19], v[144:147], v[80:83]
    v_mfma_f32_16x16x32_bf16 v[84:87], a[16:19], v[148:151], v[84:87]
    v_mfma_f32_16x16x32_bf16 v[88:91], a[16:19], v[152:155], v[88:91]
    v_mfma_f32_16x16x32_bf16 v[92:95], a[16:19], v[156:159], v[92:95]
    buffer_load_dwordx4 a[12:15], v5, s[40:43], s28 offen offset:2048 sc1
    s_setprio 3
    s_waitcnt lgkmcnt(0)
    s_barrier
    s_waitcnt vmcnt(16)
    v_mfma_f32_16x16x32_bf16 v[32:35], a[20:23], v[160:163], v[32:35]
    ds_read_b128 v[144:147], v9 offset:4096
    v_mfma_f32_16x16x32_bf16 v[36:39], a[20:23], v[164:167], v[36:39]
    v_mfma_f32_16x16x32_bf16 v[40:43], a[20:23], v[168:171], v[40:43]
    ds_read_b128 v[148:151], v9 offset:5120
    v_mfma_f32_16x16x32_bf16 v[44:47], a[20:23], v[172:175], v[44:47]
    buffer_load_dwordx4 a[16:19], v5, s[40:43], s28 offen offset:3072 sc1
    s_waitcnt vmcnt(16)
    v_mfma_f32_16x16x32_bf16 v[48:51], a[24:27], v[160:163], v[48:51]
    ds_read_b128 v[152:155], v9 offset:6144
    v_mfma_f32_16x16x32_bf16 v[52:55], a[24:27], v[164:167], v[52:55]
    v_mfma_f32_16x16x32_bf16 v[56:59], a[24:27], v[168:171], v[56:59]
    ds_read_b128 v[156:159], v9 offset:7168
    v_mfma_f32_16x16x32_bf16 v[60:63], a[24:27], v[172:175], v[60:63]
    s_mov_b32 s28, 147456
    buffer_load_dwordx4 a[20:23], v5, s[40:43], s28 offen offset:0 sc1
    s_waitcnt vmcnt(16)
    v_mfma_f32_16x16x32_bf16 v[64:67], a[28:31], v[160:163], v[64:67]
    v_mfma_f32_16x16x32_bf16 v[68:71], a[28:31], v[164:167], v[68:71]
    v_mfma_f32_16x16x32_bf16 v[72:75], a[28:31], v[168:171], v[72:75]
    v_mfma_f32_16x16x32_bf16 v[76:79], a[28:31], v[172:175], v[76:79]
    buffer_load_dwordx4 a[24:27], v5, s[40:43], s28 offen offset:1024 sc1
    s_waitcnt vmcnt(16)
    v_mfma_f32_16x16x32_bf16 v[80:83], a[32:35], v[160:163], v[80:83]
    v_mfma_f32_16x16x32_bf16 v[84:87], a[32:35], v[164:167], v[84:87]
    v_mfma_f32_16x16x32_bf16 v[88:91], a[32:35], v[168:171], v[88:91]
    v_mfma_f32_16x16x32_bf16 v[92:95], a[32:35], v[172:175], v[92:95]
    buffer_load_dwordx4 a[28:31], v5, s[40:43], s28 offen offset:2048 sc1
    s_waitcnt vmcnt(16) lgkmcnt(3)
    v_mfma_f32_16x16x32_bf16 v[32:35], a[36:39], v[144:147], v[32:35]
    ds_read_b128 v[160:163], v9 offset:8192
    s_lshr_b32 s24, s21, 1
    s_and_b32 s25, s21, 1
    s_waitcnt lgkmcnt(3)
    v_mfma_f32_16x16x32_bf16 v[36:39], a[36:39], v[148:151], v[36:39]
    s_add_u32 s26, s23, s24
    v_and_b32 v6, 7, v1
    s_waitcnt lgkmcnt(2)
    v_mfma_f32_16x16x32_bf16 v[40:43], a[36:39], v[152:155], v[40:43]
    ds_read_b128 v[164:167], v9 offset:9216
    v_lshrrev_b32 v7, 3, v1
    v_mov_b32 v10, 0x80000000
    s_waitcnt lgkmcnt(2)
    v_mfma_f32_16x16x32_bf16 v[44:47], a[36:39], v[156:159], v[44:47]
    buffer_load_dwordx4 a[32:35], v5, s[40:43], s28 offen offset:3072 sc1
    s_mul_i32 s30, s19, 144
    v_lshl_add_u32 v20, v7, 4, s30
    s_waitcnt vmcnt(16)
    v_mfma_f32_16x16x32_bf16 v[48:51], a[40:43], v[144:147], v[48:51]
    ds_read_b128 v[168:171], v9 offset:10240
    s_lshr_b32 s27, s19, 2
    s_lshl_b32 s27, s27, 2
    v_mfma_f32_16x16x32_bf16 v[52:55], a[40:43], v[148:151], v[52:55]
    s_and_b32 s29, s19, 1
    s_add_u32 s27, s27, s29
    v_mfma_f32_16x16x32_bf16 v[56:59], a[40:43], v[152:155], v[56:59]
    ds_read_b128 v[172:175], v9 offset:11264
    s_bfe_u32 s29, s19, 0x10001
    s_lshl_b32 s29, s29, 3
    v_mfma_f32_16x16x32_bf16 v[60:63], a[40:43], v[156:159], v[60:63]
    s_mov_b32 s28, 151552
    buffer_load_dwordx4 a[36:39], v5, s[40:43], s28 offen offset:0 sc1
    s_mul_i32 s30, s27, 144
    s_add_u32 s30, s30, s29
    s_waitcnt vmcnt(16) lgkmcnt(3)
    v_mfma_f32_16x16x32_bf16 v[32:35], a[44:47], v[160:163], v[32:35]
    ds_read_b128 v[144:147], v9 offset:12288
    s_add_u32 s30, s30, 128
    v_lshrrev_b32 v14, 5, v1
    s_waitcnt lgkmcnt(3)
    v_mfma_f32_16x16x32_bf16 v[36:39], a[44:47], v[164:167], v[36:39]
    v_mul_u32_u24 v21, 288, v14
    v_add_u32 v21, s30, v21
    s_waitcnt lgkmcnt(2)
    v_mfma_f32_16x16x32_bf16 v[40:43], a[44:47], v[168:171], v[40:43]
    ds_read_b128 v[148:151], v9 offset:13312
    v_add_u32 v11, 151808, v20
    v_add_u32 v12, 151808, v21
    s_waitcnt lgkmcnt(2)
    v_mfma_f32_16x16x32_bf16 v[44:47], a[44:47], v[172:175], v[44:47]
    buffer_load_dwordx4 a[40:43], v5, s[40:43], s28 offen offset:1024 sc1
    ds_read_b128 v[120:123], v11
    ds_read_b64 v[124:125], v12
    s_waitcnt vmcnt(16)
    v_mfma_f32_16x16x32_bf16 v[48:51], a[48:51], v[160:163], v[48:51]
    ds_read_b128 v[152:155], v9 offset:14336
    v_and_b32 v13, 24, v1
    v_cmp_eq_u32 s[0:1], 0, v13
    v_mfma_f32_16x16x32_bf16 v[52:55], a[48:51], v[164:167], v[52:55]
    s_nop 0
    v_cndmask_b32 v21, v10, v21, s[0:1]
    v_bfe_u32 v176, v1, 3, 1
    v_mfma_f32_16x16x32_bf16 v[56:59], a[48:51], v[168:171], v[56:59]
    ds_read_b128 v[156:159], v9 offset:15360
    v_cmp_eq_u32 vcc, s25, v176
    s_nop 1
    v_cndmask_b32 v176, v15, v10, vcc
    v_mfma_f32_16x16x32_bf16 v[60:63], a[48:51], v[172:175], v[60:63]
    buffer_load_dwordx4 a[44:47], v5, s[40:43], s28 offen offset:2048 sc1
    s_lshl_b32 s31, s19, 11
    s_lshl_b32 s33, s25, 7
    s_waitcnt vmcnt(16) lgkmcnt(5)
    v_mfma_f32_16x16x32_bf16 v[32:35], a[52:55], v[144:147], v[32:35]
    ds_read_b128 v[160:163], v9 offset:16384
    s_add_u32 s31, s31, s33
    v_lshl_add_u32 v18, v6, 4, s31
    s_waitcnt lgkmcnt(5)
    v_mfma_f32_16x16x32_bf16 v[36:39], a[52:55], v[148:151], v[36:39]
    v_lshl_add_u32 v18, v7, 8, v18
    v_lshrrev_b32 v11, 5, v1
    s_waitcnt lgkmcnt(2)
    v_mfma_f32_16x16x32_bf16 v[40:43], a[52:55], v[152:155], v[40:43]
    ds_read_b128 v[164:167], v9 offset:17408
    v_and_b32 v16, 0xfffffbff, v18
    s_lshr_b32 s31, s21, 2
    s_waitcnt lgkmcnt(2)
    v_mfma_f32_16x16x32_bf16 v[44:47], a[52:55], v[156:159], v[44:47]
    buffer_load_dwordx4 a[48:51], v5, s[40:43], s28 offen offset:3072 sc1
    v_xor_b32 v11, s31, v11
    s_mov_b32 s31, 9437184
    s_waitcnt vmcnt(16)
    v_mfma_f32_16x16x32_bf16 v[48:51], a[56:59], v[144:147], v[48:51]
    ds_read_b128 v[168:171], v9 offset:18432
    v_mad_u32_u24 v16, v11, s31, v16
    v_cmp_gt_u32 vcc, 32, v1
    s_nop 1
    v_cndmask_b32 v177, v16, v10, vcc
    v_mfma_f32_16x16x32_bf16 v[52:55], a[56:59], v[148:151], v[52:55]
    v_mfma_f32_16x16x32_bf16 v[56:59], a[56:59], v[152:155], v[56:59]
    ds_read_b128 v[172:175], v9 offset:19456
    s_lshl_b32 s31, s19, 7
    s_lshl_b32 s32, s25, 10
    v_mfma_f32_16x16x32_bf16 v[60:63], a[56:59], v[156:159], v[60:63]
    s_mov_b32 s28, 155648
    buffer_load_dwordx4 a[52:55], v5, s[40:43], s28 offen offset:0 sc1
    s_add_u32 s31, s31, s32
    s_add_u32 s31, s31, 16384
    s_setprio 2
    s_waitcnt vmcnt(16) lgkmcnt(3)
    v_mfma_f32_16x16x32_bf16 v[32:35], a[60:63], v[160:163], v[32:35]
    ds_read_b128 v[144:147], v9 offset:20480
    v_lshl_add_u32 v17, v6, 4, s31
    s_mov_b32 s31, 2359296
    s_waitcnt lgkmcnt(3)
    v_mfma_f32_16x16x32_bf16 v[36:39], a[60:63], v[164:167], v[36:39]
    v_mad_u32_u24 v17, v7, s31, v17
    s_lshl_b32 s30, s27, 8
    s_waitcnt lgkmcnt(2)
    v_mfma_f32_16x16x32_bf16 v[40:43], a[60:63], v[168:171], v[40:43]
    ds_read_b128 v[148:151], v9 offset:21504
    s_add_u32 s30, s30, s29
    s_add_u32 s30, s30, s33
    s_waitcnt lgkmcnt(2)
    v_mfma_f32_16x16x32_bf16 v[44:47], a[60:63], v[172:175], v[44:47]
    buffer_load_dwordx4 a[56:59], v5, s[40:43], s28 offen offset:1024 sc1
    s_add_u32 s30, s30, 16384
    v_lshl_add_u32 v19, v6, 4, s30
    s_waitcnt vmcnt(16)
    v_mfma_f32_16x16x32_bf16 v[48:51], a[64:67], v[160:163], v[48:51]
    ds_read_b128 v[152:155], v9 offset:22528
    v_lshl_add_u32 v19, v14, 9, v19
    ds_read_b128 v[112:115], v18
    v_mfma_f32_16x16x32_bf16 v[52:55], a[64:67], v[164:167], v[52:55]
    ds_read_b64 v[116:117], v19
    v_cndmask_b32 v19, v10, v19, s[0:1]
    v_mfma_f32_16x16x32_bf16 v[56:59], a[64:67], v[168:171], v[56:59]
    ds_read_b128 v[156:159], v9 offset:23552
    s_mul_i32 s30, s26, 18432
    s_add_u32 s8, s12, 0x14f0000
    s_addc_u32 s9, s13, 0
    v_mfma_f32_16x16x32_bf16 v[60:63], a[64:67], v[172:175], v[60:63]
    buffer_load_dwordx4 a[60:63], v5, s[40:43], s28 offen offset:2048 sc1
    s_add_u32 s8, s8, s30
    s_addc_u32 s9, s9, 0
    s_waitcnt vmcnt(16) lgkmcnt(5)
    v_mfma_f32_16x16x32_bf16 v[32:35], a[68:71], v[144:147], v[32:35]
    ds_read_b128 v[160:163], v9 offset:24576
    s_mov_b32 s10, 0x1200000
    s_waitcnt lgkmcnt(5)
    v_mfma_f32_16x16x32_bf16 v[36:39], a[68:71], v[148:151], v[36:39]
    s_mov_b32 s11, 0x20000
    s_sub_u32 s10, s10, s30
    s_waitcnt lgkmcnt(4)
    v_mfma_f32_16x16x32_bf16 v[40:43], a[68:71], v[152:155], v[40:43]
    ds_read_b128 v[164:167], v9 offset:25600
    s_lshl_b32 s31, s3, 8
    s_add_u32 s31, s31, s23
    s_waitcnt lgkmcnt(2)
    v_mfma_f32_16x16x32_bf16 v[44:47], a[68:71], v[156:159], v[44:47]
    buffer_load_dwordx4 a[64:67], v5, s[40:43], s28 offen offset:3072 sc1
    s_add_u32 s32, s31, s20
    s_lshl_b32 s32, s32, 7
    s_waitcnt vmcnt(16)
    v_mfma_f32_16x16x32_bf16 v[48:51], a[0:3], v[144:147], v[48:51]
    ds_read_b128 v[168:171], v9 offset:26624
    s_add_u32 s56, s12, 0x2718000
    s_addc_u32 s57, s13, 0
    v_mfma_f32_16x16x32_bf16 v[52:55], a[0:3], v[148:151], v[52:55]
    s_add_u32 s56, s56, s32
    s_addc_u32 s57, s57, 0
    v_mfma_f32_16x16x32_bf16 v[56:59], a[0:3], v[152:155], v[56:59]
    ds_read_b128 v[172:175], v9 offset:27648
    s_mov_b32 s58, 0x4040
    s_mov_b32 s59, 0x20000
    v_mfma_f32_16x16x32_bf16 v[60:63], a[0:3], v[156:159], v[60:63]
    s_mov_b32 s28, 159744
    buffer_load_dwordx4 a[68:71], v5, s[40:43], s28 offen offset:0 sc1
    s_lshr_b32 s32, s19, 1
    s_add_u32 s31, s31, s32
    s_waitcnt vmcnt(16) lgkmcnt(3)
    v_mfma_f32_16x16x32_bf16 v[32:35], a[4:7], v[160:163], v[32:35]
    ds_read_b128 v[144:147], v9 offset:28672
    s_lshl_b32 s31, s31, 7
    s_add_u32 s31, s31, 0x2718000
    s_waitcnt lgkmcnt(3)
    v_mfma_f32_16x16x32_bf16 v[36:39], a[4:7], v[164:167], v[36:39]
    s_add_u32 s14, s12, s31
    s_addc_u32 s15, s13, 0
    s_waitcnt lgkmcnt(2)
    v_mfma_f32_16x16x32_bf16 v[40:43], a[4:7], v[168:171], v[40:43]
    ds_read_b128 v[148:151], v9 offset:29696
    s_lshl_b32 s32, s21, 2
    s_add_u32 s32, s32, 0
    s_waitcnt lgkmcnt(2)
    v_mfma_f32_16x16x32_bf16 v[44:47], a[4:7], v[172:175], v[44:47]
    buffer_load_dwordx4 a[0:3], v5, s[40:43], s28 offen offset:1024 sc1
    v_mov_b32 v23, s32
    v_cmp_eq_u32 vcc, 0, v1
    s_nop 1
    v_cndmask_b32 v23, v10, v23, vcc
    s_waitcnt vmcnt(16)
    v_mfma_f32_16x16x32_bf16 v[48:51], a[8:11], v[160:163], v[48:51]
    ds_read_b128 v[152:155], v9 offset:30720
    v_mov_b32 v24, 1
    v_mfma_f32_16x16x32_bf16 v[52:55], a[8:11], v[164:167], v[52:55]
    s_and_b32 s35, s19, 1
    s_xor_b32 s35, s35, 1
    v_mfma_f32_16x16x32_bf16 v[56:59], a[8:11], v[168:171], v[56:59]
    ds_read_b128 v[156:159], v9 offset:31744
    s_lshl_b32 s35, s35, 5
    v_lshlrev_b32 v25, 2, v6
    v_mfma_f32_16x16x32_bf16 v[60:63], a[8:11], v[172:175], v[60:63]
    buffer_load_dwordx4 a[4:7], v5, s[40:43], s28 offen offset:2048 sc1
    v_add_u32 v26, s35, v25
    v_add_u32 v25, 32, v25
    s_waitcnt vmcnt(16) lgkmcnt(3)
    v_mfma_f32_16x16x32_bf16 v[32:35], a[12:15], v[144:147], v[32:35]
    ds_read_b128 v[160:163], v9 offset:32768
    v_cmp_gt_u32 vcc, 8, v1
    s_nop 1
    v_cndmask_b32 v25, v25, v26, vcc
    s_waitcnt lgkmcnt(3)
    v_mfma_f32_16x16x32_bf16 v[36:39], a[12:15], v[148:151], v[36:39]
    v_cmp_gt_u32 vcc, 16, v1
    s_nop 1
    v_cndmask_b32 v25, v10, v25, vcc
    s_waitcnt lgkmcnt(2)
    v_mfma_f32_16x16x32_bf16 v[40:43], a[12:15], v[152:155], v[40:43]
    ds_read_b128 v[164:167], v9 offset:33792
    v_add_u32 v26, 16384, v26
    s_waitcnt lgkmcnt(2)
    v_mfma_f32_16x16x32_bf16 v[44:47], a[12:15], v[156:159], v[44:47]
    buffer_load_dwordx4 a[8:11], v5, s[40:43], s28 offen offset:3072 sc1
    v_cmp_gt_u32 vcc, 8, v1
    s_nop 1
    v_cndmask_b32 v26, v10, v26, vcc
    s_waitcnt vmcnt(16)
    v_mfma_f32_16x16x32_bf16 v[48:51], a[16:19], v[144:147], v[48:51]
    ds_read_b128 v[168:171], v9 offset:34816
    s_add_u32 s34, s35, 16384
    s_mul_i32 s31, s25, 9216
    v_mfma_f32_16x16x32_bf16 v[52:55], a[16:19], v[148:151], v[52:55]
    v_mul_u32_u24 v22, 1152, v6
    v_add_u32 v22, s31, v22
    v_mfma_f32_16x16x32_bf16 v[56:59], a[16:19], v[152:155], v[56:59]
    ds_read_b128 v[172:175], v9 offset:35840
    v_add_u32 v20, v20, v22
    v_add_u32 v21, v21, v22
    v_mfma_f32_16x16x32_bf16 v[60:63], a[16:19], v[156:159], v[60:63]
    s_mov_b32 s28, 163840
    buffer_load_dwordx4 a[12:15], v5, s[40:43], s28 offen offset:0 sc1
    s_cmp_eq_u32 s3, 0
    s_cselect_b64 vcc, -1, 0
    v_cndmask_b32 v20, v20, v18, vcc
    v_cndmask_b32 v21, v21, v19, vcc
    s_setprio 1
    s_waitcnt vmcnt(16) lgkmcnt(3)
    v_mfma_f32_16x16x32_bf16 v[32:35], a[20:23], v[160:163], v[32:35]
    ds_read_b128 v[144:147], v9 offset:4096
    s_waitcnt lgkmcnt(3)
    v_mfma_f32_16x16x32_bf16 v[36:39], a[20:23], v[164:167], v[36:39]
    s_lshr_b32 s31, s19, 1
    s_lshl_b32 s31, s31, 8
    s_waitcnt lgkmcnt(2)
    v_mfma_f32_16x16x32_bf16 v[40:43], a[20:23], v[168:171], v[40:43]
    ds_read_b128 v[148:151], v9 offset:5120
    s_and_b32 s32, s19, 1
    s_lshl_b32 s32, s32, 3
    s_waitcnt lgkmcnt(2)
    v_mfma_f32_16x16x32_bf16 v[44:47], a[20:23], v[172:175], v[44:47]
    buffer_load_dwordx4 a[16:19], v5, s[40:43], s28 offen offset:1024 sc1
    s_add_u32 s31, s31, s32
    s_add_u32 s31, s31, s33
    s_waitcnt vmcnt(16)
    v_mfma_f32_16x16x32_bf16 v[48:51], a[24:27], v[160:163], v[48:51]
    ds_read_b128 v[152:155], v9 offset:6144
    v_lshl_add_u32 v22, v6, 4, s31
    v_cmp_gt_u32 vcc, 8, v1
    s_nop 1
    v_cndmask_b32 v22, v10, v22, vcc
    v_mfma_f32_16x16x32_bf16 v[52:55], a[24:27], v[164:167], v[52:55]
    v_mfma_f32_16x16x32_bf16 v[56:59], a[24:27], v[168:171], v[56:59]
    ds_read_b128 v[156:159], v9 offset:7168
    s_mov_b32 s16, 0xffff0000
    s_mov_b32 s17, 0x3f80
    v_mfma_f32_16x16x32_bf16 v[60:63], a[24:27], v[172:175], v[60:63]
    s_mov_b32 s18, 0x3f800000
    v_lshlrev_b32 v128, 16, v112
    s_waitcnt vmcnt(15) lgkmcnt(3)
    v_mfma_f32_16x16x32_bf16 v[64:67], a[28:31], v[144:147], v[64:67]
    ds_read_b128 v[160:163], v9 offset:8192
    v_cvt_pk_bf16_f32 v32, v32, v33
    s_waitcnt lgkmcnt(3)
    v_mfma_f32_16x16x32_bf16 v[68:71], a[28:31], v[148:151], v[68:71]
    v_cvt_pk_bf16_f32 v33, v34, v35
    v_cvt_pk_bf16_f32 v34, v48, v49
    s_waitcnt lgkmcnt(2)
    v_mfma_f32_16x16x32_bf16 v[72:75], a[28:31], v[152:155], v[72:75]
    ds_read_b128 v[164:167], v9 offset:9216
    v_cvt_pk_bf16_f32 v35, v50, v51
    s_waitcnt lgkmcnt(2)
    v_mfma_f32_16x16x32_bf16 v[76:79], a[28:31], v[156:159], v[76:79]
    buffer_store_dwordx4 v[32:35], v176, s[4:7], s44 offen offset:2048 sc1
    s_waitcnt vmcnt(15)
    v_mfma_f32_16x16x32_bf16 v[80:83], a[32:35], v[144:147], v[80:83]
    ds_read_b128 v[168:171], v9 offset:10240
    ds_write_b128 v15, v[32:35] offset:21504
    v_mfma_f32_16x16x32_bf16 v[84:87], a[32:35], v[148:151], v[84:87]
    v_mfma_f32_16x16x32_bf16 v[88:91], a[32:35], v[152:155], v[88:91]
    ds_read_b128 v[172:175], v9 offset:11264
    v_cvt_pk_bf16_f32 v36, v36, v37
    v_mfma_f32_16x16x32_bf16 v[92:95], a[32:35], v[156:159], v[92:95]
    v_cvt_pk_bf16_f32 v37, v38, v39
    v_cvt_pk_bf16_f32 v38, v52, v53
    s_waitcnt vmcnt(14) lgkmcnt(4)
    v_mfma_f32_16x16x32_bf16 v[64:67], a[36:39], v[160:163], v[64:67]
    ds_read_b128 v[144:147], v9 offset:12288
    v_cvt_pk_bf16_f32 v39, v54, v55
    s_waitcnt lgkmcnt(4)
    v_mfma_f32_16x16x32_bf16 v[68:71], a[36:39], v[164:167], v[68:71]
    buffer_store_dwordx4 v[36:39], v15, s[4:7], s45 offen offset:2048 sc1
    s_waitcnt lgkmcnt(3)
    v_mfma_f32_16x16x32_bf16 v[72:75], a[36:39], v[168:171], v[72:75]
    ds_read_b128 v[148:151], v9 offset:13312
    v_cvt_pk_bf16_f32 v40, v40, v41
    s_waitcnt lgkmcnt(2)
    v_mfma_f32_16x16x32_bf16 v[76:79], a[36:39], v[172:175], v[76:79]
    v_cvt_pk_bf16_f32 v41, v42, v43
    v_cvt_pk_bf16_f32 v42, v56, v57
    s_waitcnt vmcnt(14)
    v_mfma_f32_16x16x32_bf16 v[80:83], a[40:43], v[160:163], v[80:83]
    ds_read_b128 v[152:155], v9 offset:14336
    v_cvt_pk_bf16_f32 v43, v58, v59
    v_mfma_f32_16x16x32_bf16 v[84:87], a[40:43], v[164:167], v[84:87]
    buffer_store_dwordx4 v[40:43], v15, s[4:7], s46 offen offset:2048 sc1
    v_mfma_f32_16x16x32_bf16 v[88:91], a[40:43], v[168:171], v[88:91]
    ds_read_b128 v[156:159], v9 offset:15360
    v_cvt_pk_bf16_f32 v44, v44, v45
    v_mfma_f32_16x16x32_bf16 v[92:95], a[40:43], v[172:175], v[92:95]
    v_cvt_pk_bf16_f32 v45, v46, v47
    v_cvt_pk_bf16_f32 v46, v60, v61
    s_waitcnt vmcnt(14) lgkmcnt(3)
    v_mfma_f32_16x16x32_bf16 v[64:67], a[44:47], v[144:147], v[64:67]
    ds_read_b128 v[160:163], v9 offset:16384
    v_cvt_pk_bf16_f32 v47, v62, v63
    s_waitcnt lgkmcnt(3)
    v_mfma_f32_16x16x32_bf16 v[68:71], a[44:47], v[148:151], v[68:71]
    buffer_store_dwordx4 v[44:47], v15, s[4:7], s47 offen offset:2048 sc1
    s_waitcnt lgkmcnt(2)
    v_mfma_f32_16x16x32_bf16 v[72:75], a[44:47], v[152:155], v[72:75]
    ds_read_b128 v[164:167], v9 offset:17408
    v_and_b32 v129, s16, v112
    v_lshlrev_b32 v130, 16, v113
    s_waitcnt lgkmcnt(2)
    v_mfma_f32_16x16x32_bf16 v[76:79], a[44:47], v[156:159], v[76:79]
    v_and_b32 v131, s16, v113
    s_waitcnt vmcnt(14)
    v_mfma_f32_16x16x32_bf16 v[80:83], a[48:51], v[144:147], v[80:83]
    ds_read_b128 v[168:171], v9 offset:18432
    v_lshlrev_b32 v132, 16, v114
    v_and_b32 v133, s16, v114
    v_mfma_f32_16x16x32_bf16 v[84:87], a[48:51], v[148:151], v[84:87]
    v_lshlrev_b32 v134, 16, v115
    v_mfma_f32_16x16x32_bf16 v[88:91], a[48:51], v[152:155], v[88:91]
    ds_read_b128 v[172:175], v9 offset:19456
    v_and_b32 v135, s16, v115
    v_lshlrev_b32 v28, 16, v116
    v_mfma_f32_16x16x32_bf16 v[92:95], a[48:51], v[156:159], v[92:95]
    v_and_b32 v29, s16, v116
    s_waitcnt vmcnt(13) lgkmcnt(3)
    v_mfma_f32_16x16x32_bf16 v[64:67], a[52:55], v[160:163], v[64:67]
    ds_read_b128 v[144:147], v9 offset:20480
    v_lshlrev_b32 v30, 16, v117
    v_and_b32 v31, s16, v117
    s_waitcnt lgkmcnt(3)
    v_mfma_f32_16x16x32_bf16 v[68:71], a[52:55], v[164:167], v[68:71]
    v_dot2c_f32_bf16 v128, s17, v120
    s_waitcnt lgkmcnt(2)
    v_mfma_f32_16x16x32_bf16 v[72:75], a[52:55], v[168:171], v[72:75]
    ds_read_b128 v[148:151], v9 offset:21504
    v_dot2c_f32_bf16 v129, s18, v120
    v_dot2c_f32_bf16 v130, s17, v121
    s_waitcnt lgkmcnt(2)
    v_mfma_f32_16x16x32_bf16 v[76:79], a[52:55], v[172:175], v[76:79]
    v_dot2c_f32_bf16 v131, s18, v121
    s_waitcnt vmcnt(12)
    v_mfma_f32_16x16x32_bf16 v[80:83], a[56:59], v[160:163], v[80:83]
    ds_read_b128 v[152:155], v9 offset:22528
    v_dot2c_f32_bf16 v132, s17, v122
    v_dot2c_f32_bf16 v133, s18, v122
    v_mfma_f32_16x16x32_bf16 v[84:87], a[56:59], v[164:167], v[84:87]
    v_dot2c_f32_bf16 v134, s17, v123
    v_mfma_f32_16x16x32_bf16 v[88:91], a[56:59], v[168:171], v[88:91]
    ds_read_b128 v[156:159], v9 offset:23552
    v_dot2c_f32_bf16 v135, s18, v123
    v_dot2c_f32_bf16 v28, s17, v124
    v_mfma_f32_16x16x32_bf16 v[92:95], a[56:59], v[172:175], v[92:95]
    v_dot2c_f32_bf16 v29, s18, v124
    s_setprio 0
    s_waitcnt vmcnt(11) lgkmcnt(3)
    v_mfma_f32_16x16x32_bf16 v[64:67], a[60:63], v[144:147], v[64:67]
    ds_read_b128 v[160:163], v9 offset:24576
    v_dot2c_f32_bf16 v30, s17, v125
    v_dot2c_f32_bf16 v31, s18, v125
    s_waitcnt lgkmcnt(3)
    v_mfma_f32_16x16x32_bf16 v[68:71], a[60:63], v[148:151], v[68:71]
    v_mov_b32 v11, 0
    s_waitcnt lgkmcnt(2)
    v_mfma_f32_16x16x32_bf16 v[72:75], a[60:63], v[152:155], v[72:75]
    ds_read_b128 v[164:167], v9 offset:25600
    v_cmp_gt_u32 s[52:53], 32, v1
    s_nop 1
    v_cndmask_b32 v136, v128, v11, s[52:53]
    s_waitcnt lgkmcnt(2)
    v_mfma_f32_16x16x32_bf16 v[76:79], a[60:63], v[156:159], v[76:79]
    v_cndmask_b32 v137, v129, v11, s[52:53]
    s_waitcnt vmcnt(10)
    v_mfma_f32_16x16x32_bf16 v[80:83], a[64:67], v[144:147], v[80:83]
    ds_read_b128 v[168:171], v9 offset:26624
    v_cndmask_b32 v138, v130, v11, s[52:53]
    v_mfma_f32_16x16x32_bf16 v[84:87], a[64:67], v[148:151], v[84:87]
    v_cndmask_b32 v139, v131, v11, s[52:53]
    v_mfma_f32_16x16x32_bf16 v[88:91], a[64:67], v[152:155], v[88:91]
    ds_read_b128 v[172:175], v9 offset:27648
    v_cndmask_b32 v140, v132, v11, s[52:53]
    v_mfma_f32_16x16x32_bf16 v[92:95], a[64:67], v[156:159], v[92:95]
    v_cndmask_b32 v141, v133, v11, s[52:53]
    v_cndmask_b32 v142, v134, v11, s[52:53]
    v_cndmask_b32 v143, v135, v11, s[52:53]
    v_cndmask_b32 v128, v11, v128, s[52:53]
    v_cndmask_b32 v129, v11, v129, s[52:53]
    v_cndmask_b32 v130, v11, v130, s[52:53]
    v_cndmask_b32 v131, v11, v131, s[52:53]
    v_cndmask_b32 v132, v11, v132, s[52:53]
    v_cndmask_b32 v133, v11, v133, s[52:53]
    v_cndmask_b32 v134, v11, v134, s[52:53]
    v_cndmask_b32 v135, v11, v135, s[52:53]
    s_waitcnt vmcnt(0)
    buffer_store_dword v24, v23, s[56:59], 0 offen sc1
    s_waitcnt lgkmcnt(3)
    v_mfma_f32_16x16x32_bf16 v[64:67], a[68:71], v[160:163], v[64:67]
    ds_read_b128 v[144:147], v9 offset:28672
    s_waitcnt lgkmcnt(3)
    v_mfma_f32_16x16x32_bf16 v[68:71], a[68:71], v[164:167], v[68:71]
    s_waitcnt lgkmcnt(2)
    v_mfma_f32_16x16x32_bf16 v[72:75], a[68:71], v[168:171], v[72:75]
    ds_read_b128 v[148:151], v9 offset:29696
    s_waitcnt lgkmcnt(2)
    v_mfma_f32_16x16x32_bf16 v[76:79], a[68:71], v[172:175], v[76:79]
    v_mfma_f32_16x16x32_bf16 v[80:83], a[0:3], v[160:163], v[80:83]
    ds_read_b128 v[152:155], v9 offset:30720
    v_mfma_f32_16x16x32_bf16 v[84:87], a[0:3], v[164:167], v[84:87]
    v_mfma_f32_16x16x32_bf16 v[88:91], a[0:3], v[168:171], v[88:91]
    ds_read_b128 v[156:159], v9 offset:31744
    v_mfma_f32_16x16x32_bf16 v[92:95], a[0:3], v[172:175], v[92:95]
    s_waitcnt lgkmcnt(3)
    v_mfma_f32_16x16x32_bf16 v[64:67], a[4:7], v[144:147], v[64:67]
    ds_read_b128 v[160:163], v9 offset:32768
    s_waitcnt lgkmcnt(3)
    v_mfma_f32_16x16x32_bf16 v[68:71], a[4:7], v[148:151], v[68:71]
    s_waitcnt lgkmcnt(2)
    v_mfma_f32_16x16x32_bf16 v[72:75], a[4:7], v[152:155], v[72:75]
    ds_read_b128 v[164:167], v9 offset:33792
    s_waitcnt lgkmcnt(2)
    v_mfma_f32_16x16x32_bf16 v[76:79], a[4:7], v[156:159], v[76:79]
    v_mfma_f32_16x16x32_bf16 v[80:83], a[8:11], v[144:147], v[80:83]
    ds_read_b128 v[168:171], v9 offset:34816
    v_mfma_f32_16x16x32_bf16 v[84:87], a[8:11], v[148:151], v[84:87]
    v_mfma_f32_16x16x32_bf16 v[88:91], a[8:11], v[152:155], v[88:91]
    ds_read_b128 v[172:175], v9 offset:35840
    v_mfma_f32_16x16x32_bf16 v[92:95], a[8:11], v[156:159], v[92:95]
    s_waitcnt lgkmcnt(3)
    v_mfma_f32_16x16x32_bf16 v[64:67], a[12:15], v[160:163], v[64:67]
    s_waitcnt lgkmcnt(2)
    v_mfma_f32_16x16x32_bf16 v[68:71], a[12:15], v[164:167], v[68:71]
    s_waitcnt lgkmcnt(1)
    v_mfma_f32_16x16x32_bf16 v[72:75], a[12:15], v[168:171], v[72:75]
    s_waitcnt lgkmcnt(0)
    v_mfma_f32_16x16x32_bf16 v[76:79], a[12:15], v[172:175], v[76:79]
    v_mfma_f32_16x16x32_bf16 v[80:83], a[16:19], v[160:163], v[80:83]
    v_mfma_f32_16x16x32_bf16 v[84:87], a[16:19], v[164:167], v[84:87]
    v_mfma_f32_16x16x32_bf16 v[88:91], a[16:19], v[168:171], v[88:91]
    v_mfma_f32_16x16x32_bf16 v[92:95], a[16:19], v[172:175], v[92:95]
    v_cvt_pk_bf16_f32 v64, v64, v65
    v_cvt_pk_bf16_f32 v65, v66, v67
    s_nop 2
    v_cvt_pk_bf16_f32 v66, v80, v81
    v_cvt_pk_bf16_f32 v67, v82, v83
    buffer_store_dwordx4 v[64:67], v176, s[4:7], s44 offen offset:3072 sc1
    ds_write_b128 v15, v[64:67] offset:22528
    v_cvt_pk_bf16_f32 v68, v68, v69
    v_cvt_pk_bf16_f32 v69, v70, v71
    v_cvt_pk_bf16_f32 v70, v84, v85
    v_cvt_pk_bf16_f32 v71, v86, v87
    buffer_store_dwordx4 v[68:71], v15, s[4:7], s45 offen offset:3072 sc1
    v_cvt_pk_bf16_f32 v72, v72, v73
    v_cvt_pk_bf16_f32 v73, v74, v75
    v_cvt_pk_bf16_f32 v74, v88, v89
    v_cvt_pk_bf16_f32 v75, v90, v91
    buffer_store_dwordx4 v[72:75], v15, s[4:7], s46 offen offset:3072 sc1
    v_cvt_pk_bf16_f32 v76, v76, v77
    v_cvt_pk_bf16_f32 v77, v78, v79
    v_cvt_pk_bf16_f32 v78, v92, v93
    v_cvt_pk_bf16_f32 v79, v94, v95
    buffer_store_dwordx4 v[76:79], v15, s[4:7], s47 offen offset:3072 sc1
    s_branch .L_mlp_red
.L_mlp_B:
    s_waitcnt lgkmcnt(0)
    s_barrier
    s_mov_b32 s52, s48
    s_mov_b32 s53, s49
    s_mov_b32 s54, 0x480
    s_mov_b32 s55, 0x20000
    s_waitcnt vmcnt(10)
    buffer_load_dwordx4 v[32:35], v5, s[52:55], 0 offen offset:0
    s_waitcnt vmcnt(10)
    buffer_load_dwordx4 v[36:39], v5, s[52:55], 0 offen offset:1024
    s_mov_b32 s54, s98
    s_and_b32 s21, s2, 6
    s_bfe_u32 s23, s2, 0x10003
    s_add_u32 s21, s21, s23
    s_and_b32 s22, s2, 1
    s_lshl_b32 s22, s22, 4
    s_lshr_b32 s23, s2, 4
    s_add_u32 s22, s22, s23
    s_lshl_b32 s23, s22, 2
    s_lshl_b32 s27, s21, 3
    s_add_u32 s27, s27, s19
    s_mul_i32 s27, s27, 165888
    s_add_u32 s40, s12, s27
    s_addc_u32 s41, s13, 0
    s_mov_b32 s42, 0x28800
    s_mov_b32 s43, 0x20000
    buffer_load_dwordx4 a[0:3], v5, s[40:43], 0 offen offset:0
    buffer_load_dwordx4 a[4:7], v5, s[40:43], 0 offen offset:1024
    buffer_load_dwordx4 a[8:11], v5, s[40:43], 0 offen offset:2048
    buffer_load_dwordx4 a[12:15], v5, s[40:43], 0 offen offset:3072
    s_mov_b32 s28, 4096
    buffer_load_dwordx4 a[16:19], v5, s[40:43], s28 offen offset:0
    buffer_load_dwordx4 a[20:23], v5, s[40:43], s28 offen offset:1024
    buffer_load_dwordx4 a[24:27], v5, s[40:43], s28 offen offset:2048
    buffer_load_dwordx4 a[28:31], v5, s[40:43], s28 offen offset:3072
    s_mov_b32 s28, 8192
    buffer_load_dwordx4 a[32:35], v5, s[40:43], s28 offen offset:0
    buffer_load_dwordx4 a[36:39], v5, s[40:43], s28 offen offset:1024
    buffer_load_dwordx4 a[40:43], v5, s[40:43], s28 offen offset:2048
    buffer_load_dwordx4 a[44:47], v5, s[40:43], s28 offen offset:3072
    s_mov_b32 s28, 12288
    buffer_load_dwordx4 a[48:51], v5, s[40:43], s28 offen offset:0
    buffer_load_dwordx4 a[52:55], v5, s[40:43], s28 offen offset:1024
    buffer_load_dwordx4 a[56:59], v5, s[40:43], s28 offen offset:2048
    buffer_load_dwordx4 a[60:63], v5, s[40:43], s28 offen offset:3072
    s_mov_b32 s28, 16384
    buffer_load_dwordx4 a[64:67], v5, s[40:43], s28 offen offset:0
    buffer_load_dwordx4 a[68:71], v5, s[40:43], s28 offen offset:1024
    v_mov_b32 v8, 0x80000000
    v_cmp_gt_u32 vcc, 32, v1
    s_nop 1
    v_cndmask_b32 v6, v8, v5, vcc
    s_mul_i32 s29, s21, 18432
    s_add_u32 s36, s12, 0xa20000
    s_addc_u32 s37, s13, 0
    s_add_u32 s36, s36, s29
    s_addc_u32 s37, s37, 0
    s_mov_b32 s38, 0x4800
    s_mov_b32 s39, 0x20000
    s_lshl_b32 s29, s20, 11
    s_add_u32 s29, s29, 1024
    s_add_u32 s33, s29, 10240
    s_lshl_b32 s35, s20, 9
    s_add_u32 s35, s35, 8192
    v_add_u32 v7, 38912, v5
    v_add_u32 v8, 77824, v5
    v_add_u32 v9, 114688, v5
    s_lshl_b32 s32, s20, 13
    s_add_u32 s32, s32, 4096
    v_add_u32 v10, s32, v8
    s_add_u32 s56, s12, 0x2717000
    s_addc_u32 s57, s13, 0
    s_mov_b32 s58, 0x400
    s_mov_b32 s59, 0x20000
    s_lshl_b32 s34, s21, 7
    s_mul_i32 s25, s2, 3641
    s_lshr_b32 s25, s25, 16
    s_mul_i32 s24, s25, 18
    s_sub_u32 s24, s2, s24
    s_lshl_b32 s26, s25, 7
    s_lshl_b32 s31, s24, 2
    s_add_u32 s26, s26, s31
    v_mov_b32 v4, s26
    v_mov_b32 v102, 0x80000000
    v_cmp_eq_u32 vcc, 256, v0
    s_nop 1
    v_cndmask_b32 v102, v102, v4, vcc
    v_mov_b32 v103, 1
    s_lshl_b32 s25, s25, 3
    s_add_u32 s25, s25, s20
    s_mul_i32 s25, s25, 165888
    s_cmp_eq_u32 s54, 0
    s_cselect_b32 s25, 0, s25
    s_cselect_b32 s62, 0, 829440
    s_add_u32 s60, s12, s25
    s_addc_u32 s61, s13, 0
    s_mov_b32 s63, 0x20000
    s_mul_i32 s14, s24, 5120
    s_add_u32 s14, s14, 73728
    s_lshl_b32 s16, s24, 12
    s_add_u32 s16, s16, 92160
    s_add_u32 s18, s14, 4096
    s_lshl_b32 s15, s24, 11
    s_add_u32 s15, s15, 112640
    s_lshl_b32 s17, s24, 10
    s_add_u32 s17, s17, 114688
    s_mov_b32 s26, 16384
    s_cmp_lt_u32 s24, 10
    s_cselect_b32 s14, s14, s15
    s_cselect_b32 s16, s16, s15
    s_cselect_b32 s18, s18, s17
    s_cselect_b32 s26, 2048, s26
    s_add_u32 s14, s14, 663552
    s_add_u32 s18, s18, 663552
    s_add_u32 s15, s14, s26
    s_add_u32 s17, s16, s26
    v_lshrrev_b32 v4, 2, v3
    v_lshl_add_u32 v4, v2, 2, v4
    v_mul_u32_u24 v4, 1152, v4
    v_and_b32 v12, 3, v3
    s_mul_i32 s26, s20, 288
    s_add_u32 s26, s26, 77824
    v_add_u32 v100, s26, v4
    v_lshl_add_u32 v100, v12, 4, v100
    s_lshr_b32 s25, s20, 1
    s_mul_i32 s25, s25, 576
    s_and_b32 s24, s20, 1
    s_lshl_b32 s24, s24, 3
    s_add_u32 s25, s25, s24
    s_add_u32 s25, s25, 77952
    v_mul_u32_u24 v12, 144, v12
    v_add3_u32 v101, v12, v4, s25
    s_mul_i32 s26, s20, 9216
    s_add_u32 s26, s26, 77824
    v_add_u32 v104, s26, v5
    s_lshr_b32 s24, s21, 1
    s_xor_b32 s24, s24, s20
    s_add_u32 s24, s23, s24
    s_lshl_b32 s25, s24, 10
    s_add_u32 s4, s12, 0x11c0000
    s_addc_u32 s5, s13, 0
    s_add_u32 s4, s4, s25
    s_addc_u32 s5, s5, 0
    s_mov_b32 s6, 0x400
    s_mov_b32 s7, 0x20000
    s_mul_i32 s30, s20, 19456
    s_mul_i32 s26, s24, 18432
    s_sub_u32 s26, s26, s30
    s_add_u32 s26, s26, 0xf60000
    s_add_u32 s8, s12, s26
    s_addc_u32 s9, s13, 0
    s_mov_b32 s10, 0x0
    s_mov_b32 s11, 0x20000
    s_add_u32 s10, s30, 18432
    s_lshl_b32 s25, s3, 7
    s_add_u32 s25, s25, s24
    s_lshl_b32 s25, s25, 7
    s_add_u32 s52, s12, 0x270f000
    s_addc_u32 s53, s13, 0
    s_add_u32 s52, s52, s25
    s_addc_u32 s53, s53, 0
    s_mov_b32 s54, 0x20
    s_mov_b32 s55, 0x20000
    v_lshlrev_b32 v29, 2, v1
    s_add_u32 s32, s30, 18432
    v_add_u32 v13, s32, v5
    s_lshl_b32 s32, s20, 6
    s_add_u32 s32, s32, 151552
    v_lshl_add_u32 v14, v3, 2, s32
    s_barrier
    s_mov_b32 s32, 0x40000
.L_mlp_xp:
    buffer_load_dword v30, v29, s[52:55], 0 offen sc1
    s_waitcnt vmcnt(0)
    v_cmp_ne_u32 vcc, 0, v30
    s_sub_u32 s32, s32, 1
    s_cbranch_scc1 .L_mlp_xpx
    s_cmp_lg_u32 vcc_lo, 0xff
    s_cbranch_scc1 .L_mlp_xp
.L_mlp_xpx:
    s_waitcnt vmcnt(0)
    buffer_load_dwordx4 v[28:31], v5, s[4:7], 0 offen sc1
    s_add_u32 m0, s30, 0
    s_nop 0
    buffer_load_dwordx4 v5, s[8:11], m0 offen offset:0 sc1 lds
    buffer_load_dwordx4 v5, s[8:11], m0 offen offset:1024 sc1 lds
    buffer_load_dwordx4 v5, s[8:11], m0 offen offset:2048 sc1 lds
    s_add_u32 m0, s30, 3072
    s_nop 0
    buffer_load_dwordx4 v5, s[8:11], m0 offen offset:0 sc1 lds
    buffer_load_dwordx4 v5, s[8:11], m0 offen offset:1024 sc1 lds
    buffer_load_dwordx4 v5, s[8:11], m0 offen offset:2048 sc1 lds
    s_add_u32 m0, s30, 6144
    s_nop 0
    buffer_load_dwordx4 v5, s[8:11], m0 offen offset:0 sc1 lds
    buffer_load_dwordx4 v5, s[8:11], m0 offen offset:1024 sc1 lds
    buffer_load_dwordx4 v5, s[8:11], m0 offen offset:2048 sc1 lds
    ds_write_b128 v104, v[64:67] offset:0
    ds_write_b128 v104, v[68:71] offset:1024
    ds_write_b128 v104, v[72:75] offset:2048
    ds_write_b128 v104, v[76:79] offset:3072
    ds_write_b128 v104, v[80:83] offset:4096
    ds_write_b128 v104, v[84:87] offset:5120
    ds_write_b128 v104, v[88:91] offset:6144
    ds_write_b128 v104, v[92:95] offset:7168
    ds_write_b128 v104, v[96:99] offset:8192
    v_add_u32 v4, 151808, v5
    ds_write_b128 v4, v[32:35] offset:0
    ds_write_b128 v4, v[36:39] offset:1024
    s_waitcnt vmcnt(6)
    s_waitcnt lgkmcnt(0)
    s_barrier
    ds_read_b128 v[144:147], v5 offset:0
    ds_read_b128 v[148:151], v5 offset:19456
    ds_read_b128 v[152:155], v7 offset:0
    ds_read_b128 v[156:159], v7 offset:19456
    s_setprio 3
    s_add_u32 m0, s30, 9216
    s_nop 0
    buffer_load_dwordx4 v5, s[8:11], m0 offen offset:0 sc1 lds
    buffer_load_dwordx4 v5, s[8:11], m0 offen offset:1024 sc1 lds
    buffer_load_dwordx4 v5, s[8:11], m0 offen offset:2048 sc1 lds
    s_waitcnt lgkmcnt(3)
    v_mfma_f32_16x16x32_bf16 v[32:35], a[0:3], v[144:147], 0
    ds_read_b128 v[160:163], v5 offset:1024
    v_add_f32 v28, v28, v30
    v_add_f32 v29, v29, v31
    s_waitcnt lgkmcnt(3)
    v_mfma_f32_16x16x32_bf16 v[36:39], a[0:3], v[148:151], 0
    v_mov_b32 v30, v28
    s_waitcnt lgkmcnt(2)
    v_mfma_f32_16x16x32_bf16 v[40:43], a[0:3], v[152:155], 0
    ds_read_b128 v[164:167], v5 offset:20480
    v_permlane32_swap_b32 v28, v30
    v_add_f32 v28, v28, v30
    s_waitcnt lgkmcnt(2)
    v_mfma_f32_16x16x32_bf16 v[44:47], a[0:3], v[156:159], 0
    v_mov_b32 v30, v28
    v_mfma_f32_16x16x32_bf16 v[48:51], a[4:7], v[144:147], 0
    ds_read_b128 v[168:171], v7 offset:1024
    v_permlane16_swap_b32 v28, v30
    v_add_f32 v28, v28, v30
    v_mfma_f32_16x16x32_bf16 v[52:55], a[4:7], v[148:151], 0
    v_mov_b32 v31, v29
    v_mfma_f32_16x16x32_bf16 v[56:59], a[4:7], v[152:155], 0
    ds_read_b128 v[172:175], v7 offset:20480
    v_permlane32_swap_b32 v29, v31
    v_add_f32 v29, v29, v31
    v_mfma_f32_16x16x32_bf16 v[60:63], a[4:7], v[156:159], 0
    buffer_load_dwordx4 a[0:3], v5, s[40:43], s28 offen offset:2048
    v_mov_b32 v31, v29
    s_setprio 1
    s_add_u32 m0, s30, 12288
    s_nop 0
    buffer_load_dwordx4 v5, s[8:11], m0 offen offset:0 sc1 lds
    buffer_load_dwordx4 v5, s[8:11], m0 offen offset:1024 sc1 lds
    buffer_load_dwordx4 v5, s[8:11], m0 offen offset:2048 sc1 lds
    s_waitcnt lgkmcnt(3)
    v_mfma_f32_16x16x32_bf16 v[32:35], a[8:11], v[160:163], v[32:35]
    ds_read_b128 v[144:147], v5 offset:2048
    v_permlane16_swap_b32 v29, v31
    v_add_f32 v29, v29, v31
    s_waitcnt lgkmcnt(3)
    v_mfma_f32_16x16x32_bf16 v[36:39], a[8:11], v[164:167], v[36:39]
    v_mul_f32 v28, 0xbae38e39, v28
    s_waitcnt lgkmcnt(2)
    v_mfma_f32_16x16x32_bf16 v[40:43], a[8:11], v[168:171], v[40:43]
    ds_read_b128 v[148:151], v5 offset:21504
    v_mul_f32 v29, 0x3ae38e39, v29
    s_waitcnt lgkmcnt(2)
    v_mfma_f32_16x16x32_bf16 v[44:47], a[8:11], v[172:175], v[44:47]
    buffer_load_dwordx4 a[4:7], v5, s[40:43], s28 offen offset:3072
    v_fma_f32 v29, -v28, v28, v29
    v_max_f32 v29, 0, v29
    v_mfma_f32_16x16x32_bf16 v[48:51], a[12:15], v[160:163], v[48:51]
    ds_read_b128 v[152:155], v7 offset:2048
    v_add_f32 v30, 0x3727c5ac, v29
    v_mfma_f32_16x16x32_bf16 v[52:55], a[12:15], v[164:167], v[52:55]
    v_rsq_f32 v30, v30
    v_mfma_f32_16x16x32_bf16 v[56:59], a[12:15], v[168:171], v[56:59]
    ds_read_b128 v[156:159], v7 offset:21504
    v_mul_f32 v29, v29, v30
    v_mfma_f32_16x16x32_bf16 v[60:63], a[12:15], v[172:175], v[60:63]
    s_mov_b32 s28, 20480
    buffer_load_dwordx4 a[8:11], v5, s[40:43], s28 offen offset:0
    v_mul_f32 v29, v29, v30
    v_add_f32 v29, 0x3727c5ac, v29
    s_setprio 3
    s_waitcnt vmcnt(12)
    s_barrier
    s_add_u32 m0, s30, 15360
    s_nop 0
    buffer_load_dwordx4 v5, s[8:11], m0 offen offset:0 sc1 lds
    buffer_load_dwordx4 v5, s[8:11], m0 offen offset:1024 sc1 lds
    buffer_load_dwordx4 v5, s[8:11], m0 offen offset:2048 sc1 lds
    s_waitcnt lgkmcnt(3)
    v_mfma_f32_16x16x32_bf16 v[32:35], a[16:19], v[144:147], v[32:35]
    ds_read_b128 v[160:163], v5 offset:3072
    v_rsq_f32 v29, v29
    s_waitcnt lgkmcnt(3)
    v_mfma_f32_16x16x32_bf16 v[36:39], a[16:19], v[148:151], v[36:39]
    v_mul_f32 v30, v30, v29
    s_waitcnt lgkmcnt(2)
    v_mfma_f32_16x16x32_bf16 v[40:43], a[16:19], v[152:155], v[40:43]
    ds_read_b128 v[164:167], v5 offset:22528
    ds_write_b32 v14, v30 offset:0
    s_waitcnt lgkmcnt(3)
    v_mfma_f32_16x16x32_bf16 v[44:47], a[16:19], v[156:159], v[44:47]
    buffer_load_dwordx4 a[12:15], v5, s[40:43], s28 offen offset:1024
    v_rcp_f32 v29, v30
    v_mfma_f32_16x16x32_bf16 v[48:51], a[20:23], v[144:147], v[48:51]
    ds_read_b128 v[168:171], v7 offset:3072
    v_cvt_pk_bf16_f32 v31, v28, v28
    v_mfma_f32_16x16x32_bf16 v[52:55], a[20:23], v[148:151], v[52:55]
    v_lshlrev_b32 v31, 16, v31
    v_sub_f32 v31, v28, v31
    v_mfma_f32_16x16x32_bf16 v[56:59], a[20:23], v[152:155], v[56:59]
    ds_read_b128 v[172:175], v7 offset:22528
    v_cvt_pk_bf16_f32 v106, v28, v31
    v_mfma_f32_16x16x32_bf16 v[60:63], a[20:23], v[156:159], v[60:63]
    buffer_load_dwordx4 a[16:19], v5, s[40:43], s28 offen offset:2048
    v_cvt_pk_bf16_f32 v31, v29, v29
    s_setprio 2
    s_waitcnt lgkmcnt(4)
    v_mfma_f32_16x16x32_bf16 v[32:35], a[24:27], v[160:163], v[32:35]
    ds_read_b128 v[144:147], v5 offset:4096
    v_lshlrev_b32 v31, 16, v31
    v_sub_f32 v31, v29, v31
    s_waitcnt lgkmcnt(4)
    v_mfma_f32_16x16x32_bf16 v[36:39], a[24:27], v[164:167], v[36:39]
    v_cvt_pk_bf16_f32 v108, v29, v31
    v_and_b32 v28, 0xffff0000, v108
    v_sub_f32 v31, v31, v28
    v_mov_b32 v28, 0
    v_cvt_pk_bf16_f32 v109, v31, v28
    v_cmp_gt_u32 vcc, 2, v2
    s_nop 1
    v_cndmask_b32 v106, v28, v106, vcc
    v_cndmask_b32 v108, v28, v108, vcc
    v_cndmask_b32 v109, v28, v109, vcc
    v_mov_b32 v107, v106
    ds_write_b128 v13, v[106:109]
    ds_read_b64_tr_b16 v[64:65], v100 offset:0
    ds_read_b64_tr_b16 v[66:67], v100 offset:18432
    ds_read_b64_tr_b16 v[68:69], v100 offset:8
    ds_read_b64_tr_b16 v[70:71], v100 offset:18440
    ds_read_b64_tr_b16 v[72:73], v100 offset:64
    ds_read_b64_tr_b16 v[74:75], v100 offset:18496
    ds_read_b64_tr_b16 v[76:77], v100 offset:72
    ds_read_b64_tr_b16 v[78:79], v100 offset:18504
    ds_read_b64_tr_b16 v[80:81], v100 offset:144
    ds_read_b64_tr_b16 v[82:83], v100 offset:18576
    ds_read_b64_tr_b16 v[84:85], v100 offset:152
    ds_read_b64_tr_b16 v[86:87], v100 offset:18584
    ds_read_b64_tr_b16 v[88:89], v100 offset:208
    ds_read_b64_tr_b16 v[90:91], v100 offset:18640
    ds_read_b64_tr_b16 v[92:93], v100 offset:216
    ds_read_b64_tr_b16 v[94:95], v100 offset:18648
    ds_read_b64_tr_b16 v[96:97], v101 offset:0
    ds_read_b64_tr_b16 v[98:99], v101 offset:18432
    s_waitcnt lgkmcnt(15)
    buffer_store_dwordx4 v[64:67], v5, s[60:63], s14 offen offset:0 sc1
    v_mfma_f32_16x16x32_bf16 v[40:43], a[24:27], v[168:171], v[40:43]
    ds_read_b128 v[148:151], v5 offset:23552
    v_mfma_f32_16x16x32_bf16 v[44:47], a[24:27], v[172:175], v[44:47]
    buffer_load_dwordx4 a[20:23], v5, s[40:43], s28 offen offset:3072
    v_mfma_f32_16x16x32_bf16 v[48:51], a[28:31], v[160:163], v[48:51]
    ds_read_b128 v[152:155], v7 offset:4096
    v_mfma_f32_16x16x32_bf16 v[52:55], a[28:31], v[164:167], v[52:55]
    s_waitcnt lgkmcnt(15)
    buffer_store_dwordx4 v[68:71], v5, s[60:63], s14 offen offset:1024 sc1
    v_mfma_f32_16x16x32_bf16 v[56:59], a[28:31], v[168:171], v[56:59]
    ds_read_b128 v[156:159], v7 offset:23552
    v_mfma_f32_16x16x32_bf16 v[60:63], a[28:31], v[172:175], v[60:63]
    s_mov_b32 s28, 24576
    buffer_load_dwordx4 a[24:27], v5, s[40:43], s28 offen offset:0
    s_setprio 1
    v_mfma_f32_16x16x32_bf16 v[32:35], a[32:35], v[144:147], v[32:35]
    ds_read_b128 v[160:163], v5 offset:5120
    s_waitcnt lgkmcnt(3)
    v_mfma_f32_16x16x32_bf16 v[36:39], a[32:35], v[148:151], v[36:39]
    buffer_store_dwordx4 v[72:75], v5, s[60:63], s15 offen offset:0 sc1
    s_waitcnt lgkmcnt(2)
    v_mfma_f32_16x16x32_bf16 v[40:43], a[32:35], v[152:155], v[40:43]
    ds_read_b128 v[164:167], v5 offset:24576
    s_waitcnt lgkmcnt(2)
    v_mfma_f32_16x16x32_bf16 v[44:47], a[32:35], v[156:159], v[44:47]
    buffer_load_dwordx4 a[28:31], v5, s[40:43], s28 offen offset:1024
    v_mfma_f32_16x16x32_bf16 v[48:51], a[36:39], v[144:147], v[48:51]
    ds_read_b128 v[168:171], v7 offset:5120
    v_mfma_f32_16x16x32_bf16 v[52:55], a[36:39], v[148:151], v[52:55]
    buffer_store_dwordx4 v[76:79], v5, s[60:63], s15 offen offset:1024 sc1
    v_mfma_f32_16x16x32_bf16 v[56:59], a[36:39], v[152:155], v[56:59]
    ds_read_b128 v[172:175], v7 offset:24576
    v_mfma_f32_16x16x32_bf16 v[60:63], a[36:39], v[156:159], v[60:63]
    buffer_load_dwordx4 a[32:35], v5, s[40:43], s28 offen offset:2048
    s_setprio 3
    s_waitcnt vmcnt(22)
    s_barrier
    s_waitcnt lgkmcnt(3)
    v_mfma_f32_16x16x32_bf16 v[32:35], a[40:43], v[160:163], v[32:35]
    ds_read_b128 v[144:147], v5 offset:6144
    v_lshlrev_b32 v12, 2, v3
    v_add_u32 v12, 151552, v12
    s_waitcnt lgkmcnt(3)
    v_mfma_f32_16x16x32_bf16 v[36:39], a[40:43], v[164:167], v[36:39]
    buffer_store_dwordx4 v[80:83], v5, s[60:63], s16 offen offset:0 sc1
    ds_read_b32 v24, v12 offset:0
    s_waitcnt lgkmcnt(3)
    v_mfma_f32_16x16x32_bf16 v[40:43], a[40:43], v[168:171], v[40:43]
    ds_read_b128 v[148:151], v5 offset:25600
    ds_read_b32 v25, v12 offset:64
    ds_read_b32 v26, v12 offset:128
    s_waitcnt lgkmcnt(5)
    v_mfma_f32_16x16x32_bf16 v[44:47], a[40:43], v[172:175], v[44:47]
    buffer_load_dwordx4 a[36:39], v5, s[40:43], s28 offen offset:3072
    ds_read_b32 v27, v12 offset:192
    v_mfma_f32_16x16x32_bf16 v[48:51], a[44:47], v[160:163], v[48:51]
    ds_read_b128 v[152:155], v7 offset:6144
    s_waitcnt lgkmcnt(5)
    v_mul_f32 v16, 0xc0135761, v24
    v_mul_f32 v20, v24, v24
    v_mfma_f32_16x16x32_bf16 v[52:55], a[44:47], v[164:167], v[52:55]
    buffer_store_dwordx4 v[84:87], v5, s[60:63], s16 offen offset:1024 sc1
    v_mul_f32 v20, v20, v24
    v_mfma_f32_16x16x32_bf16 v[56:59], a[44:47], v[168:171], v[56:59]
    ds_read_b128 v[156:159], v7 offset:25600
    v_mul_f32 v20, 0xbdd2d3e8, v20
    v_mfma_f32_16x16x32_bf16 v[60:63], a[44:47], v[172:175], v[60:63]
    s_mov_b32 s28, 28672
    buffer_load_dwordx4 a[40:43], v5, s[40:43], s28 offen offset:0
    v_rcp_f32 v24, v24
    s_setprio 2
    v_mfma_f32_16x16x32_bf16 v[32:35], a[48:51], v[144:147], v[32:35]
    ds_read_b128 v[160:163], v5 offset:7168
    s_waitcnt lgkmcnt(5)
    v_mul_f32 v17, 0xc0135761, v25
    v_mul_f32 v21, v25, v25
    v_mfma_f32_16x16x32_bf16 v[36:39], a[48:51], v[148:151], v[36:39]
    buffer_store_dwordx4 v[88:91], v5, s[60:63], s17 offen offset:0 sc1
    v_mul_f32 v21, v21, v25
    s_waitcnt lgkmcnt(2)
    v_mfma_f32_16x16x32_bf16 v[40:43], a[48:51], v[152:155], v[40:43]
    ds_read_b128 v[164:167], v5 offset:26624
    v_mul_f32 v21, 0xbdd2d3e8, v21
    s_waitcnt lgkmcnt(2)
    v_mfma_f32_16x16x32_bf16 v[44:47], a[48:51], v[156:159], v[44:47]
    buffer_load_dwordx4 a[44:47], v5, s[40:43], s28 offen offset:1024
    v_rcp_f32 v25, v25
    v_mfma_f32_16x16x32_bf16 v[48:51], a[52:55], v[144:147], v[48:51]
    ds_read_b128 v[168:171], v7 offset:7168
    v_mul_f32 v18, 0xc0135761, v26
    v_mul_f32 v22, v26, v26
    v_mfma_f32_16x16x32_bf16 v[52:55], a[52:55], v[148:151], v[52:55]
    buffer_store_dwordx4 v[92:95], v5, s[60:63], s17 offen offset:1024 sc1
    v_mul_f32 v22, v22, v26
    v_mfma_f32_16x16x32_bf16 v[56:59], a[52:55], v[152:155], v[56:59]
    ds_read_b128 v[172:175], v7 offset:26624
    v_mul_f32 v22, 0xbdd2d3e8, v22
    v_mfma_f32_16x16x32_bf16 v[60:63], a[52:55], v[156:159], v[60:63]
    buffer_load_dwordx4 a[48:51], v5, s[40:43], s28 offen offset:2048
    v_rcp_f32 v26, v26
    s_setprio 1
    s_waitcnt lgkmcnt(3)
    v_mfma_f32_16x16x32_bf16 v[32:35], a[56:59], v[160:163], v[32:35]
    ds_read_b128 v[144:147], v5 offset:8192
    v_mul_f32 v19, 0xc0135761, v27
    v_mul_f32 v23, v27, v27
    s_waitcnt lgkmcnt(3)
    v_mfma_f32_16x16x32_bf16 v[36:39], a[56:59], v[164:167], v[36:39]
    buffer_store_dwordx4 v[96:99], v5, s[60:63], s18 offen offset:0 sc1
    v_mul_f32 v23, v23, v27
    s_waitcnt lgkmcnt(2)
    v_mfma_f32_16x16x32_bf16 v[40:43], a[56:59], v[168:171], v[40:43]
    ds_read_b128 v[148:151], v5 offset:27648
    v_mul_f32 v23, 0xbdd2d3e8, v23
    s_waitcnt lgkmcnt(2)
    v_mfma_f32_16x16x32_bf16 v[44:47], a[56:59], v[172:175], v[44:47]
    buffer_load_dwordx4 a[52:55], v5, s[40:43], s28 offen offset:3072
    v_rcp_f32 v27, v27
    v_mfma_f32_16x16x32_bf16 v[48:51], a[60:63], v[160:163], v[48:51]
    ds_read_b128 v[152:155], v7 offset:8192
    v_min_u32 v29, 31, v1
    v_lshlrev_b32 v29, 2, v29
    v_mfma_f32_16x16x32_bf16 v[52:55], a[60:63], v[164:167], v[52:55]
    v_mfma_f32_16x16x32_bf16 v[56:59], a[60:63], v[168:171], v[56:59]
    ds_read_b128 v[156:159], v7 offset:27648
    v_mfma_f32_16x16x32_bf16 v[60:63], a[60:63], v[172:175], v[60:63]
    s_mov_b32 s28, 32768
    buffer_load_dwordx4 a[56:59], v5, s[40:43], s28 offen offset:0
    s_setprio 3
    s_waitcnt vmcnt(30)
    s_barrier
    s_waitcnt lgkmcnt(3)
    v_mfma_f32_16x16x32_bf16 v[32:35], a[64:67], v[144:147], v[32:35]
    ds_read_b128 v[160:163], v5 offset:9216
    s_waitcnt lgkmcnt(3)
    v_mfma_f32_16x16x32_bf16 v[36:39], a[64:67], v[148:151], v[36:39]
    s_waitcnt lgkmcnt(2)
    v_mfma_f32_16x16x32_bf16 v[40:43], a[64:67], v[152:155], v[40:43]
    ds_read_b128 v[164:167], v5 offset:28672
    s_waitcnt lgkmcnt(2)
    v_mfma_f32_16x16x32_bf16 v[44:47], a[64:67], v[156:159], v[44:47]
    buffer_load_dwordx4 a[60:63], v5, s[40:43], s28 offen offset:1024
    v_mfma_f32_16x16x32_bf16 v[48:51], a[68:71], v[144:147], v[48:51]
    ds_read_b128 v[168:171], v7 offset:9216
    v_mfma_f32_16x16x32_bf16 v[52:55], a[68:71], v[148:151], v[52:55]
    v_mfma_f32_16x16x32_bf16 v[56:59], a[68:71], v[152:155], v[56:59]
    ds_read_b128 v[172:175], v7 offset:28672
    v_mfma_f32_16x16x32_bf16 v[60:63], a[68:71], v[156:159], v[60:63]
    buffer_load_dwordx4 a[64:67], v5, s[40:43], s28 offen offset:2048
    s_setprio 2
    s_waitcnt vmcnt(31) lgkmcnt(3)
    v_mfma_f32_16x16x32_bf16 v[32:35], a[0:3], v[160:163], v[32:35]
    ds_read_b128 v[144:147], v5 offset:10240
    s_waitcnt lgkmcnt(3)
    v_mfma_f32_16x16x32_bf16 v[36:39], a[0:3], v[164:167], v[36:39]
    s_waitcnt lgkmcnt(2)
    v_mfma_f32_16x16x32_bf16 v[40:43], a[0:3], v[168:171], v[40:43]
    ds_read_b128 v[148:151], v5 offset:29696
    s_waitcnt lgkmcnt(2)
    v_mfma_f32_16x16x32_bf16 v[44:47], a[0:3], v[172:175], v[44:47]
    buffer_load_dwordx4 a[68:71], v5, s[40:43], s28 offen offset:3072
    s_waitcnt vmcnt(28)
    v_mfma_f32_16x16x32_bf16 v[48:51], a[4:7], v[160:163], v[48:51]
    ds_read_b128 v[152:155], v7 offset:10240
    v_mfma_f32_16x16x32_bf16 v[52:55], a[4:7], v[164:167], v[52:55]
    v_mfma_f32_16x16x32_bf16 v[56:59], a[4:7], v[168:171], v[56:59]
    ds_read_b128 v[156:159], v7 offset:29696
    v_mfma_f32_16x16x32_bf16 v[60:63], a[4:7], v[172:175], v[60:63]
    buffer_load_dwordx4 a[0:3], v6, s[36:39], s29 offen offset:0
    s_setprio 1
    s_waitcnt vmcnt(28) lgkmcnt(3)
    v_mfma_f32_16x16x32_bf16 v[32:35], a[8:11], v[144:147], v[32:35]
    ds_read_b128 v[160:163], v5 offset:11264
    s_waitcnt lgkmcnt(3)
    v_mfma_f32_16x16x32_bf16 v[36:39], a[8:11], v[148:151], v[36:39]
    s_waitcnt lgkmcnt(2)
    v_mfma_f32_16x16x32_bf16 v[40:43], a[8:11], v[152:155], v[40:43]
    ds_read_b128 v[164:167], v5 offset:30720
    s_waitcnt lgkmcnt(2)
    v_mfma_f32_16x16x32_bf16 v[44:47], a[8:11], v[156:159], v[44:47]
    buffer_load_dwordx4 a[4:7], v6, s[36:39], s29 offen offset:512
    s_waitcnt vmcnt(25)
    v_mfma_f32_16x16x32_bf16 v[48:51], a[12:15], v[144:147], v[48:51]
    ds_read_b128 v[168:171], v7 offset:11264
    v_mfma_f32_16x16x32_bf16 v[52:55], a[12:15], v[148:151], v[52:55]
    v_mfma_f32_16x16x32_bf16 v[56:59], a[12:15], v[152:155], v[56:59]
    ds_read_b128 v[172:175], v7 offset:30720
    v_mfma_f32_16x16x32_bf16 v[60:63], a[12:15], v[156:159], v[60:63]
    s_mov_b32 s28, 36864
    buffer_load_dwordx4 a[8:11], v5, s[40:43], s28 offen offset:0
    s_setprio 3
    s_barrier
    s_waitcnt vmcnt(25) lgkmcnt(3)
    v_mfma_f32_16x16x32_bf16 v[32:35], a[16:19], v[160:163], v[32:35]
    ds_read_b128 v[144:147], v5 offset:12288
    s_waitcnt lgkmcnt(3)
    v_mfma_f32_16x16x32_bf16 v[36:39], a[16:19], v[164:167], v[36:39]
    s_waitcnt lgkmcnt(2)
    v_mfma_f32_16x16x32_bf16 v[40:43], a[16:19], v[168:171], v[40:43]
    ds_read_b128 v[148:151], v5 offset:31744
    s_waitcnt lgkmcnt(2)
    v_mfma_f32_16x16x32_bf16 v[44:47], a[16:19], v[172:175], v[44:47]
    buffer_load_dwordx4 a[12:15], v5, s[40:43], s28 offen offset:1024
    s_waitcnt vmcnt(24)
    v_mfma_f32_16x16x32_bf16 v[48:51], a[20:23], v[160:163], v[48:51]
    ds_read_b128 v[152:155], v7 offset:12288
    v_mfma_f32_16x16x32_bf16 v[52:55], a[20:23], v[164:167], v[52:55]
    v_mfma_f32_16x16x32_bf16 v[56:59], a[20:23], v[168:171], v[56:59]
    ds_read_b128 v[156:159], v7 offset:31744
    v_mfma_f32_16x16x32_bf16 v[60:63], a[20:23], v[172:175], v[60:63]
    buffer_load_dwordx4 a[16:19], v5, s[40:43], s28 offen offset:2048
    s_setprio 2
    s_waitcnt vmcnt(23) lgkmcnt(3)
    v_mfma_f32_16x16x32_bf16 v[32:35], a[24:27], v[144:147], v[32:35]
    ds_read_b128 v[160:163], v5 offset:13312
    s_waitcnt lgkmcnt(3)
    v_mfma_f32_16x16x32_bf16 v[36:39], a[24:27], v[148:151], v[36:39]
    s_waitcnt lgkmcnt(2)
    v_mfma_f32_16x16x32_bf16 v[40:43], a[24:27], v[152:155], v[40:43]
    ds_read_b128 v[164:167], v5 offset:32768
    s_waitcnt lgkmcnt(2)
    v_mfma_f32_16x16x32_bf16 v[44:47], a[24:27], v[156:159], v[44:47]
    buffer_load_dwordx4 a[20:23], v5, s[40:43], s28 offen offset:3072
    s_waitcnt vmcnt(22)
    v_mfma_f32_16x16x32_bf16 v[48:51], a[28:31], v[144:147], v[48:51]
    ds_read_b128 v[168:171], v7 offset:13312
    v_mfma_f32_16x16x32_bf16 v[52:55], a[28:31], v[148:151], v[52:55]
    v_mfma_f32_16x16x32_bf16 v[56:59], a[28:31], v[152:155], v[56:59]
    ds_read_b128 v[172:175], v7 offset:32768
    v_mfma_f32_16x16x32_bf16 v[60:63], a[28:31], v[156:159], v[60:63]
    s_mov_b32 s28, 40960
    buffer_load_dwordx4 a[24:27], v5, s[40:43], s28 offen offset:0
    s_setprio 1
    s_waitcnt vmcnt(21) lgkmcnt(3)
    v_mfma_f32_16x16x32_bf16 v[32:35], a[32:35], v[160:163], v[32:35]
    ds_read_b128 v[144:147], v5 offset:14336
    s_waitcnt lgkmcnt(3)
    v_mfma_f32_16x16x32_bf16 v[36:39], a[32:35], v[164:167], v[36:39]
    s_waitcnt lgkmcnt(2)
    v_mfma_f32_16x16x32_bf16 v[40:43], a[32:35], v[168:171], v[40:43]
    ds_read_b128 v[148:151], v5 offset:33792
    s_waitcnt lgkmcnt(2)
    v_mfma_f32_16x16x32_bf16 v[44:47], a[32:35], v[172:175], v[44:47]
    buffer_load_dwordx4 a[28:31], v5, s[40:43], s28 offen offset:1024
    s_waitcnt vmcnt(20)
    v_mfma_f32_16x16x32_bf16 v[48:51], a[36:39], v[160:163], v[48:51]
    ds_read_b128 v[152:155], v7 offset:14336
    v_mfma_f32_16x16x32_bf16 v[52:55], a[36:39], v[164:167], v[52:55]
    v_mfma_f32_16x16x32_bf16 v[56:59], a[36:39], v[168:171], v[56:59]
    ds_read_b128 v[156:159], v7 offset:33792
    v_mfma_f32_16x16x32_bf16 v[60:63], a[36:39], v[172:175], v[60:63]
    buffer_load_dwordx4 a[32:35], v5, s[40:43], s28 offen offset:2048
    s_setprio 3
    s_waitcnt vmcnt(14)
    s_barrier
    buffer_store_dword v103, v102, s[56:59], 0 offen sc1
    s_waitcnt lgkmcnt(3)
    v_mfma_f32_16x16x32_bf16 v[32:35], a[40:43], v[144:147], v[32:35]
    ds_read_b128 v[160:163], v5 offset:15360
    s_waitcnt lgkmcnt(3)
    v_mfma_f32_16x16x32_bf16 v[36:39], a[40:43], v[148:151], v[36:39]
    s_waitcnt lgkmcnt(2)
    v_mfma_f32_16x16x32_bf16 v[40:43], a[40:43], v[152:155], v[40:43]
    ds_read_b128 v[164:167], v5 offset:34816
    s_waitcnt lgkmcnt(2)
    v_mfma_f32_16x16x32_bf16 v[44:47], a[40:43], v[156:159], v[44:47]
    buffer_load_dwordx4 a[36:39], v5, s[40:43], s28 offen offset:3072
    v_mfma_f32_16x16x32_bf16 v[48:51], a[44:47], v[144:147], v[48:51]
    ds_read_b128 v[168:171], v7 offset:15360
    v_mfma_f32_16x16x32_bf16 v[52:55], a[44:47], v[148:151], v[52:55]
    v_mfma_f32_16x16x32_bf16 v[56:59], a[44:47], v[152:155], v[56:59]
    ds_read_b128 v[172:175], v7 offset:34816
    v_mfma_f32_16x16x32_bf16 v[60:63], a[44:47], v[156:159], v[60:63]
    s_mov_b32 s28, 45056
    buffer_load_dwordx4 a[40:43], v5, s[40:43], s28 offen offset:0
    s_waitcnt lgkmcnt(3)
    v_mfma_f32_16x16x32_bf16 v[32:35], a[48:51], v[160:163], v[32:35]
    ds_read_b128 v[144:147], v5 offset:16384
    s_mul_i32 s32, s21, 2359296
    s_mul_i32 s31, s22, 73728
    s_waitcnt lgkmcnt(3)
    v_mfma_f32_16x16x32_bf16 v[36:39], a[48:51], v[164:167], v[36:39]
    s_add_u32 s32, s32, s31
    s_waitcnt lgkmcnt(2)
    v_mfma_f32_16x16x32_bf16 v[40:43], a[48:51], v[168:171], v[40:43]
    ds_read_b128 v[148:151], v5 offset:35840
    s_add_u32 s4, s12, 0x14f0000
    s_addc_u32 s5, s13, 0
    s_waitcnt lgkmcnt(2)
    v_mfma_f32_16x16x32_bf16 v[44:47], a[48:51], v[172:175], v[44:47]
    buffer_load_dwordx4 a[44:47], v5, s[40:43], s28 offen offset:1024
    s_add_u32 s4, s4, s32
    s_addc_u32 s5, s5, 0
    s_waitcnt vmcnt(17)
    v_mfma_f32_16x16x32_bf16 v[48:51], a[52:55], v[160:163], v[48:51]
    ds_read_b128 v[152:155], v7 offset:16384
    s_mov_b32 s6, 0x12000
    v_mfma_f32_16x16x32_bf16 v[52:55], a[52:55], v[164:167], v[52:55]
    s_mov_b32 s7, 0x20000
    v_mfma_f32_16x16x32_bf16 v[56:59], a[52:55], v[168:171], v[56:59]
    ds_read_b128 v[156:159], v7 offset:35840
    s_lshl_b32 s32, s20, 12
    v_add_u32 v15, s32, v5
    v_mfma_f32_16x16x32_bf16 v[60:63], a[52:55], v[172:175], v[60:63]
    buffer_load_dwordx4 a[48:51], v5, s[40:43], s28 offen offset:2048
    s_lshl_b32 s32, s20, 8
    s_waitcnt vmcnt(17) lgkmcnt(3)
    v_mfma_f32_16x16x32_bf16 v[32:35], a[56:59], v[144:147], v[32:35]
    ds_read_b128 v[160:163], v5 offset:17408
    s_add_u32 s32, s32, 16384
    v_and_b32 v12, 1, v2
    s_waitcnt lgkmcnt(3)
    v_mfma_f32_16x16x32_bf16 v[36:39], a[56:59], v[148:151], v[36:39]
    v_lshl_add_u32 v4, v12, 7, s32
    s_waitcnt lgkmcnt(2)
    v_mfma_f32_16x16x32_bf16 v[40:43], a[56:59], v[152:155], v[40:43]
    ds_read_b128 v[164:167], v5 offset:36864
    v_and_b32 v12, 7, v3
    v_lshl_add_u32 v4, v12, 4, v4
    s_waitcnt lgkmcnt(2)
    v_mfma_f32_16x16x32_bf16 v[44:47], a[56:59], v[156:159], v[44:47]
    buffer_load_dwordx4 a[52:55], v5, s[40:43], s28 offen offset:3072
    v_lshrrev_b32 v12, 3, v3
    s_waitcnt vmcnt(17)
    v_mfma_f32_16x16x32_bf16 v[48:51], a[60:63], v[144:147], v[48:51]
    ds_read_b128 v[168:171], v7 offset:17408
    v_lshl_add_u32 v4, v12, 10, v4
    v_lshrrev_b32 v12, 5, v1
    v_mfma_f32_16x16x32_bf16 v[52:55], a[60:63], v[148:151], v[52:55]
    s_bfe_u32 s32, s21, 0x10001
    v_mfma_f32_16x16x32_bf16 v[56:59], a[60:63], v[152:155], v[56:59]
    ds_read_b128 v[172:175], v7 offset:36864
    v_xor_b32 v12, s32, v12
    v_mul_u32_u24 v12, 18432, v12
    v_mfma_f32_16x16x32_bf16 v[60:63], a[60:63], v[156:159], v[60:63]
    s_mov_b32 s28, 49152
    buffer_load_dwordx4 a[56:59], v5, s[40:43], s28 offen offset:0
    v_add_u32 v4, v4, v12
    s_waitcnt vmcnt(17) lgkmcnt(3)
    v_mfma_f32_16x16x32_bf16 v[32:35], a[64:67], v[160:163], v[32:35]
    ds_read_b128 v[144:147], v5 offset:18432
    s_lshr_b32 s32, s21, 1
    s_xor_b32 s44, s32, 0
    s_waitcnt lgkmcnt(3)
    v_mfma_f32_16x16x32_bf16 v[36:39], a[64:67], v[164:167], v[36:39]
    s_xor_b32 s45, s32, 1
    s_waitcnt lgkmcnt(2)
    v_mfma_f32_16x16x32_bf16 v[40:43], a[64:67], v[168:171], v[40:43]
    ds_read_b128 v[148:151], v5 offset:37888
    s_xor_b32 s46, s32, 2
    s_xor_b32 s47, s32, 3
    s_waitcnt lgkmcnt(2)
    v_mfma_f32_16x16x32_bf16 v[44:47], a[64:67], v[172:175], v[44:47]
    buffer_load_dwordx4 a[60:63], v5, s[40:43], s28 offen offset:1024
    s_and_b32 s48, s44, 2
    s_waitcnt vmcnt(17)
    v_mfma_f32_16x16x32_bf16 v[48:51], a[68:71], v[160:163], v[48:51]
    ds_read_b128 v[152:155], v7 offset:18432
    s_xor_b32 s49, s48, 2
    s_mul_i32 s44, s44, 18432
    v_mfma_f32_16x16x32_bf16 v[52:55], a[68:71], v[164:167], v[52:55]
    s_mul_i32 s45, s45, 18432
    v_mfma_f32_16x16x32_bf16 v[56:59], a[68:71], v[168:171], v[56:59]
    ds_read_b128 v[156:159], v7 offset:37888
    s_mul_i32 s46, s46, 18432
    s_mul_i32 s47, s47, 18432
    v_mfma_f32_16x16x32_bf16 v[60:63], a[68:71], v[172:175], v[60:63]
    buffer_load_dwordx4 a[64:67], v5, s[40:43], s28 offen offset:2048
    s_mul_i32 s48, s48, 18432
    s_waitcnt vmcnt(17) lgkmcnt(3)
    v_mfma_f32_16x16x32_bf16 v[32:35], a[0:3], v[144:147], v[32:35]
    ds_read_b128 v[160:163], v5 offset:0
    s_mul_i32 s49, s49, 18432
    s_waitcnt lgkmcnt(3)
    v_mfma_f32_16x16x32_bf16 v[36:39], a[0:3], v[148:151], v[36:39]
    s_waitcnt lgkmcnt(2)
    v_mfma_f32_16x16x32_bf16 v[40:43], a[0:3], v[152:155], v[40:43]
    ds_read_b128 v[164:167], v5 offset:19456
    s_waitcnt lgkmcnt(2)
    v_mfma_f32_16x16x32_bf16 v[44:47], a[0:3], v[156:159], v[44:47]
    buffer_load_dwordx4 a[68:71], v5, s[40:43], s28 offen offset:3072
    s_waitcnt vmcnt(17)
    v_mfma_f32_16x16x32_bf16 v[48:51], a[4:7], v[144:147], v[48:51]
    ds_read_b128 v[168:171], v7 offset:0
    v_mfma_f32_16x16x32_bf16 v[52:55], a[4:7], v[148:151], v[52:55]
    v_mfma_f32_16x16x32_bf16 v[56:59], a[4:7], v[152:155], v[56:59]
    ds_read_b128 v[172:175], v7 offset:19456
    v_mfma_f32_16x16x32_bf16 v[60:63], a[4:7], v[156:159], v[60:63]
    s_mov_b32 s28, 53248
    buffer_load_dwordx4 a[0:3], v5, s[40:43], s28 offen offset:0
    s_waitcnt vmcnt(17) lgkmcnt(3)
    v_mfma_f32_16x16x32_bf16 v[112:115], a[8:11], v[160:163], 0
    ds_read_b128 v[144:147], v5 offset:1024
    v_mul_f32 v176, v32, v32
    v_mul_f32 v177, v33, v33
    s_waitcnt lgkmcnt(3)
    v_mfma_f32_16x16x32_bf16 v[116:119], a[8:11], v[164:167], 0
    v_mul_f32 v178, v34, v34
    v_mul_f32 v179, v35, v35
    v_fma_f32 v176, v176, v20, v16
    s_waitcnt lgkmcnt(2)
    v_mfma_f32_16x16x32_bf16 v[120:123], a[8:11], v[168:171], 0
    ds_read_b128 v[148:151], v5 offset:20480
    v_fma_f32 v177, v177, v20, v16
    v_fma_f32 v178, v178, v20, v16
    s_waitcnt lgkmcnt(2)
    v_mfma_f32_16x16x32_bf16 v[124:127], a[8:11], v[172:175], 0
    buffer_load_dwordx4 a[4:7], v5, s[40:43], s28 offen offset:1024
    v_fma_f32 v179, v179, v20, v16
    v_mul_f32 v176, v176, v32
    s_waitcnt vmcnt(17)
    v_mfma_f32_16x16x32_bf16 v[128:131], a[12:15], v[160:163], 0
    ds_read_b128 v[152:155], v7 offset:1024
    v_mul_f32 v177, v177, v33
    v_mul_f32 v178, v178, v34
    v_mfma_f32_16x16x32_bf16 v[132:135], a[12:15], v[164:167], 0
    v_mul_f32 v179, v179, v35
    v_exp_f32 v176, v176
    v_mfma_f32_16x16x32_bf16 v[136:139], a[12:15], v[168:171], 0
    ds_read_b128 v[156:159], v7 offset:20480
    v_exp_f32 v177, v177
    v_mfma_f32_16x16x32_bf16 v[140:143], a[12:15], v[172:175], 0
    buffer_load_dwordx4 a[8:11], v5, s[40:43], s28 offen offset:2048
    v_exp_f32 v178, v178
    s_setprio 2
    s_waitcnt vmcnt(17) lgkmcnt(3)
    v_mfma_f32_16x16x32_bf16 v[112:115], a[16:19], v[144:147], v[112:115]
    ds_read_b128 v[160:163], v5 offset:2048
    v_exp_f32 v179, v179
    v_fma_f32 v176, v176, v24, v24
    s_waitcnt lgkmcnt(3)
    v_mfma_f32_16x16x32_bf16 v[116:119], a[16:19], v[148:151], v[116:119]
    v_fma_f32 v177, v177, v24, v24
    v_fma_f32 v178, v178, v24, v24
    s_waitcnt lgkmcnt(2)
    v_mfma_f32_16x16x32_bf16 v[120:123], a[16:19], v[152:155], v[120:123]
    ds_read_b128 v[164:167], v5 offset:21504
    v_fma_f32 v179, v179, v24, v24
    v_rcp_f32 v176, v176
    s_waitcnt lgkmcnt(2)
    v_mfma_f32_16x16x32_bf16 v[124:127], a[16:19], v[156:159], v[124:127]
    buffer_load_dwordx4 a[12:15], v5, s[40:43], s28 offen offset:3072
    v_rcp_f32 v177, v177
    s_waitcnt vmcnt(17)
    v_mfma_f32_16x16x32_bf16 v[128:131], a[20:23], v[144:147], v[128:131]
    ds_read_b128 v[168:171], v7 offset:2048
    v_rcp_f32 v178, v178
    v_mfma_f32_16x16x32_bf16 v[132:135], a[20:23], v[148:151], v[132:135]
    v_rcp_f32 v179, v179
    v_mul_f32 v176, v176, v32
    v_mfma_f32_16x16x32_bf16 v[136:139], a[20:23], v[152:155], v[136:139]
    ds_read_b128 v[172:175], v7 offset:21504
    v_mul_f32 v177, v177, v33
    v_mul_f32 v178, v178, v34
    v_mfma_f32_16x16x32_bf16 v[140:143], a[20:23], v[156:159], v[140:143]
    s_mov_b32 s28, 57344
    buffer_load_dwordx4 a[16:19], v5, s[40:43], s28 offen offset:0
    v_mul_f32 v179, v179, v35
    v_cvt_pk_bf16_f32 v32, v176, v177
    s_waitcnt vmcnt(17) lgkmcnt(3)
    v_mfma_f32_16x16x32_bf16 v[112:115], a[24:27], v[160:163], v[112:115]
    ds_read_b128 v[144:147], v5 offset:3072
    v_cvt_pk_bf16_f32 v33, v178, v179
    v_mul_f32 v180, v48, v48
    v_mul_f32 v181, v49, v49
    s_waitcnt lgkmcnt(3)
    v_mfma_f32_16x16x32_bf16 v[116:119], a[24:27], v[164:167], v[116:119]
    v_mul_f32 v182, v50, v50
    v_mul_f32 v183, v51, v51
    s_waitcnt lgkmcnt(2)
    v_mfma_f32_16x16x32_bf16 v[120:123], a[24:27], v[168:171], v[120:123]
    ds_read_b128 v[148:151], v5 offset:22528
    v_fma_f32 v180, v180, v20, v16
    v_fma_f32 v181, v181, v20, v16
    s_waitcnt lgkmcnt(2)
    v_mfma_f32_16x16x32_bf16 v[124:127], a[24:27], v[172:175], v[124:127]
    buffer_load_dwordx4 a[20:23], v5, s[40:43], s28 offen offset:1024
    v_fma_f32 v182, v182, v20, v16
    v_fma_f32 v183, v183, v20, v16
    s_waitcnt vmcnt(17)
    v_mfma_f32_16x16x32_bf16 v[128:131], a[28:31], v[160:163], v[128:131]
    ds_read_b128 v[152:155], v7 offset:3072
    v_mul_f32 v180, v180, v48
    v_mul_f32 v181, v181, v49
    v_mfma_f32_16x16x32_bf16 v[132:135], a[28:31], v[164:167], v[132:135]
    v_mul_f32 v182, v182, v50
    v_mul_f32 v183, v183, v51
    v_mfma_f32_16x16x32_bf16 v[136:139], a[28:31], v[168:171], v[136:139]
    ds_read_b128 v[156:159], v7 offset:22528
    v_exp_f32 v180, v180
    v_exp_f32 v181, v181
    v_mfma_f32_16x16x32_bf16 v[140:143], a[28:31], v[172:175], v[140:143]
    buffer_load_dwordx4 a[24:27], v5, s[40:43], s28 offen offset:2048
    v_exp_f32 v182, v182
    buffer_load_dword v30, v29, s[56:59], s34 offen sc1
    s_waitcnt vmcnt(18) lgkmcnt(3)
    v_mfma_f32_16x16x32_bf16 v[112:115], a[32:35], v[144:147], v[112:115]
    ds_read_b128 v[160:163], v5 offset:4096
    v_exp_f32 v183, v183
    s_waitcnt lgkmcnt(3)
    v_mfma_f32_16x16x32_bf16 v[116:119], a[32:35], v[148:151], v[116:119]
    v_fma_f32 v180, v180, v24, v24
    v_fma_f32 v181, v181, v24, v24
    s_waitcnt lgkmcnt(2)
    v_mfma_f32_16x16x32_bf16 v[120:123], a[32:35], v[152:155], v[120:123]
    ds_read_b128 v[164:167], v5 offset:23552
    v_fma_f32 v182, v182, v24, v24
    v_fma_f32 v183, v183, v24, v24
    s_waitcnt lgkmcnt(2)
    v_mfma_f32_16x16x32_bf16 v[124:127], a[32:35], v[156:159], v[124:127]
    buffer_load_dwordx4 a[28:31], v5, s[40:43], s28 offen offset:3072
    v_rcp_f32 v180, v180
    s_waitcnt vmcnt(17)
    v_mfma_f32_16x16x32_bf16 v[128:131], a[36:39], v[144:147], v[128:131]
    ds_read_b128 v[168:171], v7 offset:4096
    v_rcp_f32 v181, v181
    v_rcp_f32 v182, v182
    v_mfma_f32_16x16x32_bf16 v[132:135], a[36:39], v[148:151], v[132:135]
    v_rcp_f32 v183, v183
    v_mfma_f32_16x16x32_bf16 v[136:139], a[36:39], v[152:155], v[136:139]
    ds_read_b128 v[172:175], v7 offset:23552
    v_mul_f32 v180, v180, v48
    v_mul_f32 v181, v181, v49
    v_mfma_f32_16x16x32_bf16 v[140:143], a[36:39], v[156:159], v[140:143]
    s_mov_b32 s28, 61440
    buffer_load_dwordx4 a[32:35], v5, s[40:43], s28 offen offset:0
    v_mul_f32 v182, v182, v50
    v_mul_f32 v183, v183, v51
    s_waitcnt vmcnt(17) lgkmcnt(3)
    v_mfma_f32_16x16x32_bf16 v[112:115], a[40:43], v[160:163], v[112:115]
    ds_read_b128 v[144:147], v5 offset:5120
    v_cvt_pk_bf16_f32 v34, v180, v181
    v_cvt_pk_bf16_f32 v35, v182, v183
    s_waitcnt lgkmcnt(3)
    v_mfma_f32_16x16x32_bf16 v[116:119], a[40:43], v[164:167], v[116:119]
    ds_write_b128 v10, v[32:35] offset:0
    s_waitcnt lgkmcnt(3)
    v_mfma_f32_16x16x32_bf16 v[120:123], a[40:43], v[168:171], v[120:123]
    ds_read_b128 v[148:151], v5 offset:24576
    v_mul_f32 v176, v36, v36
    v_mul_f32 v177, v37, v37
    s_waitcnt lgkmcnt(3)
    v_mfma_f32_16x16x32_bf16 v[124:127], a[40:43], v[172:175], v[124:127]
    buffer_load_dwordx4 a[36:39], v5, s[40:43], s28 offen offset:1024
    v_mul_f32 v178, v38, v38
    v_mul_f32 v179, v39, v39
    v_fma_f32 v176, v176, v21, v17
    s_waitcnt vmcnt(17)
    v_mfma_f32_16x16x32_bf16 v[128:131], a[44:47], v[160:163], v[128:131]
    ds_read_b128 v[152:155], v7 offset:5120
    v_fma_f32 v177, v177, v21, v17
    v_fma_f32 v178, v178, v21, v17
    v_mfma_f32_16x16x32_bf16 v[132:135], a[44:47], v[164:167], v[132:135]
    v_fma_f32 v179, v179, v21, v17
    v_mul_f32 v176, v176, v36
    v_mfma_f32_16x16x32_bf16 v[136:139], a[44:47], v[168:171], v[136:139]
    ds_read_b128 v[156:159], v7 offset:24576
    v_mul_f32 v177, v177, v37
    v_mul_f32 v178, v178, v38
    v_mfma_f32_16x16x32_bf16 v[140:143], a[44:47], v[172:175], v[140:143]
    buffer_load_dwordx4 a[40:43], v5, s[40:43], s28 offen offset:2048
    v_mul_f32 v179, v179, v39
    v_exp_f32 v176, v176
    s_waitcnt vmcnt(17) lgkmcnt(4)
    v_mfma_f32_16x16x32_bf16 v[112:115], a[48:51], v[144:147], v[112:115]
    ds_read_b128 v[160:163], v5 offset:6144
    v_exp_f32 v177, v177
    s_waitcnt lgkmcnt(3)
    v_mfma_f32_16x16x32_bf16 v[116:119], a[48:51], v[148:151], v[116:119]
    v_exp_f32 v178, v178
    s_waitcnt lgkmcnt(2)
    v_mfma_f32_16x16x32_bf16 v[120:123], a[48:51], v[152:155], v[120:123]
    ds_read_b128 v[164:167], v5 offset:25600
    v_exp_f32 v179, v179
    v_fma_f32 v176, v176, v25, v25
    s_waitcnt lgkmcnt(2)
    v_mfma_f32_16x16x32_bf16 v[124:127], a[48:51], v[156:159], v[124:127]
    buffer_load_dwordx4 a[44:47], v5, s[40:43], s28 offen offset:3072
    v_fma_f32 v177, v177, v25, v25
    v_fma_f32 v178, v178, v25, v25
    s_waitcnt vmcnt(17)
    v_mfma_f32_16x16x32_bf16 v[128:131], a[52:55], v[144:147], v[128:131]
    ds_read_b128 v[168:171], v7 offset:6144
    v_fma_f32 v179, v179, v25, v25
    v_rcp_f32 v176, v176
    v_mfma_f32_16x16x32_bf16 v[132:135], a[52:55], v[148:151], v[132:135]
    v_rcp_f32 v177, v177
    v_mfma_f32_16x16x32_bf16 v[136:139], a[52:55], v[152:155], v[136:139]
    ds_read_b128 v[172:175], v7 offset:25600
    v_rcp_f32 v178, v178
    v_mfma_f32_16x16x32_bf16 v[140:143], a[52:55], v[156:159], v[140:143]
    s_mov_b32 s28, 65536
    buffer_load_dwordx4 a[48:51], v5, s[40:43], s28 offen offset:0
    v_rcp_f32 v179, v179
    v_mul_f32 v176, v176, v36
    s_waitcnt vmcnt(17) lgkmcnt(3)
    v_mfma_f32_16x16x32_bf16 v[112:115], a[56:59], v[160:163], v[112:115]
    ds_read_b128 v[144:147], v5 offset:7168
    v_mul_f32 v177, v177, v37
    v_mul_f32 v178, v178, v38
    s_waitcnt lgkmcnt(3)
    v_mfma_f32_16x16x32_bf16 v[116:119], a[56:59], v[164:167], v[116:119]
    v_mul_f32 v179, v179, v39
    v_cvt_pk_bf16_f32 v36, v176, v177
    s_waitcnt lgkmcnt(2)
    v_mfma_f32_16x16x32_bf16 v[120:123], a[56:59], v[168:171], v[120:123]
    ds_read_b128 v[148:151], v5 offset:26624
    v_cvt_pk_bf16_f32 v37, v178, v179
    v_mul_f32 v180, v52, v52
    v_mul_f32 v181, v53, v53
    s_waitcnt lgkmcnt(2)
    v_mfma_f32_16x16x32_bf16 v[124:127], a[56:59], v[172:175], v[124:127]
    buffer_load_dwordx4 a[52:55], v5, s[40:43], s28 offen offset:1024
    v_mul_f32 v182, v54, v54
    v_mul_f32 v183, v55, v55
    s_waitcnt vmcnt(17)
    v_mfma_f32_16x16x32_bf16 v[128:131], a[60:63], v[160:163], v[128:131]
    ds_read_b128 v[152:155], v7 offset:7168
    v_fma_f32 v180, v180, v21, v17
    v_fma_f32 v181, v181, v21, v17
    v_mfma_f32_16x16x32_bf16 v[132:135], a[60:63], v[164:167], v[132:135]
    v_fma_f32 v182, v182, v21, v17
    v_fma_f32 v183, v183, v21, v17
    v_mfma_f32_16x16x32_bf16 v[136:139], a[60:63], v[168:171], v[136:139]
    ds_read_b128 v[156:159], v7 offset:26624
    v_mul_f32 v180, v180, v52
    v_mul_f32 v181, v181, v53
    v_mfma_f32_16x16x32_bf16 v[140:143], a[60:63], v[172:175], v[140:143]
    buffer_load_dwordx4 a[56:59], v5, s[40:43], s28 offen offset:2048
    v_mul_f32 v182, v182, v54
    v_mul_f32 v183, v183, v55
    s_setprio 1
    s_waitcnt vmcnt(17) lgkmcnt(3)
    v_mfma_f32_16x16x32_bf16 v[112:115], a[64:67], v[144:147], v[112:115]
    ds_read_b128 v[160:163], v5 offset:8192
    v_exp_f32 v180, v180
    v_exp_f32 v181, v181
    s_waitcnt lgkmcnt(3)
    v_mfma_f32_16x16x32_bf16 v[116:119], a[64:67], v[148:151], v[116:119]
    v_exp_f32 v182, v182
    s_waitcnt lgkmcnt(2)
    v_mfma_f32_16x16x32_bf16 v[120:123], a[64:67], v[152:155], v[120:123]
    ds_read_b128 v[164:167], v5 offset:27648
    v_exp_f32 v183, v183
    s_waitcnt lgkmcnt(2)
    v_mfma_f32_16x16x32_bf16 v[124:127], a[64:67], v[156:159], v[124:127]
    buffer_load_dwordx4 a[60:63], v5, s[40:43], s28 offen offset:3072
    v_fma_f32 v180, v180, v25, v25
    v_fma_f32 v181, v181, v25, v25
    s_waitcnt vmcnt(17)
    v_mfma_f32_16x16x32_bf16 v[128:131], a[68:71], v[144:147], v[128:131]
    ds_read_b128 v[168:171], v7 offset:8192
    v_fma_f32 v182, v182, v25, v25
    v_fma_f32 v183, v183, v25, v25
    v_mfma_f32_16x16x32_bf16 v[132:135], a[68:71], v[148:151], v[132:135]
    v_rcp_f32 v180, v180
    v_mfma_f32_16x16x32_bf16 v[136:139], a[68:71], v[152:155], v[136:139]
    ds_read_b128 v[172:175], v7 offset:27648
    v_rcp_f32 v181, v181
    v_rcp_f32 v182, v182
    v_mfma_f32_16x16x32_bf16 v[140:143], a[68:71], v[156:159], v[140:143]
    s_mov_b32 s28, 69632
    buffer_load_dwordx4 a[64:67], v5, s[40:43], s28 offen offset:0
    v_rcp_f32 v183, v183
    s_waitcnt vmcnt(17) lgkmcnt(3)
    v_mfma_f32_16x16x32_bf16 v[112:115], a[0:3], v[160:163], v[112:115]
    ds_read_b128 v[144:147], v5 offset:9216
    v_mul_f32 v180, v180, v52
    v_mul_f32 v181, v181, v53
    s_waitcnt lgkmcnt(3)
    v_mfma_f32_16x16x32_bf16 v[116:119], a[0:3], v[164:167], v[116:119]
    v_mul_f32 v182, v182, v54
    v_mul_f32 v183, v183, v55
    s_waitcnt lgkmcnt(2)
    v_mfma_f32_16x16x32_bf16 v[120:123], a[0:3], v[168:171], v[120:123]
    ds_read_b128 v[148:151], v5 offset:28672
    v_cvt_pk_bf16_f32 v38, v180, v181
    v_cvt_pk_bf16_f32 v39, v182, v183
    s_waitcnt lgkmcnt(2)
    v_mfma_f32_16x16x32_bf16 v[124:127], a[0:3], v[172:175], v[124:127]
    buffer_load_dwordx4 a[68:71], v5, s[40:43], s28 offen offset:1024
    ds_write_b128 v10, v[36:39] offset:1024
    s_waitcnt vmcnt(17)
    v_mfma_f32_16x16x32_bf16 v[128:131], a[4:7], v[160:163], v[128:131]
    ds_read_b128 v[152:155], v7 offset:9216
    v_mul_f32 v176, v40, v40
    v_mul_f32 v177, v41, v41
    v_mfma_f32_16x16x32_bf16 v[132:135], a[4:7], v[164:167], v[132:135]
    v_mul_f32 v178, v42, v42
    v_mul_f32 v179, v43, v43
    v_fma_f32 v176, v176, v22, v18
    v_mfma_f32_16x16x32_bf16 v[136:139], a[4:7], v[168:171], v[136:139]
    ds_read_b128 v[156:159], v7 offset:28672
    v_fma_f32 v177, v177, v22, v18
    v_fma_f32 v178, v178, v22, v18
    v_mfma_f32_16x16x32_bf16 v[140:143], a[4:7], v[172:175], v[140:143]
    buffer_load_dwordx4 a[0:3], v5, s[40:43], s28 offen offset:2048
    v_fma_f32 v179, v179, v22, v18
    v_mul_f32 v176, v176, v40
    s_waitcnt vmcnt(17) lgkmcnt(4)
    v_mfma_f32_16x16x32_bf16 v[112:115], a[8:11], v[144:147], v[112:115]
    ds_read_b128 v[160:163], v5 offset:10240
    v_mul_f32 v177, v177, v41
    v_mul_f32 v178, v178, v42
    s_waitcnt lgkmcnt(4)
    v_mfma_f32_16x16x32_bf16 v[116:119], a[8:11], v[148:151], v[116:119]
    v_mul_f32 v179, v179, v43
    v_exp_f32 v176, v176
    s_waitcnt lgkmcnt(2)
    v_mfma_f32_16x16x32_bf16 v[120:123], a[8:11], v[152:155], v[120:123]
    ds_read_b128 v[164:167], v5 offset:29696
    v_exp_f32 v177, v177
    s_waitcnt lgkmcnt(2)
    v_mfma_f32_16x16x32_bf16 v[124:127], a[8:11], v[156:159], v[124:127]
    buffer_load_dwordx4 a[4:7], v5, s[40:43], s28 offen offset:3072
    v_exp_f32 v178, v178
    s_waitcnt vmcnt(17)
    v_mfma_f32_16x16x32_bf16 v[128:131], a[12:15], v[144:147], v[128:131]
    ds_read_b128 v[168:171], v7 offset:10240
    v_exp_f32 v179, v179
    v_fma_f32 v176, v176, v26, v26
    v_mfma_f32_16x16x32_bf16 v[132:135], a[12:15], v[148:151], v[132:135]
    v_fma_f32 v177, v177, v26, v26
    v_fma_f32 v178, v178, v26, v26
    v_mfma_f32_16x16x32_bf16 v[136:139], a[12:15], v[152:155], v[136:139]
    ds_read_b128 v[172:175], v7 offset:29696
    v_fma_f32 v179, v179, v26, v26
    v_rcp_f32 v176, v176
    v_mfma_f32_16x16x32_bf16 v[140:143], a[12:15], v[156:159], v[140:143]
    buffer_load_dwordx4 a[8:11], v6, s[36:39], s33 offen offset:0
    v_rcp_f32 v177, v177
    s_waitcnt vmcnt(17) lgkmcnt(3)
    v_mfma_f32_16x16x32_bf16 v[112:115], a[16:19], v[160:163], v[112:115]
    ds_read_b128 v[144:147], v5 offset:11264
    v_rcp_f32 v178, v178
    s_waitcnt lgkmcnt(3)
    v_mfma_f32_16x16x32_bf16 v[116:119], a[16:19], v[164:167], v[116:119]
    v_rcp_f32 v179, v179
    v_mul_f32 v176, v176, v40
    s_waitcnt lgkmcnt(2)
    v_mfma_f32_16x16x32_bf16 v[120:123], a[16:19], v[168:171], v[120:123]
    ds_read_b128 v[148:151], v5 offset:30720
    v_mul_f32 v177, v177, v41
    v_mul_f32 v178, v178, v42
    s_waitcnt lgkmcnt(2)
    v_mfma_f32_16x16x32_bf16 v[124:127], a[16:19], v[172:175], v[124:127]
    buffer_load_dwordx4 a[12:15], v6, s[36:39], s33 offen offset:512
    v_mul_f32 v179, v179, v43
    v_cvt_pk_bf16_f32 v40, v176, v177
    s_waitcnt vmcnt(17)
    v_mfma_f32_16x16x32_bf16 v[128:131], a[20:23], v[160:163], v[128:131]
    ds_read_b128 v[152:155], v7 offset:11264
    v_cvt_pk_bf16_f32 v41, v178, v179
    v_mul_f32 v180, v56, v56
    v_mul_f32 v181, v57, v57
    v_mfma_f32_16x16x32_bf16 v[132:135], a[20:23], v[164:167], v[132:135]
    v_mul_f32 v182, v58, v58
    v_mul_f32 v183, v59, v59
    v_mfma_f32_16x16x32_bf16 v[136:139], a[20:23], v[168:171], v[136:139]
    ds_read_b128 v[156:159], v7 offset:30720
    v_fma_f32 v180, v180, v22, v18
    v_fma_f32 v181, v181, v22, v18
    v_mfma_f32_16x16x32_bf16 v[140:143], a[20:23], v[172:175], v[140:143]
    s_waitcnt vmcnt(15)
    v_cmp_ne_u32 vcc, 0, v30
    s_nop 0
    s_cmp_eq_u32 vcc_lo, 0x3ffff
    s_cbranch_scc1 .L_mlp_wk1x
    v_add_u32 v29, s34, v29
    s_mov_b32 s32, 0x40000
.L_mlp_wk1:
    buffer_load_dword v30, v29, s[56:59], 0 offen sc1
    s_waitcnt vmcnt(0)
    v_cmp_ne_u32 vcc, 0, v30
    s_sub_u32 s32, s32, 1
    s_cbranch_scc1 .L_mlp_wk1x
    s_cmp_lg_u32 vcc_lo, 0x3ffff
    s_cbranch_scc1 .L_mlp_wk1
.L_mlp_wk1x:
    s_mov_b32 s28, 73728
    buffer_load_dwordx4 a[16:19], v5, s[40:43], s28 offen offset:0 sc1
    v_fma_f32 v182, v182, v22, v18
    v_fma_f32 v183, v183, v22, v18
    s_waitcnt lgkmcnt(3)
    v_mfma_f32_16x16x32_bf16 v[112:115], a[24:27], v[144:147], v[112:115]
    ds_read_b128 v[160:163], v5 offset:12288
    v_mul_f32 v180, v180, v56
    v_mul_f32 v181, v181, v57
    s_waitcnt lgkmcnt(3)
    v_mfma_f32_16x16x32_bf16 v[116:119], a[24:27], v[148:151], v[116:119]
    v_mul_f32 v182, v182, v58
    v_mul_f32 v183, v183, v59
    s_waitcnt lgkmcnt(2)
    v_mfma_f32_16x16x32_bf16 v[120:123], a[24:27], v[152:155], v[120:123]
    ds_read_b128 v[164:167], v5 offset:31744
    v_exp_f32 v180, v180
    v_exp_f32 v181, v181
    s_waitcnt lgkmcnt(2)
    v_mfma_f32_16x16x32_bf16 v[124:127], a[24:27], v[156:159], v[124:127]
    buffer_load_dwordx4 a[20:23], v5, s[40:43], s28 offen offset:1024 sc1
    v_exp_f32 v182, v182
    s_waitcnt vmcnt(16)
    v_mfma_f32_16x16x32_bf16 v[128:131], a[28:31], v[144:147], v[128:131]
    ds_read_b128 v[168:171], v7 offset:12288
    v_exp_f32 v183, v183
    v_mfma_f32_16x16x32_bf16 v[132:135], a[28:31], v[148:151], v[132:135]
    v_fma_f32 v180, v180, v26, v26
    v_fma_f32 v181, v181, v26, v26
    v_mfma_f32_16x16x32_bf16 v[136:139], a[28:31], v[152:155], v[136:139]
    ds_read_b128 v[172:175], v7 offset:31744
    v_fma_f32 v182, v182, v26, v26
    v_fma_f32 v183, v183, v26, v26
    v_mfma_f32_16x16x32_bf16 v[140:143], a[28:31], v[156:159], v[140:143]
    buffer_load_dwordx4 a[24:27], v5, s[40:43], s28 offen offset:2048 sc1
    v_rcp_f32 v180, v180
    s_waitcnt vmcnt(16) lgkmcnt(3)
    v_mfma_f32_16x16x32_bf16 v[112:115], a[32:35], v[160:163], v[112:115]
    ds_read_b128 v[144:147], v5 offset:13312
    v_rcp_f32 v181, v181
    v_rcp_f32 v182, v182
    s_waitcnt lgkmcnt(3)
    v_mfma_f32_16x16x32_bf16 v[116:119], a[32:35], v[164:167], v[116:119]
    v_rcp_f32 v183, v183
    s_waitcnt lgkmcnt(2)
    v_mfma_f32_16x16x32_bf16 v[120:123], a[32:35], v[168:171], v[120:123]
    ds_read_b128 v[148:151], v5 offset:32768
    v_mul_f32 v180, v180, v56
    v_mul_f32 v181, v181, v57
    s_waitcnt lgkmcnt(2)
    v_mfma_f32_16x16x32_bf16 v[124:127], a[32:35], v[172:175], v[124:127]
    buffer_load_dwordx4 a[28:31], v5, s[40:43], s28 offen offset:3072 sc1
    v_mul_f32 v182, v182, v58
    v_mul_f32 v183, v183, v59
    s_waitcnt vmcnt(16)
    v_mfma_f32_16x16x32_bf16 v[128:131], a[36:39], v[160:163], v[128:131]
    ds_read_b128 v[152:155], v7 offset:13312
    v_cvt_pk_bf16_f32 v42, v180, v181
    v_cvt_pk_bf16_f32 v43, v182, v183
    v_mfma_f32_16x16x32_bf16 v[132:135], a[36:39], v[164:167], v[132:135]
    ds_write_b128 v10, v[40:43] offset:2048
    v_mfma_f32_16x16x32_bf16 v[136:139], a[36:39], v[168:171], v[136:139]
    ds_read_b128 v[156:159], v7 offset:32768
    v_mul_f32 v176, v44, v44
    v_mul_f32 v177, v45, v45
    v_mfma_f32_16x16x32_bf16 v[140:143], a[36:39], v[172:175], v[140:143]
    s_mov_b32 s28, 77824
    buffer_load_dwordx4 a[32:35], v5, s[40:43], s28 offen offset:0 sc1
    v_mul_f32 v178, v46, v46
    v_mul_f32 v179, v47, v47
    v_fma_f32 v176, v176, v23, v19
    s_setprio 0
    s_waitcnt vmcnt(16) lgkmcnt(4)
    v_mfma_f32_16x16x32_bf16 v[112:115], a[40:43], v[144:147], v[112:115]
    ds_read_b128 v[160:163], v5 offset:14336
    v_fma_f32 v177, v177, v23, v19
    v_fma_f32 v178, v178, v23, v19
    s_waitcnt lgkmcnt(4)
    v_mfma_f32_16x16x32_bf16 v[116:119], a[40:43], v[148:151], v[116:119]
    v_fma_f32 v179, v179, v23, v19
    v_mul_f32 v176, v176, v44
    s_waitcnt lgkmcnt(3)
    v_mfma_f32_16x16x32_bf16 v[120:123], a[40:43], v[152:155], v[120:123]
    ds_read_b128 v[164:167], v5 offset:33792
    v_mul_f32 v177, v177, v45
    v_mul_f32 v178, v178, v46
    s_waitcnt lgkmcnt(2)
    v_mfma_f32_16x16x32_bf16 v[124:127], a[40:43], v[156:159], v[124:127]
    buffer_load_dwordx4 a[36:39], v5, s[40:43], s28 offen offset:1024 sc1
    v_mul_f32 v179, v179, v47
    v_exp_f32 v176, v176
    s_waitcnt vmcnt(16)
    v_mfma_f32_16x16x32_bf16 v[128:131], a[44:47], v[144:147], v[128:131]
    ds_read_b128 v[168:171], v7 offset:14336
    v_exp_f32 v177, v177
    v_mfma_f32_16x16x32_bf16 v[132:135], a[44:47], v[148:151], v[132:135]
    v_exp_f32 v178, v178
    v_mfma_f32_16x16x32_bf16 v[136:139], a[44:47], v[152:155], v[136:139]
    ds_read_b128 v[172:175], v7 offset:33792
    v_exp_f32 v179, v179
    v_fma_f32 v176, v176, v27, v27
    v_mfma_f32_16x16x32_bf16 v[140:143], a[44:47], v[156:159], v[140:143]
    buffer_load_dwordx4 a[40:43], v5, s[40:43], s28 offen offset:2048 sc1
    v_fma_f32 v177, v177, v27, v27
    v_fma_f32 v178, v178, v27, v27
    s_waitcnt vmcnt(16) lgkmcnt(3)
    v_mfma_f32_16x16x32_bf16 v[112:115], a[48:51], v[160:163], v[112:115]
    ds_read_b128 v[144:147], v5 offset:15360
    v_fma_f32 v179, v179, v27, v27
    v_rcp_f32 v176, v176
    s_waitcnt lgkmcnt(3)
    v_mfma_f32_16x16x32_bf16 v[116:119], a[48:51], v[164:167], v[116:119]
    v_rcp_f32 v177, v177
    s_waitcnt lgkmcnt(2)
    v_mfma_f32_16x16x32_bf16 v[120:123], a[48:51], v[168:171], v[120:123]
    ds_read_b128 v[148:151], v5 offset:34816
    v_rcp_f32 v178, v178
    s_waitcnt lgkmcnt(2)
    v_mfma_f32_16x16x32_bf16 v[124:127], a[48:51], v[172:175], v[124:127]
    buffer_load_dwordx4 a[44:47], v5, s[40:43], s28 offen offset:3072 sc1
    v_rcp_f32 v179, v179
    v_mul_f32 v176, v176, v44
    s_waitcnt vmcnt(16)
    v_mfma_f32_16x16x32_bf16 v[128:131], a[52:55], v[160:163], v[128:131]
    ds_read_b128 v[152:155], v7 offset:15360
    v_mul_f32 v177, v177, v45
    v_mul_f32 v178, v178, v46
    v_mfma_f32_16x16x32_bf16 v[132:135], a[52:55], v[164:167], v[132:135]
    v_mul_f32 v179, v179, v47
    v_cvt_pk_bf16_f32 v44, v176, v177
    v_mfma_f32_16x16x32_bf16 v[136:139], a[52:55], v[168:171], v[136:139]
    ds_read_b128 v[156:159], v7 offset:34816
    v_cvt_pk_bf16_f32 v45, v178, v179
    v_mul_f32 v180, v60, v60
    v_mul_f32 v181, v61, v61
    v_mfma_f32_16x16x32_bf16 v[140:143], a[52:55], v[172:175], v[140:143]
    s_mov_b32 s28, 81920
    buffer_load_dwordx4 a[48:51], v5, s[40:43], s28 offen offset:0 sc1
    v_mul_f32 v182, v62, v62
    v_mul_f32 v183, v63, v63
    s_waitcnt vmcnt(16) lgkmcnt(3)
    v_mfma_f32_16x16x32_bf16 v[112:115], a[56:59], v[144:147], v[112:115]
    ds_read_b128 v[160:163], v5 offset:16384
    v_fma_f32 v180, v180, v23, v19
    v_fma_f32 v181, v181, v23, v19
    s_waitcnt lgkmcnt(3)
    v_mfma_f32_16x16x32_bf16 v[116:119], a[56:59], v[148:151], v[116:119]
    v_fma_f32 v182, v182, v23, v19
    v_fma_f32 v183, v183, v23, v19
    s_waitcnt lgkmcnt(2)
    v_mfma_f32_16x16x32_bf16 v[120:123], a[56:59], v[152:155], v[120:123]
    ds_read_b128 v[164:167], v5 offset:35840
    v_mul_f32 v180, v180, v60
    v_mul_f32 v181, v181, v61
    s_waitcnt lgkmcnt(2)
    v_mfma_f32_16x16x32_bf16 v[124:127], a[56:59], v[156:159], v[124:127]
    buffer_load_dwordx4 a[52:55], v5, s[40:43], s28 offen offset:1024 sc1
    v_mul_f32 v182, v182, v62
    v_mul_f32 v183, v183, v63
    s_waitcnt vmcnt(16)
    v_mfma_f32_16x16x32_bf16 v[128:131], a[60:63], v[144:147], v[128:131]
    ds_read_b128 v[168:171], v7 offset:16384
    v_exp_f32 v180, v180
    v_exp_f32 v181, v181
    v_mfma_f32_16x16x32_bf16 v[132:135], a[60:63], v[148:151], v[132:135]
    v_exp_f32 v182, v182
    v_mfma_f32_16x16x32_bf16 v[136:139], a[60:63], v[152:155], v[136:139]
    ds_read_b128 v[172:175], v7 offset:35840
    v_exp_f32 v183, v183
    v_mfma_f32_16x16x32_bf16 v[140:143], a[60:63], v[156:159], v[140:143]
    buffer_load_dwordx4 a[56:59], v5, s[40:43], s28 offen offset:2048 sc1
    v_fma_f32 v180, v180, v27, v27
    v_fma_f32 v181, v181, v27, v27
    s_waitcnt vmcnt(16) lgkmcnt(3)
    v_mfma_f32_16x16x32_bf16 v[112:115], a[64:67], v[160:163], v[112:115]
    ds_read_b128 v[144:147], v5 offset:17408
    v_fma_f32 v182, v182, v27, v27
    v_fma_f32 v183, v183, v27, v27
    s_waitcnt lgkmcnt(3)
    v_mfma_f32_16x16x32_bf16 v[116:119], a[64:67], v[164:167], v[116:119]
    v_rcp_f32 v180, v180
    s_waitcnt lgkmcnt(2)
    v_mfma_f32_16x16x32_bf16 v[120:123], a[64:67], v[168:171], v[120:123]
    ds_read_b128 v[148:151], v5 offset:36864
    v_rcp_f32 v181, v181
    v_rcp_f32 v182, v182
    s_waitcnt lgkmcnt(2)
    v_mfma_f32_16x16x32_bf16 v[124:127], a[64:67], v[172:175], v[124:127]
    buffer_load_dwordx4 a[60:63], v5, s[40:43], s28 offen offset:3072 sc1
    v_rcp_f32 v183, v183
    s_waitcnt vmcnt(16)
    v_mfma_f32_16x16x32_bf16 v[128:131], a[68:71], v[160:163], v[128:131]
    ds_read_b128 v[152:155], v7 offset:17408
    v_mul_f32 v180, v180, v60
    v_mul_f32 v181, v181, v61
    v_mfma_f32_16x16x32_bf16 v[132:135], a[68:71], v[164:167], v[132:135]
    v_mul_f32 v182, v182, v62
    v_mul_f32 v183, v183, v63
    v_mfma_f32_16x16x32_bf16 v[136:139], a[68:71], v[168:171], v[136:139]
    ds_read_b128 v[156:159], v7 offset:36864
    v_cvt_pk_bf16_f32 v46, v180, v181
    v_cvt_pk_bf16_f32 v47, v182, v183
    v_mfma_f32_16x16x32_bf16 v[140:143], a[68:71], v[172:175], v[140:143]
    s_mov_b32 s28, 86016
    buffer_load_dwordx4 a[64:67], v5, s[40:43], s28 offen offset:0 sc1
    ds_write_b128 v10, v[44:47] offset:3072
    s_waitcnt vmcnt(16) lgkmcnt(4)
    v_mfma_f32_16x16x32_bf16 v[112:115], a[0:3], v[144:147], v[112:115]
    ds_read_b128 v[160:163], v5 offset:18432
    s_waitcnt lgkmcnt(4)
    v_mfma_f32_16x16x32_bf16 v[116:119], a[0:3], v[148:151], v[116:119]
    s_waitcnt lgkmcnt(3)
    v_mfma_f32_16x16x32_bf16 v[120:123], a[0:3], v[152:155], v[120:123]
    ds_read_b128 v[164:167], v5 offset:37888
    s_waitcnt lgkmcnt(3)
    v_mfma_f32_16x16x32_bf16 v[124:127], a[0:3], v[156:159], v[124:127]
    buffer_load_dwordx4 a[68:71], v5, s[40:43], s28 offen offset:1024 sc1
    s_waitcnt vmcnt(16)
    v_mfma_f32_16x16x32_bf16 v[128:131], a[4:7], v[144:147], v[128:131]
    ds_read_b128 v[168:171], v7 offset:18432
    v_mfma_f32_16x16x32_bf16 v[132:135], a[4:7], v[148:151], v[132:135]
    v_mfma_f32_16x16x32_bf16 v[136:139], a[4:7], v[152:155], v[136:139]
    ds_read_b128 v[172:175], v7 offset:37888
    v_mfma_f32_16x16x32_bf16 v[140:143], a[4:7], v[156:159], v[140:143]
    buffer_load_dwordx4 a[0:3], v5, s[40:43], s28 offen offset:2048 sc1
    s_setprio 3
    s_waitcnt lgkmcnt(4)
    s_barrier
    s_waitcnt vmcnt(16) lgkmcnt(3)
    v_mfma_f32_16x16x32_bf16 v[112:115], a[8:11], v[160:163], v[112:115]
    ds_read_b128 v[144:147], v8 offset:0
    s_waitcnt lgkmcnt(3)
    v_mfma_f32_16x16x32_bf16 v[116:119], a[8:11], v[164:167], v[116:119]
    s_waitcnt lgkmcnt(2)
    v_mfma_f32_16x16x32_bf16 v[120:123], a[8:11], v[168:171], v[120:123]
    ds_read_b128 v[148:151], v8 offset:1024
    s_waitcnt lgkmcnt(2)
    v_mfma_f32_16x16x32_bf16 v[124:127], a[8:11], v[172:175], v[124:127]
    buffer_load_dwordx4 a[4:7], v5, s[40:43], s28 offen offset:3072 sc1
    s_waitcnt vmcnt(16)
    v_mfma_f32_16x16x32_bf16 v[128:131], a[12:15], v[160:163], v[128:131]
    ds_read_b128 v[152:155], v8 offset:2048
    v_mfma_f32_16x16x32_bf16 v[132:135], a[12:15], v[164:167], v[132:135]
    v_mfma_f32_16x16x32_bf16 v[136:139], a[12:15], v[168:171], v[136:139]
    ds_read_b128 v[156:159], v8 offset:3072
    v_mfma_f32_16x16x32_bf16 v[140:143], a[12:15], v[172:175], v[140:143]
    s_mov_b32 s28, 90112
    buffer_load_dwordx4 a[8:11], v5, s[40:43], s28 offen offset:0 sc1
    s_waitcnt vmcnt(16) lgkmcnt(3)
    v_mfma_f32_16x16x32_bf16 v[32:35], a[16:19], v[144:147], 0
    ds_read_b128 v[160:163], v8 offset:4096
    v_mul_f32 v176, v112, v112
    v_mul_f32 v177, v113, v113
    s_waitcnt lgkmcnt(3)
    v_mfma_f32_16x16x32_bf16 v[36:39], a[16:19], v[148:151], 0
    v_mul_f32 v178, v114, v114
    v_mul_f32 v179, v115, v115
    s_waitcnt lgkmcnt(2)
    v_mfma_f32_16x16x32_bf16 v[40:43], a[16:19], v[152:155], 0
    ds_read_b128 v[164:167], v8 offset:5120
    v_fma_f32 v176, v176, v20, v16
    s_waitcnt lgkmcnt(2)
    v_mfma_f32_16x16x32_bf16 v[44:47], a[16:19], v[156:159], 0
    buffer_load_dwordx4 a[12:15], v5, s[40:43], s28 offen offset:1024 sc1
    v_fma_f32 v177, v177, v20, v16
    v_fma_f32 v178, v178, v20, v16
    s_waitcnt vmcnt(16)
    v_mfma_f32_16x16x32_bf16 v[48:51], a[20:23], v[144:147], 0
    ds_read_b128 v[168:171], v8 offset:6144
    v_fma_f32 v179, v179, v20, v16
    v_mul_f32 v176, v176, v112
    v_mfma_f32_16x16x32_bf16 v[52:55], a[20:23], v[148:151], 0
    v_mul_f32 v177, v177, v113
    v_mul_f32 v178, v178, v114
    v_mfma_f32_16x16x32_bf16 v[56:59], a[20:23], v[152:155], 0
    ds_read_b128 v[172:175], v8 offset:7168
    v_mul_f32 v179, v179, v115
    v_mfma_f32_16x16x32_bf16 v[60:63], a[20:23], v[156:159], 0
    buffer_load_dwordx4 a[16:19], v5, s[40:43], s28 offen offset:2048 sc1
    v_exp_f32 v176, v176
    s_waitcnt vmcnt(16)
    v_mfma_f32_16x16x32_bf16 v[64:67], a[24:27], v[144:147], 0
    v_exp_f32 v177, v177
    v_mfma_f32_16x16x32_bf16 v[68:71], a[24:27], v[148:151], 0
    v_exp_f32 v178, v178
    v_mfma_f32_16x16x32_bf16 v[72:75], a[24:27], v[152:155], 0
    v_exp_f32 v179, v179
    v_mfma_f32_16x16x32_bf16 v[76:79], a[24:27], v[156:159], 0
    buffer_load_dwordx4 a[20:23], v5, s[40:43], s28 offen offset:3072 sc1
    v_fma_f32 v176, v176, v24, v24
    v_fma_f32 v177, v177, v24, v24
    s_waitcnt vmcnt(16)
    v_mfma_f32_16x16x32_bf16 v[80:83], a[28:31], v[144:147], 0
    v_fma_f32 v178, v178, v24, v24
    v_fma_f32 v179, v179, v24, v24
    v_mfma_f32_16x16x32_bf16 v[84:87], a[28:31], v[148:151], 0
    v_rcp_f32 v176, v176
    v_mfma_f32_16x16x32_bf16 v[88:91], a[28:31], v[152:155], 0
    v_rcp_f32 v177, v177
    v_mfma_f32_16x16x32_bf16 v[92:95], a[28:31], v[156:159], 0
    s_mov_b32 s28, 94208
    buffer_load_dwordx4 a[24:27], v5, s[40:43], s28 offen offset:0 sc1
    v_rcp_f32 v178, v178
    s_waitcnt vmcnt(16)
    v_mfma_f32_16x16x32_bf16 v[96:99], a[32:35], v[144:147], 0
    v_rcp_f32 v179, v179
    v_mfma_f32_16x16x32_bf16 v[100:103], a[32:35], v[148:151], 0
    v_mul_f32 v176, v176, v112
    v_mfma_f32_16x16x32_bf16 v[104:107], a[32:35], v[152:155], 0
    v_mul_f32 v177, v177, v113
    v_mul_f32 v178, v178, v114
    v_mfma_f32_16x16x32_bf16 v[108:111], a[32:35], v[156:159], 0
    buffer_load_dwordx4 a[28:31], v5, s[40:43], s28 offen offset:1024 sc1
    v_mul_f32 v179, v179, v115
    v_cvt_pk_bf16_f32 v112, v176, v177
    s_waitcnt vmcnt(16) lgkmcnt(3)
    v_mfma_f32_16x16x32_bf16 v[32:35], a[36:39], v[160:163], v[32:35]
    ds_read_b128 v[144:147], v8 offset:8192
    v_cvt_pk_bf16_f32 v113, v178, v179
    v_mul_f32 v180, v128, v128
    s_waitcnt lgkmcnt(3)
    v_mfma_f32_16x16x32_bf16 v[36:39], a[36:39], v[164:167], v[36:39]
    v_mul_f32 v181, v129, v129
    s_waitcnt lgkmcnt(2)
    v_mfma_f32_16x16x32_bf16 v[40:43], a[36:39], v[168:171], v[40:43]
    ds_read_b128 v[148:151], v8 offset:9216
    v_mul_f32 v182, v130, v130
    v_mul_f32 v183, v131, v131
    s_waitcnt lgkmcnt(2)
    v_mfma_f32_16x16x32_bf16 v[44:47], a[36:39], v[172:175], v[44:47]
    buffer_load_dwordx4 a[32:35], v5, s[40:43], s28 offen offset:2048 sc1
    v_fma_f32 v180, v180, v20, v16
    v_fma_f32 v181, v181, v20, v16
    s_waitcnt vmcnt(16)
    v_mfma_f32_16x16x32_bf16 v[48:51], a[40:43], v[160:163], v[48:51]
    ds_read_b128 v[152:155], v8 offset:10240
    v_fma_f32 v182, v182, v20, v16
    v_mfma_f32_16x16x32_bf16 v[52:55], a[40:43], v[164:167], v[52:55]
    v_fma_f32 v183, v183, v20, v16
    v_mul_f32 v180, v180, v128
    v_mfma_f32_16x16x32_bf16 v[56:59], a[40:43], v[168:171], v[56:59]
    ds_read_b128 v[156:159], v8 offset:11264
    v_mul_f32 v181, v181, v129
    v_mul_f32 v182, v182, v130
    v_mfma_f32_16x16x32_bf16 v[60:63], a[40:43], v[172:175], v[60:63]
    buffer_load_dwordx4 a[36:39], v5, s[40:43], s28 offen offset:3072 sc1
    v_mul_f32 v183, v183, v131
    v_exp_f32 v180, v180
    s_waitcnt vmcnt(16)
    v_mfma_f32_16x16x32_bf16 v[64:67], a[44:47], v[160:163], v[64:67]
    v_exp_f32 v181, v181
    v_mfma_f32_16x16x32_bf16 v[68:71], a[44:47], v[164:167], v[68:71]
    v_exp_f32 v182, v182
    v_mfma_f32_16x16x32_bf16 v[72:75], a[44:47], v[168:171], v[72:75]
    v_exp_f32 v183, v183
    v_mfma_f32_16x16x32_bf16 v[76:79], a[44:47], v[172:175], v[76:79]
    s_mov_b32 s28, 98304
    buffer_load_dwordx4 a[40:43], v5, s[40:43], s28 offen offset:0 sc1
    v_fma_f32 v180, v180, v24, v24
    s_waitcnt vmcnt(16)
    v_mfma_f32_16x16x32_bf16 v[80:83], a[48:51], v[160:163], v[80:83]
    v_fma_f32 v181, v181, v24, v24
    v_mfma_f32_16x16x32_bf16 v[84:87], a[48:51], v[164:167], v[84:87]
    v_fma_f32 v182, v182, v24, v24
    v_fma_f32 v183, v183, v24, v24
    v_mfma_f32_16x16x32_bf16 v[88:91], a[48:51], v[168:171], v[88:91]
    v_rcp_f32 v180, v180
    v_mfma_f32_16x16x32_bf16 v[92:95], a[48:51], v[172:175], v[92:95]
    buffer_load_dwordx4 a[44:47], v5, s[40:43], s28 offen offset:1024 sc1
    v_rcp_f32 v181, v181
    s_waitcnt vmcnt(16)
    v_mfma_f32_16x16x32_bf16 v[96:99], a[52:55], v[160:163], v[96:99]
    v_rcp_f32 v182, v182
    v_mfma_f32_16x16x32_bf16 v[100:103], a[52:55], v[164:167], v[100:103]
    v_rcp_f32 v183, v183
    v_mfma_f32_16x16x32_bf16 v[104:107], a[52:55], v[168:171], v[104:107]
    v_mul_f32 v180, v180, v128
    v_mul_f32 v181, v181, v129
    v_mfma_f32_16x16x32_bf16 v[108:111], a[52:55], v[172:175], v[108:111]
    buffer_load_dwordx4 a[48:51], v5, s[40:43], s28 offen offset:2048 sc1
    v_mul_f32 v182, v182, v130
    v_mul_f32 v183, v183, v131
    s_setprio 2
    s_waitcnt vmcnt(16) lgkmcnt(3)
    v_mfma_f32_16x16x32_bf16 v[32:35], a[56:59], v[144:147], v[32:35]
    ds_read_b128 v[160:163], v8 offset:12288
    v_cvt_pk_bf16_f32 v114, v180, v181
    s_waitcnt lgkmcnt(3)
    v_mfma_f32_16x16x32_bf16 v[36:39], a[56:59], v[148:151], v[36:39]
    v_cvt_pk_bf16_f32 v115, v182, v183
    s_waitcnt lgkmcnt(2)
    v_mfma_f32_16x16x32_bf16 v[40:43], a[56:59], v[152:155], v[40:43]
    ds_read_b128 v[164:167], v8 offset:13312
    ds_write_b128 v10, v[112:115] offset:40960
    s_waitcnt lgkmcnt(3)
    v_mfma_f32_16x16x32_bf16 v[44:47], a[56:59], v[156:159], v[44:47]
    buffer_load_dwordx4 a[52:55], v5, s[40:43], s28 offen offset:3072 sc1
    v_mul_f32 v176, v116, v116
    v_mul_f32 v177, v117, v117
    s_waitcnt vmcnt(16)
    v_mfma_f32_16x16x32_bf16 v[48:51], a[60:63], v[144:147], v[48:51]
    ds_read_b128 v[168:171], v8 offset:14336
    v_mul_f32 v178, v118, v118
    v_mul_f32 v179, v119, v119
    v_mfma_f32_16x16x32_bf16 v[52:55], a[60:63], v[148:151], v[52:55]
    v_fma_f32 v176, v176, v21, v17
    v_mfma_f32_16x16x32_bf16 v[56:59], a[60:63], v[152:155], v[56:59]
    ds_read_b128 v[172:175], v8 offset:15360
    v_fma_f32 v177, v177, v21, v17
    v_fma_f32 v178, v178, v21, v17
    v_mfma_f32_16x16x32_bf16 v[60:63], a[60:63], v[156:159], v[60:63]
    s_mov_b32 s28, 102400
    buffer_load_dwordx4 a[56:59], v5, s[40:43], s28 offen offset:0 sc1
    v_fma_f32 v179, v179, v21, v17
    v_mul_f32 v176, v176, v116
    s_waitcnt vmcnt(16)
    v_mfma_f32_16x16x32_bf16 v[64:67], a[64:67], v[144:147], v[64:67]
    v_mul_f32 v177, v177, v117
    v_mul_f32 v178, v178, v118
    v_mfma_f32_16x16x32_bf16 v[68:71], a[64:67], v[148:151], v[68:71]
    v_mul_f32 v179, v179, v119
    v_mfma_f32_16x16x32_bf16 v[72:75], a[64:67], v[152:155], v[72:75]
    v_exp_f32 v176, v176
    v_mfma_f32_16x16x32_bf16 v[76:79], a[64:67], v[156:159], v[76:79]
    buffer_load_dwordx4 a[60:63], v5, s[40:43], s28 offen offset:1024 sc1
    v_exp_f32 v177, v177
    s_waitcnt vmcnt(16)
    v_mfma_f32_16x16x32_bf16 v[80:83], a[68:71], v[144:147], v[80:83]
    v_exp_f32 v178, v178
    v_mfma_f32_16x16x32_bf16 v[84:87], a[68:71], v[148:151], v[84:87]
    v_exp_f32 v179, v179
    v_mfma_f32_16x16x32_bf16 v[88:91], a[68:71], v[152:155], v[88:91]
    v_fma_f32 v176, v176, v25, v25
    v_fma_f32 v177, v177, v25, v25
    v_mfma_f32_16x16x32_bf16 v[92:95], a[68:71], v[156:159], v[92:95]
    buffer_load_dwordx4 a[64:67], v5, s[40:43], s28 offen offset:2048 sc1
    v_fma_f32 v178, v178, v25, v25
    v_fma_f32 v179, v179, v25, v25
    s_waitcnt vmcnt(16)
    v_mfma_f32_16x16x32_bf16 v[96:99], a[0:3], v[144:147], v[96:99]
    v_rcp_f32 v176, v176
    v_mfma_f32_16x16x32_bf16 v[100:103], a[0:3], v[148:151], v[100:103]
    v_rcp_f32 v177, v177
    v_mfma_f32_16x16x32_bf16 v[104:107], a[0:3], v[152:155], v[104:107]
    v_rcp_f32 v178, v178
    v_mfma_f32_16x16x32_bf16 v[108:111], a[0:3], v[156:159], v[108:111]
    buffer_load_dwordx4 a[68:71], v5, s[40:43], s28 offen offset:3072 sc1
    v_rcp_f32 v179, v179
    s_waitcnt vmcnt(16) lgkmcnt(4)
    v_mfma_f32_16x16x32_bf16 v[32:35], a[4:7], v[160:163], v[32:35]
    ds_read_b128 v[144:147], v8 offset:16384
    v_mul_f32 v176, v176, v116
    s_waitcnt lgkmcnt(4)
    v_mfma_f32_16x16x32_bf16 v[36:39], a[4:7], v[164:167], v[36:39]
    v_mul_f32 v177, v177, v117
    v_mul_f32 v178, v178, v118
    s_waitcnt lgkmcnt(2)
    v_mfma_f32_16x16x32_bf16 v[40:43], a[4:7], v[168:171], v[40:43]
    ds_read_b128 v[148:151], v8 offset:17408
    v_mul_f32 v179, v179, v119
    v_cvt_pk_bf16_f32 v116, v176, v177
    s_waitcnt lgkmcnt(2)
    v_mfma_f32_16x16x32_bf16 v[44:47], a[4:7], v[172:175], v[44:47]
    s_mov_b32 s28, 106496
    buffer_load_dwordx4 a[0:3], v5, s[40:43], s28 offen offset:0 sc1
    v_cvt_pk_bf16_f32 v117, v178, v179
    v_mul_f32 v180, v132, v132
    s_waitcnt vmcnt(16)
    v_mfma_f32_16x16x32_bf16 v[48:51], a[8:11], v[160:163], v[48:51]
    ds_read_b128 v[152:155], v8 offset:18432
    v_mul_f32 v181, v133, v133
    v_mfma_f32_16x16x32_bf16 v[52:55], a[8:11], v[164:167], v[52:55]
    v_mul_f32 v182, v134, v134
    v_mul_f32 v183, v135, v135
    v_mfma_f32_16x16x32_bf16 v[56:59], a[8:11], v[168:171], v[56:59]
    ds_read_b128 v[156:159], v8 offset:19456
    v_fma_f32 v180, v180, v21, v17
    v_fma_f32 v181, v181, v21, v17
    v_mfma_f32_16x16x32_bf16 v[60:63], a[8:11], v[172:175], v[60:63]
    buffer_load_dwordx4 a[4:7], v5, s[40:43], s28 offen offset:1024 sc1
    v_fma_f32 v182, v182, v21, v17
    s_waitcnt vmcnt(16)
    v_mfma_f32_16x16x32_bf16 v[64:67], a[12:15], v[160:163], v[64:67]
    v_fma_f32 v183, v183, v21, v17
    v_mul_f32 v180, v180, v132
    v_mfma_f32_16x16x32_bf16 v[68:71], a[12:15], v[164:167], v[68:71]
    v_mul_f32 v181, v181, v133
    v_mul_f32 v182, v182, v134
    v_mfma_f32_16x16x32_bf16 v[72:75], a[12:15], v[168:171], v[72:75]
    v_mul_f32 v183, v183, v135
    v_exp_f32 v180, v180
    v_mfma_f32_16x16x32_bf16 v[76:79], a[12:15], v[172:175], v[76:79]
    buffer_load_dwordx4 a[8:11], v5, s[40:43], s28 offen offset:2048 sc1
    v_exp_f32 v181, v181
    s_waitcnt vmcnt(16)
    v_mfma_f32_16x16x32_bf16 v[80:83], a[16:19], v[160:163], v[80:83]
    v_exp_f32 v182, v182
    v_mfma_f32_16x16x32_bf16 v[84:87], a[16:19], v[164:167], v[84:87]
    v_exp_f32 v183, v183
    v_mfma_f32_16x16x32_bf16 v[88:91], a[16:19], v[168:171], v[88:91]
    v_fma_f32 v180, v180, v25, v25
    v_mfma_f32_16x16x32_bf16 v[92:95], a[16:19], v[172:175], v[92:95]
    buffer_load_dwordx4 a[12:15], v5, s[40:43], s28 offen offset:3072 sc1
    v_fma_f32 v181, v181, v25, v25
    s_waitcnt vmcnt(16)
    v_mfma_f32_16x16x32_bf16 v[96:99], a[20:23], v[160:163], v[96:99]
    v_fma_f32 v182, v182, v25, v25
    v_fma_f32 v183, v183, v25, v25
    v_mfma_f32_16x16x32_bf16 v[100:103], a[20:23], v[164:167], v[100:103]
    v_rcp_f32 v180, v180
    v_mfma_f32_16x16x32_bf16 v[104:107], a[20:23], v[168:171], v[104:107]
    v_rcp_f32 v181, v181
    v_mfma_f32_16x16x32_bf16 v[108:111], a[20:23], v[172:175], v[108:111]
    s_mov_b32 s28, 110592
    buffer_load_dwordx4 a[16:19], v5, s[40:43], s28 offen offset:0 sc1
    v_rcp_f32 v182, v182
    s_waitcnt vmcnt(16) lgkmcnt(3)
    v_mfma_f32_16x16x32_bf16 v[32:35], a[24:27], v[144:147], v[32:35]
    ds_read_b128 v[160:163], v8 offset:20480
    v_rcp_f32 v183, v183
    s_waitcnt lgkmcnt(3)
    v_mfma_f32_16x16x32_bf16 v[36:39], a[24:27], v[148:151], v[36:39]
    v_mul_f32 v180, v180, v132
    v_mul_f32 v181, v181, v133
    s_waitcnt lgkmcnt(2)
    v_mfma_f32_16x16x32_bf16 v[40:43], a[24:27], v[152:155], v[40:43]
    ds_read_b128 v[164:167], v8 offset:21504
    v_mul_f32 v182, v182, v134
    v_mul_f32 v183, v183, v135
    s_waitcnt lgkmcnt(2)
    v_mfma_f32_16x16x32_bf16 v[44:47], a[24:27], v[156:159], v[44:47]
    buffer_load_dwordx4 a[20:23], v5, s[40:43], s28 offen offset:1024 sc1
    v_cvt_pk_bf16_f32 v118, v180, v181
    s_waitcnt vmcnt(16)
    v_mfma_f32_16x16x32_bf16 v[48:51], a[28:31], v[144:147], v[48:51]
    ds_read_b128 v[168:171], v8 offset:22528
    v_cvt_pk_bf16_f32 v119, v182, v183
    v_mfma_f32_16x16x32_bf16 v[52:55], a[28:31], v[148:151], v[52:55]
    ds_write_b128 v10, v[116:119] offset:41984
    v_mfma_f32_16x16x32_bf16 v[56:59], a[28:31], v[152:155], v[56:59]
    ds_read_b128 v[172:175], v8 offset:23552
    v_mul_f32 v176, v120, v120
    v_mul_f32 v177, v121, v121
    v_mfma_f32_16x16x32_bf16 v[60:63], a[28:31], v[156:159], v[60:63]
    buffer_load_dwordx4 a[24:27], v5, s[40:43], s28 offen offset:2048 sc1
    v_mul_f32 v178, v122, v122
    v_mul_f32 v179, v123, v123
    s_waitcnt vmcnt(16)
    v_mfma_f32_16x16x32_bf16 v[64:67], a[32:35], v[144:147], v[64:67]
    v_fma_f32 v176, v176, v22, v18
    v_mfma_f32_16x16x32_bf16 v[68:71], a[32:35], v[148:151], v[68:71]
    v_fma_f32 v177, v177, v22, v18
    v_fma_f32 v178, v178, v22, v18
    v_mfma_f32_16x16x32_bf16 v[72:75], a[32:35], v[152:155], v[72:75]
    v_fma_f32 v179, v179, v22, v18
    v_mul_f32 v176, v176, v120
    v_mfma_f32_16x16x32_bf16 v[76:79], a[32:35], v[156:159], v[76:79]
    buffer_load_dwordx4 a[28:31], v5, s[40:43], s28 offen offset:3072 sc1
    v_mul_f32 v177, v177, v121
    v_mul_f32 v178, v178, v122
    s_waitcnt vmcnt(16)
    v_mfma_f32_16x16x32_bf16 v[80:83], a[36:39], v[144:147], v[80:83]
    v_mul_f32 v179, v179, v123
    v_mfma_f32_16x16x32_bf16 v[84:87], a[36:39], v[148:151], v[84:87]
    v_exp_f32 v176, v176
    v_mfma_f32_16x16x32_bf16 v[88:91], a[36:39], v[152:155], v[88:91]
    v_exp_f32 v177, v177
    v_mfma_f32_16x16x32_bf16 v[92:95], a[36:39], v[156:159], v[92:95]
    s_mov_b32 s28, 114688
    buffer_load_dwordx4 a[32:35], v5, s[40:43], s28 offen offset:0 sc1
    v_exp_f32 v178, v178
    s_waitcnt vmcnt(16)
    v_mfma_f32_16x16x32_bf16 v[96:99], a[40:43], v[144:147], v[96:99]
    v_exp_f32 v179, v179
    v_mfma_f32_16x16x32_bf16 v[100:103], a[40:43], v[148:151], v[100:103]
    v_fma_f32 v176, v176, v26, v26
    v_fma_f32 v177, v177, v26, v26
    v_mfma_f32_16x16x32_bf16 v[104:107], a[40:43], v[152:155], v[104:107]
    v_fma_f32 v178, v178, v26, v26
    v_fma_f32 v179, v179, v26, v26
    v_mfma_f32_16x16x32_bf16 v[108:111], a[40:43], v[156:159], v[108:111]
    buffer_load_dwordx4 a[36:39], v5, s[40:43], s28 offen offset:1024 sc1
    v_rcp_f32 v176, v176
    s_setprio 1
    s_waitcnt vmcnt(16) lgkmcnt(4)
    v_mfma_f32_16x16x32_bf16 v[32:35], a[44:47], v[160:163], v[32:35]
    ds_read_b128 v[144:147], v8 offset:24576
    v_rcp_f32 v177, v177
    s_waitcnt lgkmcnt(4)
    v_mfma_f32_16x16x32_bf16 v[36:39], a[44:47], v[164:167], v[36:39]
    v_rcp_f32 v178, v178
    s_waitcnt lgkmcnt(3)
    v_mfma_f32_16x16x32_bf16 v[40:43], a[44:47], v[168:171], v[40:43]
    ds_read_b128 v[148:151], v8 offset:25600
    v_rcp_f32 v179, v179
    s_waitcnt lgkmcnt(2)
    v_mfma_f32_16x16x32_bf16 v[44:47], a[44:47], v[172:175], v[44:47]
    buffer_load_dwordx4 a[40:43], v5, s[40:43], s28 offen offset:2048 sc1
    v_mul_f32 v176, v176, v120
    s_waitcnt vmcnt(16)
    v_mfma_f32_16x16x32_bf16 v[48:51], a[48:51], v[160:163], v[48:51]
    ds_read_b128 v[152:155], v8 offset:26624
    v_mul_f32 v177, v177, v121
    v_mul_f32 v178, v178, v122
    v_mfma_f32_16x16x32_bf16 v[52:55], a[48:51], v[164:167], v[52:55]
    v_mul_f32 v179, v179, v123
    v_cvt_pk_bf16_f32 v120, v176, v177
    v_mfma_f32_16x16x32_bf16 v[56:59], a[48:51], v[168:171], v[56:59]
    ds_read_b128 v[156:159], v8 offset:27648
    v_cvt_pk_bf16_f32 v121, v178, v179
    v_mul_f32 v180, v136, v136
    v_mfma_f32_16x16x32_bf16 v[60:63], a[48:51], v[172:175], v[60:63]
    buffer_load_dwordx4 a[44:47], v5, s[40:43], s28 offen offset:3072 sc1
    v_mul_f32 v181, v137, v137
    s_waitcnt vmcnt(16)
    v_mfma_f32_16x16x32_bf16 v[64:67], a[52:55], v[160:163], v[64:67]
    v_mul_f32 v182, v138, v138
    v_mul_f32 v183, v139, v139
    v_mfma_f32_16x16x32_bf16 v[68:71], a[52:55], v[164:167], v[68:71]
    v_fma_f32 v180, v180, v22, v18
    v_fma_f32 v181, v181, v22, v18
    v_mfma_f32_16x16x32_bf16 v[72:75], a[52:55], v[168:171], v[72:75]
    v_fma_f32 v182, v182, v22, v18
    v_mfma_f32_16x16x32_bf16 v[76:79], a[52:55], v[172:175], v[76:79]
    s_mov_b32 s28, 118784
    buffer_load_dwordx4 a[48:51], v5, s[40:43], s28 offen offset:0 sc1
    v_fma_f32 v183, v183, v22, v18
    v_mul_f32 v180, v180, v136
    s_waitcnt vmcnt(16)
    v_mfma_f32_16x16x32_bf16 v[80:83], a[56:59], v[160:163], v[80:83]
    v_mul_f32 v181, v181, v137
    v_mul_f32 v182, v182, v138
    v_mfma_f32_16x16x32_bf16 v[84:87], a[56:59], v[164:167], v[84:87]
    v_mul_f32 v183, v183, v139
    v_exp_f32 v180, v180
    v_mfma_f32_16x16x32_bf16 v[88:91], a[56:59], v[168:171], v[88:91]
    v_exp_f32 v181, v181
    v_mfma_f32_16x16x32_bf16 v[92:95], a[56:59], v[172:175], v[92:95]
    buffer_load_dwordx4 a[52:55], v5, s[40:43], s28 offen offset:1024 sc1
    v_exp_f32 v182, v182
    s_waitcnt vmcnt(16)
    v_mfma_f32_16x16x32_bf16 v[96:99], a[60:63], v[160:163], v[96:99]
    v_exp_f32 v183, v183
    v_mfma_f32_16x16x32_bf16 v[100:103], a[60:63], v[164:167], v[100:103]
    v_fma_f32 v180, v180, v26, v26
    v_mfma_f32_16x16x32_bf16 v[104:107], a[60:63], v[168:171], v[104:107]
    v_fma_f32 v181, v181, v26, v26
    v_mfma_f32_16x16x32_bf16 v[108:111], a[60:63], v[172:175], v[108:111]
    buffer_load_dwordx4 a[56:59], v5, s[40:43], s28 offen offset:2048 sc1
    v_fma_f32 v182, v182, v26, v26
    v_fma_f32 v183, v183, v26, v26
    s_waitcnt vmcnt(16) lgkmcnt(3)
    v_mfma_f32_16x16x32_bf16 v[32:35], a[64:67], v[144:147], v[32:35]
    ds_read_b128 v[160:163], v8 offset:28672
    v_rcp_f32 v180, v180
    s_waitcnt lgkmcnt(3)
    v_mfma_f32_16x16x32_bf16 v[36:39], a[64:67], v[148:151], v[36:39]
    v_rcp_f32 v181, v181
    s_waitcnt lgkmcnt(2)
    v_mfma_f32_16x16x32_bf16 v[40:43], a[64:67], v[152:155], v[40:43]
    ds_read_b128 v[164:167], v8 offset:29696
    v_rcp_f32 v182, v182
    s_waitcnt lgkmcnt(2)
    v_mfma_f32_16x16x32_bf16 v[44:47], a[64:67], v[156:159], v[44:47]
    buffer_load_dwordx4 a[60:63], v5, s[40:43], s28 offen offset:3072 sc1
    v_rcp_f32 v183, v183
    s_waitcnt vmcnt(16)
    v_mfma_f32_16x16x32_bf16 v[48:51], a[68:71], v[144:147], v[48:51]
    ds_read_b128 v[168:171], v8 offset:30720
    v_mul_f32 v180, v180, v136
    v_mul_f32 v181, v181, v137
    v_mfma_f32_16x16x32_bf16 v[52:55], a[68:71], v[148:151], v[52:55]
    v_mul_f32 v182, v182, v138
    v_mul_f32 v183, v183, v139
    v_mfma_f32_16x16x32_bf16 v[56:59], a[68:71], v[152:155], v[56:59]
    ds_read_b128 v[172:175], v8 offset:31744
    v_cvt_pk_bf16_f32 v122, v180, v181
    v_mfma_f32_16x16x32_bf16 v[60:63], a[68:71], v[156:159], v[60:63]
    s_mov_b32 s28, 122880
    buffer_load_dwordx4 a[64:67], v5, s[40:43], s28 offen offset:0 sc1
    v_cvt_pk_bf16_f32 v123, v182, v183
    s_waitcnt vmcnt(16)
    v_mfma_f32_16x16x32_bf16 v[64:67], a[0:3], v[144:147], v[64:67]
    ds_write_b128 v10, v[120:123] offset:43008
    v_mfma_f32_16x16x32_bf16 v[68:71], a[0:3], v[148:151], v[68:71]
    v_mul_f32 v176, v124, v124
    v_mul_f32 v177, v125, v125
    v_mfma_f32_16x16x32_bf16 v[72:75], a[0:3], v[152:155], v[72:75]
    v_mul_f32 v178, v126, v126
    v_mul_f32 v179, v127, v127
    v_mfma_f32_16x16x32_bf16 v[76:79], a[0:3], v[156:159], v[76:79]
    buffer_load_dwordx4 a[68:71], v5, s[40:43], s28 offen offset:1024 sc1
    v_fma_f32 v176, v176, v23, v19
    s_waitcnt vmcnt(16)
    v_mfma_f32_16x16x32_bf16 v[80:83], a[4:7], v[144:147], v[80:83]
    v_fma_f32 v177, v177, v23, v19
    v_fma_f32 v178, v178, v23, v19
    v_mfma_f32_16x16x32_bf16 v[84:87], a[4:7], v[148:151], v[84:87]
    v_fma_f32 v179, v179, v23, v19
    v_mul_f32 v176, v176, v124
    v_mfma_f32_16x16x32_bf16 v[88:91], a[4:7], v[152:155], v[88:91]
    v_mul_f32 v177, v177, v125
    v_mul_f32 v178, v178, v126
    v_mfma_f32_16x16x32_bf16 v[92:95], a[4:7], v[156:159], v[92:95]
    buffer_load_dwordx4 a[0:3], v5, s[40:43], s28 offen offset:2048 sc1
    v_mul_f32 v179, v179, v127
    s_waitcnt vmcnt(16)
    v_mfma_f32_16x16x32_bf16 v[96:99], a[8:11], v[144:147], v[96:99]
    v_exp_f32 v176, v176
    v_mfma_f32_16x16x32_bf16 v[100:103], a[8:11], v[148:151], v[100:103]
    v_exp_f32 v177, v177
    v_mfma_f32_16x16x32_bf16 v[104:107], a[8:11], v[152:155], v[104:107]
    v_exp_f32 v178, v178
    v_mfma_f32_16x16x32_bf16 v[108:111], a[8:11], v[156:159], v[108:111]
    buffer_load_dwordx4 a[4:7], v5, s[40:43], s28 offen offset:3072 sc1
    v_exp_f32 v179, v179
    s_setprio 0
    s_waitcnt vmcnt(16) lgkmcnt(4)
    v_mfma_f32_16x16x32_bf16 v[32:35], a[12:15], v[160:163], v[32:35]
    ds_read_b128 v[144:147], v8 offset:32768
    v_fma_f32 v176, v176, v27, v27
    v_fma_f32 v177, v177, v27, v27
    s_waitcnt lgkmcnt(4)
    v_mfma_f32_16x16x32_bf16 v[36:39], a[12:15], v[164:167], v[36:39]
    v_fma_f32 v178, v178, v27, v27
    v_fma_f32 v179, v179, v27, v27
    s_waitcnt lgkmcnt(3)
    v_mfma_f32_16x16x32_bf16 v[40:43], a[12:15], v[168:171], v[40:43]
    ds_read_b128 v[148:151], v8 offset:33792
    v_rcp_f32 v176, v176
    s_waitcnt lgkmcnt(3)
    v_mfma_f32_16x16x32_bf16 v[44:47], a[12:15], v[172:175], v[44:47]
    s_mov_b32 s28, 126976
    buffer_load_dwordx4 a[8:11], v5, s[40:43], s28 offen offset:0 sc1
    v_rcp_f32 v177, v177
    s_waitcnt vmcnt(16)
    v_mfma_f32_16x16x32_bf16 v[48:51], a[16:19], v[160:163], v[48:51]
    ds_read_b128 v[152:155], v8 offset:34816
    v_rcp_f32 v178, v178
    v_mfma_f32_16x16x32_bf16 v[52:55], a[16:19], v[164:167], v[52:55]
    v_rcp_f32 v179, v179
    v_mfma_f32_16x16x32_bf16 v[56:59], a[16:19], v[168:171], v[56:59]
    ds_read_b128 v[156:159], v8 offset:35840
    v_mul_f32 v176, v176, v124
    v_mfma_f32_16x16x32_bf16 v[60:63], a[16:19], v[172:175], v[60:63]
    buffer_load_dwordx4 a[12:15], v5, s[40:43], s28 offen offset:1024 sc1
    v_mul_f32 v177, v177, v125
    v_mul_f32 v178, v178, v126
    s_waitcnt vmcnt(16)
    v_mfma_f32_16x16x32_bf16 v[64:67], a[20:23], v[160:163], v[64:67]
    v_mul_f32 v179, v179, v127
    v_cvt_pk_bf16_f32 v124, v176, v177
    v_mfma_f32_16x16x32_bf16 v[68:71], a[20:23], v[164:167], v[68:71]
    v_cvt_pk_bf16_f32 v125, v178, v179
    v_mul_f32 v180, v140, v140
    v_mfma_f32_16x16x32_bf16 v[72:75], a[20:23], v[168:171], v[72:75]
    v_mul_f32 v181, v141, v141
    v_mfma_f32_16x16x32_bf16 v[76:79], a[20:23], v[172:175], v[76:79]
    buffer_load_dwordx4 a[16:19], v5, s[40:43], s28 offen offset:2048 sc1
    v_mul_f32 v182, v142, v142
    v_mul_f32 v183, v143, v143
    s_waitcnt vmcnt(16)
    v_mfma_f32_16x16x32_bf16 v[80:83], a[24:27], v[160:163], v[80:83]
    v_fma_f32 v180, v180, v23, v19
    v_fma_f32 v181, v181, v23, v19
    v_mfma_f32_16x16x32_bf16 v[84:87], a[24:27], v[164:167], v[84:87]
    v_fma_f32 v182, v182, v23, v19
    v_mfma_f32_16x16x32_bf16 v[88:91], a[24:27], v[168:171], v[88:91]
    v_fma_f32 v183, v183, v23, v19
    v_mul_f32 v180, v180, v140
    v_mfma_f32_16x16x32_bf16 v[92:95], a[24:27], v[172:175], v[92:95]
    buffer_load_dwordx4 a[20:23], v5, s[40:43], s28 offen offset:3072 sc1
    v_mul_f32 v181, v181, v141
    v_mul_f32 v182, v182, v142
    s_waitcnt vmcnt(16)
    v_mfma_f32_16x16x32_bf16 v[96:99], a[28:31], v[160:163], v[96:99]
    v_mul_f32 v183, v183, v143
    v_exp_f32 v180, v180
    v_mfma_f32_16x16x32_bf16 v[100:103], a[28:31], v[164:167], v[100:103]
    v_exp_f32 v181, v181
    v_mfma_f32_16x16x32_bf16 v[104:107], a[28:31], v[168:171], v[104:107]
    v_exp_f32 v182, v182
    v_mfma_f32_16x16x32_bf16 v[108:111], a[28:31], v[172:175], v[108:111]
    s_mov_b32 s28, 131072
    buffer_load_dwordx4 a[24:27], v5, s[40:43], s28 offen offset:0 sc1
    v_exp_f32 v183, v183
    s_waitcnt vmcnt(16) lgkmcnt(3)
    v_mfma_f32_16x16x32_bf16 v[32:35], a[32:35], v[144:147], v[32:35]
    ds_read_b128 v[160:163], v9 offset:0
    v_fma_f32 v180, v180, v27, v27
    s_waitcnt lgkmcnt(3)
    v_mfma_f32_16x16x32_bf16 v[36:39], a[32:35], v[148:151], v[36:39]
    v_fma_f32 v181, v181, v27, v27
    s_waitcnt lgkmcnt(2)
    v_mfma_f32_16x16x32_bf16 v[40:43], a[32:35], v[152:155], v[40:43]
    ds_read_b128 v[164:167], v9 offset:1024
    v_fma_f32 v182, v182, v27, v27
    v_fma_f32 v183, v183, v27, v27
    s_waitcnt lgkmcnt(2)
    v_mfma_f32_16x16x32_bf16 v[44:47], a[32:35], v[156:159], v[44:47]
    buffer_load_dwordx4 a[28:31], v5, s[40:43], s28 offen offset:1024 sc1
    v_rcp_f32 v180, v180
    s_waitcnt vmcnt(16)
    v_mfma_f32_16x16x32_bf16 v[48:51], a[36:39], v[144:147], v[48:51]
    ds_read_b128 v[168:171], v9 offset:2048
    v_rcp_f32 v181, v181
    v_mfma_f32_16x16x32_bf16 v[52:55], a[36:39], v[148:151], v[52:55]
    v_rcp_f32 v182, v182
    v_mfma_f32_16x16x32_bf16 v[56:59], a[36:39], v[152:155], v[56:59]
    ds_read_b128 v[172:175], v9 offset:3072
    v_rcp_f32 v183, v183
    v_mfma_f32_16x16x32_bf16 v[60:63], a[36:39], v[156:159], v[60:63]
    buffer_load_dwordx4 a[32:35], v5, s[40:43], s28 offen offset:2048 sc1
    v_mul_f32 v180, v180, v140
    v_mul_f32 v181, v181, v141
    s_waitcnt vmcnt(16)
    v_mfma_f32_16x16x32_bf16 v[64:67], a[40:43], v[144:147], v[64:67]
    v_mul_f32 v182, v182, v142
    v_mul_f32 v183, v183, v143
    v_mfma_f32_16x16x32_bf16 v[68:71], a[40:43], v[148:151], v[68:71]
    v_cvt_pk_bf16_f32 v126, v180, v181
    v_mfma_f32_16x16x32_bf16 v[72:75], a[40:43], v[152:155], v[72:75]
    v_cvt_pk_bf16_f32 v127, v182, v183
    v_mfma_f32_16x16x32_bf16 v[76:79], a[40:43], v[156:159], v[76:79]
    buffer_load_dwordx4 a[36:39], v5, s[40:43], s28 offen offset:3072 sc1
    ds_write_b128 v10, v[124:127] offset:44032
    s_waitcnt vmcnt(16)
    v_mfma_f32_16x16x32_bf16 v[80:83], a[44:47], v[144:147], v[80:83]
    v_mfma_f32_16x16x32_bf16 v[84:87], a[44:47], v[148:151], v[84:87]
    v_mfma_f32_16x16x32_bf16 v[88:91], a[44:47], v[152:155], v[88:91]
    v_mfma_f32_16x16x32_bf16 v[92:95], a[44:47], v[156:159], v[92:95]
    s_mov_b32 s28, 135168
    buffer_load_dwordx4 a[40:43], v5, s[40:43], s28 offen offset:0 sc1
    s_waitcnt vmcnt(16)
    v_mfma_f32_16x16x32_bf16 v[96:99], a[48:51], v[144:147], v[96:99]
    v_mfma_f32_16x16x32_bf16 v[100:103], a[48:51], v[148:151], v[100:103]
    v_mfma_f32_16x16x32_bf16 v[104:107], a[48:51], v[152:155], v[104:107]
    v_mfma_f32_16x16x32_bf16 v[108:111], a[48:51], v[156:159], v[108:111]
    buffer_load_dwordx4 a[44:47], v5, s[40:43], s28 offen offset:1024 sc1
    s_setprio 3
    s_waitcnt lgkmcnt(0)
    s_barrier
    s_waitcnt vmcnt(16)
    v_mfma_f32_16x16x32_bf16 v[32:35], a[52:55], v[160:163], v[32:35]
    ds_read_b128 v[144:147], v9 offset:4096
    v_mfma_f32_16x16x32_bf16 v[36:39], a[52:55], v[164:167], v[36:39]
    v_mfma_f32_16x16x32_bf16 v[40:43], a[52:55], v[168:171], v[40:43]
    ds_read_b128 v[148:151], v9 offset:5120
    v_mfma_f32_16x16x32_bf16 v[44:47], a[52:55], v[172:175], v[44:47]
    buffer_load_dwordx4 a[48:51], v5, s[40:43], s28 offen offset:2048 sc1
    s_waitcnt vmcnt(16)
    v_mfma_f32_16x16x32_bf16 v[48:51], a[56:59], v[160:163], v[48:51]
    ds_read_b128 v[152:155], v9 offset:6144
    v_mfma_f32_16x16x32_bf16 v[52:55], a[56:59], v[164:167], v[52:55]
    v_mfma_f32_16x16x32_bf16 v[56:59], a[56:59], v[168:171], v[56:59]
    ds_read_b128 v[156:159], v9 offset:7168
    v_mfma_f32_16x16x32_bf16 v[60:63], a[56:59], v[172:175], v[60:63]
    buffer_load_dwordx4 a[52:55], v5, s[40:43], s28 offen offset:3072 sc1
    s_waitcnt vmcnt(16)
    v_mfma_f32_16x16x32_bf16 v[64:67], a[60:63], v[160:163], v[64:67]
    v_mfma_f32_16x16x32_bf16 v[68:71], a[60:63], v[164:167], v[68:71]
    v_mfma_f32_16x16x32_bf16 v[72:75], a[60:63], v[168:171], v[72:75]
    v_mfma_f32_16x16x32_bf16 v[76:79], a[60:63], v[172:175], v[76:79]
    s_mov_b32 s28, 139264
    buffer_load_dwordx4 a[56:59], v5, s[40:43], s28 offen offset:0 sc1
    s_waitcnt vmcnt(16)
    v_mfma_f32_16x16x32_bf16 v[80:83], a[64:67], v[160:163], v[80:83]
    v_mfma_f32_16x16x32_bf16 v[84:87], a[64:67], v[164:167], v[84:87]
    v_mfma_f32_16x16x32_bf16 v[88:91], a[64:67], v[168:171], v[88:91]
    v_mfma_f32_16x16x32_bf16 v[92:95], a[64:67], v[172:175], v[92:95]
    buffer_load_dwordx4 a[60:63], v5, s[40:43], s28 offen offset:1024 sc1
    s_waitcnt vmcnt(16)
    v_mfma_f32_16x16x32_bf16 v[96:99], a[68:71], v[160:163], v[96:99]
    v_mfma_f32_16x16x32_bf16 v[100:103], a[68:71], v[164:167], v[100:103]
    v_mfma_f32_16x16x32_bf16 v[104:107], a[68:71], v[168:171], v[104:107]
    v_mfma_f32_16x16x32_bf16 v[108:111], a[68:71], v[172:175], v[108:111]
    buffer_load_dwordx4 a[64:67], v5, s[40:43], s28 offen offset:2048 sc1
    s_waitcnt vmcnt(16) lgkmcnt(3)
    v_mfma_f32_16x16x32_bf16 v[96:99], a[0:3], v[144:147], v[96:99]
    ds_read_b128 v[160:163], v9 offset:8192
    s_lshr_b32 s24, s21, 1
    s_and_b32 s25, s21, 1
    s_waitcnt lgkmcnt(3)
    v_mfma_f32_16x16x32_bf16 v[100:103], a[0:3], v[148:151], v[100:103]
    ds_read_b128 v[164:167], v9 offset:9216
    s_add_u32 s26, s23, s24
    v_and_b32 v6, 7, v1
    s_waitcnt lgkmcnt(3)
    v_mfma_f32_16x16x32_bf16 v[104:107], a[0:3], v[152:155], v[104:107]
    ds_read_b128 v[168:171], v9 offset:10240
    v_lshrrev_b32 v7, 3, v1
    v_mov_b32 v10, 0x80000000
    s_waitcnt lgkmcnt(3)
    v_mfma_f32_16x16x32_bf16 v[108:111], a[0:3], v[156:159], v[108:111]
    ds_read_b128 v[172:175], v9 offset:11264
    buffer_load_dwordx4 a[68:71], v5, s[40:43], s28 offen offset:3072 sc1
    s_mul_i32 s30, s19, 144
    v_lshl_add_u32 v20, v7, 4, s30
    s_waitcnt vmcnt(16) lgkmcnt(3)
    v_mfma_f32_16x16x32_bf16 v[96:99], a[4:7], v[160:163], v[96:99]
    ds_read_b128 v[144:147], v9 offset:12288
    s_lshr_b32 s27, s19, 2
    s_lshl_b32 s27, s27, 2
    s_waitcnt lgkmcnt(3)
    v_mfma_f32_16x16x32_bf16 v[100:103], a[4:7], v[164:167], v[100:103]
    ds_read_b128 v[148:151], v9 offset:13312
    s_and_b32 s29, s19, 1
    s_add_u32 s27, s27, s29
    s_waitcnt lgkmcnt(3)
    v_mfma_f32_16x16x32_bf16 v[104:107], a[4:7], v[168:171], v[104:107]
    ds_read_b128 v[152:155], v9 offset:14336
    s_bfe_u32 s29, s19, 0x10001
    s_lshl_b32 s29, s29, 3
    s_waitcnt lgkmcnt(3)
    v_mfma_f32_16x16x32_bf16 v[108:111], a[4:7], v[172:175], v[108:111]
    ds_read_b128 v[156:159], v9 offset:15360
    s_mov_b32 s28, 143360
    buffer_load_dwordx4 a[0:3], v5, s[40:43], s28 offen offset:0 sc1
    s_mul_i32 s30, s27, 144
    s_add_u32 s30, s30, s29
    s_waitcnt vmcnt(16) lgkmcnt(3)
    v_mfma_f32_16x16x32_bf16 v[96:99], a[8:11], v[144:147], v[96:99]
    ds_read_b128 v[160:163], v9 offset:16384
    s_add_u32 s30, s30, 128
    v_lshrrev_b32 v14, 5, v1
    s_waitcnt lgkmcnt(3)
    v_mfma_f32_16x16x32_bf16 v[100:103], a[8:11], v[148:151], v[100:103]
    ds_read_b128 v[164:167], v9 offset:17408
    v_mul_u32_u24 v21, 288, v14
    v_add_u32 v21, s30, v21
    s_waitcnt lgkmcnt(3)
    v_mfma_f32_16x16x32_bf16 v[104:107], a[8:11], v[152:155], v[104:107]
    ds_read_b128 v[168:171], v9 offset:18432
    v_add_u32 v11, 151808, v20
    v_add_u32 v12, 151808, v21
    s_waitcnt lgkmcnt(3)
    v_mfma_f32_16x16x32_bf16 v[108:111], a[8:11], v[156:159], v[108:111]
    ds_read_b128 v[172:175], v9 offset:19456
    buffer_load_dwordx4 a[4:7], v5, s[40:43], s28 offen offset:1024 sc1
    ds_read_b128 v[120:123], v11
    ds_read_b64 v[124:125], v12
    s_waitcnt vmcnt(16) lgkmcnt(5)
    v_mfma_f32_16x16x32_bf16 v[96:99], a[12:15], v[160:163], v[96:99]
    ds_read_b128 v[144:147], v9 offset:20480
    v_and_b32 v13, 24, v1
    v_cmp_eq_u32 s[0:1], 0, v13
    s_waitcnt lgkmcnt(5)
    v_mfma_f32_16x16x32_bf16 v[100:103], a[12:15], v[164:167], v[100:103]
    ds_read_b128 v[148:151], v9 offset:21504
    v_cndmask_b32 v21, v10, v21, s[0:1]
    v_bfe_u32 v176, v1, 3, 1
    s_waitcnt lgkmcnt(5)
    v_mfma_f32_16x16x32_bf16 v[104:107], a[12:15], v[168:171], v[104:107]
    ds_read_b128 v[152:155], v9 offset:22528
    v_cmp_eq_u32 vcc, s25, v176
    s_nop 1
    v_cndmask_b32 v176, v15, v10, vcc
    s_waitcnt lgkmcnt(5)
    v_mfma_f32_16x16x32_bf16 v[108:111], a[12:15], v[172:175], v[108:111]
    ds_read_b128 v[156:159], v9 offset:23552
    buffer_load_dwordx4 a[8:11], v5, s[40:43], s28 offen offset:2048 sc1
    s_lshl_b32 s31, s19, 11
    s_lshl_b32 s33, s25, 7
    s_waitcnt vmcnt(16) lgkmcnt(3)
    v_mfma_f32_16x16x32_bf16 v[96:99], a[16:19], v[144:147], v[96:99]
    ds_read_b128 v[160:163], v9 offset:24576
    s_add_u32 s31, s31, s33
    v_lshl_add_u32 v18, v6, 4, s31
    s_waitcnt lgkmcnt(3)
    v_mfma_f32_16x16x32_bf16 v[100:103], a[16:19], v[148:151], v[100:103]
    ds_read_b128 v[164:167], v9 offset:25600
    v_lshl_add_u32 v18, v7, 8, v18
    v_lshrrev_b32 v11, 5, v1
    s_waitcnt lgkmcnt(3)
    v_mfma_f32_16x16x32_bf16 v[104:107], a[16:19], v[152:155], v[104:107]
    ds_read_b128 v[168:171], v9 offset:26624
    v_and_b32 v16, 0xfffffbff, v18
    s_lshr_b32 s31, s21, 2
    s_waitcnt lgkmcnt(3)
    v_mfma_f32_16x16x32_bf16 v[108:111], a[16:19], v[156:159], v[108:111]
    ds_read_b128 v[172:175], v9 offset:27648
    buffer_load_dwordx4 a[12:15], v5, s[40:43], s28 offen offset:3072 sc1
    v_xor_b32 v11, s31, v11
    s_mov_b32 s31, 9437184
    s_waitcnt vmcnt(16) lgkmcnt(3)
    v_mfma_f32_16x16x32_bf16 v[96:99], a[20:23], v[160:163], v[96:99]
    ds_read_b128 v[144:147], v9 offset:28672
    v_mad_u32_u24 v16, v11, s31, v16
    v_cmp_gt_u32 vcc, 32, v1
    s_nop 1
    v_cndmask_b32 v177, v16, v10, vcc
    s_waitcnt lgkmcnt(3)
    v_mfma_f32_16x16x32_bf16 v[100:103], a[20:23], v[164:167], v[100:103]
    ds_read_b128 v[148:151], v9 offset:29696
    s_waitcnt lgkmcnt(3)
    v_mfma_f32_16x16x32_bf16 v[104:107], a[20:23], v[168:171], v[104:107]
    ds_read_b128 v[152:155], v9 offset:30720
    s_lshl_b32 s31, s19, 7
    s_lshl_b32 s32, s25, 10
    s_waitcnt lgkmcnt(3)
    v_mfma_f32_16x16x32_bf16 v[108:111], a[20:23], v[172:175], v[108:111]
    ds_read_b128 v[156:159], v9 offset:31744
    s_mov_b32 s28, 147456
    buffer_load_dwordx4 a[16:19], v5, s[40:43], s28 offen offset:0 sc1
    s_add_u32 s31, s31, s32
    s_add_u32 s31, s31, 16384
    s_waitcnt vmcnt(16) lgkmcnt(3)
    v_mfma_f32_16x16x32_bf16 v[96:99], a[24:27], v[144:147], v[96:99]
    ds_read_b128 v[160:163], v9 offset:32768
    v_lshl_add_u32 v17, v6, 4, s31
    s_mov_b32 s31, 2359296
    s_waitcnt lgkmcnt(3)
    v_mfma_f32_16x16x32_bf16 v[100:103], a[24:27], v[148:151], v[100:103]
    ds_read_b128 v[164:167], v9 offset:33792
    v_mad_u32_u24 v17, v7, s31, v17
    s_lshl_b32 s30, s27, 8
    s_waitcnt lgkmcnt(3)
    v_mfma_f32_16x16x32_bf16 v[104:107], a[24:27], v[152:155], v[104:107]
    ds_read_b128 v[168:171], v9 offset:34816
    s_add_u32 s30, s30, s29
    s_add_u32 s30, s30, s33
    s_waitcnt lgkmcnt(3)
    v_mfma_f32_16x16x32_bf16 v[108:111], a[24:27], v[156:159], v[108:111]
    ds_read_b128 v[172:175], v9 offset:35840
    buffer_load_dwordx4 a[20:23], v5, s[40:43], s28 offen offset:1024 sc1
    s_add_u32 s30, s30, 16384
    v_lshl_add_u32 v19, v6, 4, s30
    s_setprio 2
    s_waitcnt vmcnt(16) lgkmcnt(3)
    v_mfma_f32_16x16x32_bf16 v[96:99], a[28:31], v[160:163], v[96:99]
    ds_read_b128 v[144:147], v9 offset:4096
    v_lshl_add_u32 v19, v14, 9, v19
    ds_read_b128 v[112:115], v18
    s_waitcnt lgkmcnt(4)
    v_mfma_f32_16x16x32_bf16 v[100:103], a[28:31], v[164:167], v[100:103]
    ds_read_b128 v[148:151], v9 offset:5120
    ds_read_b64 v[116:117], v19
    v_cndmask_b32 v19, v10, v19, s[0:1]
    s_waitcnt lgkmcnt(5)
    v_mfma_f32_16x16x32_bf16 v[104:107], a[28:31], v[168:171], v[104:107]
    ds_read_b128 v[152:155], v9 offset:6144
    s_mul_i32 s30, s26, 18432
    s_add_u32 s8, s12, 0x14f0000
    s_addc_u32 s9, s13, 0
    s_waitcnt lgkmcnt(5)
    v_mfma_f32_16x16x32_bf16 v[108:111], a[28:31], v[172:175], v[108:111]
    ds_read_b128 v[156:159], v9 offset:7168
    buffer_load_dwordx4 a[24:27], v5, s[40:43], s28 offen offset:2048 sc1
    s_add_u32 s8, s8, s30
    s_addc_u32 s9, s9, 0
    s_waitcnt vmcnt(16) lgkmcnt(5)
    v_mfma_f32_16x16x32_bf16 v[32:35], a[32:35], v[144:147], v[32:35]
    ds_read_b128 v[160:163], v9 offset:8192
    s_waitcnt lgkmcnt(4)
    v_mfma_f32_16x16x32_bf16 v[36:39], a[32:35], v[148:151], v[36:39]
    v_cvt_pk_bf16_f32 v96, v96, v97
    v_cvt_pk_bf16_f32 v97, v98, v99
    s_waitcnt lgkmcnt(2)
    v_mfma_f32_16x16x32_bf16 v[40:43], a[32:35], v[152:155], v[40:43]
    ds_read_b128 v[164:167], v9 offset:9216
    v_cvt_pk_bf16_f32 v98, v100, v101
    s_waitcnt lgkmcnt(2)
    v_mfma_f32_16x16x32_bf16 v[44:47], a[32:35], v[156:159], v[44:47]
    buffer_load_dwordx4 a[28:31], v5, s[40:43], s28 offen offset:3072 sc1
    v_cvt_pk_bf16_f32 v99, v102, v103
    s_waitcnt vmcnt(16)
    v_mfma_f32_16x16x32_bf16 v[48:51], a[36:39], v[144:147], v[48:51]
    ds_read_b128 v[168:171], v9 offset:10240
    v_permlane32_swap_b32 v96, v98
    v_permlane32_swap_b32 v97, v99
    v_mfma_f32_16x16x32_bf16 v[52:55], a[36:39], v[148:151], v[52:55]
    buffer_store_dwordx4 v[96:99], v4, s[4:7], s48 offen sc1
    v_mfma_f32_16x16x32_bf16 v[56:59], a[36:39], v[152:155], v[56:59]
    ds_read_b128 v[172:175], v9 offset:11264
    v_cvt_pk_bf16_f32 v104, v104, v105
    v_mfma_f32_16x16x32_bf16 v[60:63], a[36:39], v[156:159], v[60:63]
    s_mov_b32 s28, 151552
    buffer_load_dwordx4 a[32:35], v5, s[40:43], s28 offen offset:0 sc1
    v_cvt_pk_bf16_f32 v105, v106, v107
    s_waitcnt vmcnt(17) lgkmcnt(3)
    v_mfma_f32_16x16x32_bf16 v[32:35], a[40:43], v[160:163], v[32:35]
    ds_read_b128 v[144:147], v9 offset:12288
    v_cvt_pk_bf16_f32 v106, v108, v109
    v_cvt_pk_bf16_f32 v107, v110, v111
    s_waitcnt lgkmcnt(3)
    v_mfma_f32_16x16x32_bf16 v[36:39], a[40:43], v[164:167], v[36:39]
    v_permlane32_swap_b32 v104, v106
    s_waitcnt lgkmcnt(2)
    v_mfma_f32_16x16x32_bf16 v[40:43], a[40:43], v[168:171], v[40:43]
    ds_read_b128 v[148:151], v9 offset:13312
    v_permlane32_swap_b32 v105, v107
    buffer_store_dwordx4 v[104:107], v4, s[4:7], s49 offen sc1
    s_waitcnt lgkmcnt(2)
    v_mfma_f32_16x16x32_bf16 v[44:47], a[40:43], v[172:175], v[44:47]
    buffer_load_dwordx4 a[36:39], v5, s[40:43], s28 offen offset:1024 sc1
    s_mov_b32 s10, 0x1200000
    s_waitcnt vmcnt(18)
    v_mfma_f32_16x16x32_bf16 v[48:51], a[44:47], v[160:163], v[48:51]
    ds_read_b128 v[152:155], v9 offset:14336
    s_mov_b32 s11, 0x20000
    s_sub_u32 s10, s10, s30
    v_mfma_f32_16x16x32_bf16 v[52:55], a[44:47], v[164:167], v[52:55]
    s_lshl_b32 s31, s3, 8
    v_mfma_f32_16x16x32_bf16 v[56:59], a[44:47], v[168:171], v[56:59]
    ds_read_b128 v[156:159], v9 offset:15360
    s_add_u32 s31, s31, s23
    s_add_u32 s32, s31, s20
    v_mfma_f32_16x16x32_bf16 v[60:63], a[44:47], v[172:175], v[60:63]
    buffer_load_dwordx4 a[40:43], v5, s[40:43], s28 offen offset:2048 sc1
    s_lshl_b32 s32, s32, 7
    s_waitcnt vmcnt(18) lgkmcnt(3)
    v_mfma_f32_16x16x32_bf16 v[32:35], a[48:51], v[144:147], v[32:35]
    ds_read_b128 v[160:163], v9 offset:16384
    s_add_u32 s56, s12, 0x2718000
    s_addc_u32 s57, s13, 0
    s_waitcnt lgkmcnt(3)
    v_mfma_f32_16x16x32_bf16 v[36:39], a[48:51], v[148:151], v[36:39]
    s_add_u32 s56, s56, s32
    s_addc_u32 s57, s57, 0
    s_waitcnt lgkmcnt(2)
    v_mfma_f32_16x16x32_bf16 v[40:43], a[48:51], v[152:155], v[40:43]
    ds_read_b128 v[164:167], v9 offset:17408
    s_mov_b32 s58, 0x4040
    s_waitcnt lgkmcnt(2)
    v_mfma_f32_16x16x32_bf16 v[44:47], a[48:51], v[156:159], v[44:47]
    buffer_load_dwordx4 a[44:47], v5, s[40:43], s28 offen offset:3072 sc1
    s_mov_b32 s59, 0x20000
    s_waitcnt vmcnt(18)
    v_mfma_f32_16x16x32_bf16 v[48:51], a[52:55], v[144:147], v[48:51]
    ds_read_b128 v[168:171], v9 offset:18432
    s_lshr_b32 s32, s19, 1
    s_add_u32 s31, s31, s32
    v_mfma_f32_16x16x32_bf16 v[52:55], a[52:55], v[148:151], v[52:55]
    s_lshl_b32 s31, s31, 7
    v_mfma_f32_16x16x32_bf16 v[56:59], a[52:55], v[152:155], v[56:59]
    ds_read_b128 v[172:175], v9 offset:19456
    s_add_u32 s31, s31, 0x2718000
    s_add_u32 s14, s12, s31
    s_addc_u32 s15, s13, 0
    v_mfma_f32_16x16x32_bf16 v[60:63], a[52:55], v[156:159], v[60:63]
    s_mov_b32 s28, 155648
    buffer_load_dwordx4 a[48:51], v5, s[40:43], s28 offen offset:0 sc1
    s_waitcnt vmcnt(18) lgkmcnt(3)
    v_mfma_f32_16x16x32_bf16 v[32:35], a[56:59], v[160:163], v[32:35]
    ds_read_b128 v[144:147], v9 offset:20480
    s_lshl_b32 s32, s21, 2
    s_add_u32 s32, s32, 32
    s_waitcnt lgkmcnt(3)
    v_mfma_f32_16x16x32_bf16 v[36:39], a[56:59], v[164:167], v[36:39]
    v_mov_b32 v23, s32
    s_waitcnt lgkmcnt(2)
    v_mfma_f32_16x16x32_bf16 v[40:43], a[56:59], v[168:171], v[40:43]
    ds_read_b128 v[148:151], v9 offset:21504
    v_cmp_eq_u32 vcc, 0, v1
    s_nop 1
    v_cndmask_b32 v23, v10, v23, vcc
    s_waitcnt lgkmcnt(2)
    v_mfma_f32_16x16x32_bf16 v[44:47], a[56:59], v[172:175], v[44:47]
    buffer_load_dwordx4 a[52:55], v5, s[40:43], s28 offen offset:1024 sc1
    v_mov_b32 v24, 1
    s_waitcnt vmcnt(18)
    v_mfma_f32_16x16x32_bf16 v[48:51], a[60:63], v[160:163], v[48:51]
    ds_read_b128 v[152:155], v9 offset:22528
    s_and_b32 s35, s19, 1
    v_mfma_f32_16x16x32_bf16 v[52:55], a[60:63], v[164:167], v[52:55]
    s_xor_b32 s35, s35, 1
    s_lshl_b32 s35, s35, 5
    v_mfma_f32_16x16x32_bf16 v[56:59], a[60:63], v[168:171], v[56:59]
    ds_read_b128 v[156:159], v9 offset:23552
    v_lshlrev_b32 v25, 2, v6
    v_mfma_f32_16x16x32_bf16 v[60:63], a[60:63], v[172:175], v[60:63]
    buffer_load_dwordx4 a[56:59], v5, s[40:43], s28 offen offset:2048 sc1
    v_add_u32 v26, s35, v25
    v_add_u32 v25, 32, v25
    s_waitcnt vmcnt(18) lgkmcnt(3)
    v_mfma_f32_16x16x32_bf16 v[32:35], a[64:67], v[144:147], v[32:35]
    ds_read_b128 v[160:163], v9 offset:24576
    v_cmp_gt_u32 vcc, 8, v1
    s_nop 1
    v_cndmask_b32 v25, v25, v26, vcc
    s_waitcnt lgkmcnt(3)
    v_mfma_f32_16x16x32_bf16 v[36:39], a[64:67], v[148:151], v[36:39]
    v_cmp_gt_u32 vcc, 16, v1
    s_nop 1
    v_cndmask_b32 v25, v10, v25, vcc
    s_waitcnt lgkmcnt(2)
    v_mfma_f32_16x16x32_bf16 v[40:43], a[64:67], v[152:155], v[40:43]
    ds_read_b128 v[164:167], v9 offset:25600
    s_waitcnt lgkmcnt(2)
    v_mfma_f32_16x16x32_bf16 v[44:47], a[64:67], v[156:159], v[44:47]
    buffer_load_dwordx4 a[60:63], v5, s[40:43], s28 offen offset:3072 sc1
    v_add_u32 v26, 16384, v26
    s_waitcnt vmcnt(18)
    v_mfma_f32_16x16x32_bf16 v[48:51], a[68:71], v[144:147], v[48:51]
    ds_read_b128 v[168:171], v9 offset:26624
    v_cmp_gt_u32 vcc, 8, v1
    s_nop 1
    v_cndmask_b32 v26, v10, v26, vcc
    v_mfma_f32_16x16x32_bf16 v[52:55], a[68:71], v[148:151], v[52:55]
    s_add_u32 s34, s35, 16384
    v_mfma_f32_16x16x32_bf16 v[56:59], a[68:71], v[152:155], v[56:59]
    ds_read_b128 v[172:175], v9 offset:27648
    s_mul_i32 s31, s25, 9216
    v_mul_u32_u24 v22, 1152, v6
    v_mfma_f32_16x16x32_bf16 v[60:63], a[68:71], v[156:159], v[60:63]
    s_mov_b32 s28, 159744
    buffer_load_dwordx4 a[64:67], v5, s[40:43], s28 offen offset:0 sc1
    v_add_u32 v22, s31, v22
    s_setprio 1
    s_waitcnt vmcnt(18) lgkmcnt(3)
    v_mfma_f32_16x16x32_bf16 v[32:35], a[0:3], v[160:163], v[32:35]
    ds_read_b128 v[144:147], v9 offset:28672
    v_add_u32 v20, v20, v22
    v_add_u32 v21, v21, v22
    s_waitcnt lgkmcnt(3)
    v_mfma_f32_16x16x32_bf16 v[36:39], a[0:3], v[164:167], v[36:39]
    s_cmp_eq_u32 s3, 0
    s_cselect_b64 vcc, -1, 0
    v_cndmask_b32 v20, v20, v18, vcc
    v_cndmask_b32 v21, v21, v19, vcc
    s_waitcnt lgkmcnt(2)
    v_mfma_f32_16x16x32_bf16 v[40:43], a[0:3], v[168:171], v[40:43]
    ds_read_b128 v[148:151], v9 offset:29696
    s_waitcnt lgkmcnt(2)
    v_mfma_f32_16x16x32_bf16 v[44:47], a[0:3], v[172:175], v[44:47]
    buffer_load_dwordx4 a[68:71], v5, s[40:43], s28 offen offset:1024 sc1
    s_waitcnt vmcnt(18)
    v_mfma_f32_16x16x32_bf16 v[48:51], a[4:7], v[160:163], v[48:51]
    ds_read_b128 v[152:155], v9 offset:30720
    s_lshr_b32 s31, s19, 1
    v_mfma_f32_16x16x32_bf16 v[52:55], a[4:7], v[164:167], v[52:55]
    s_lshl_b32 s31, s31, 8
    s_and_b32 s32, s19, 1
    v_mfma_f32_16x16x32_bf16 v[56:59], a[4:7], v[168:171], v[56:59]
    ds_read_b128 v[156:159], v9 offset:31744
    s_lshl_b32 s32, s32, 3
    v_mfma_f32_16x16x32_bf16 v[60:63], a[4:7], v[172:175], v[60:63]
    buffer_load_dwordx4 a[0:3], v5, s[40:43], s28 offen offset:2048 sc1
    s_add_u32 s31, s31, s32
    s_add_u32 s31, s31, s33
    s_waitcnt vmcnt(18) lgkmcnt(3)
    v_mfma_f32_16x16x32_bf16 v[32:35], a[8:11], v[144:147], v[32:35]
    ds_read_b128 v[160:163], v9 offset:32768
    v_lshl_add_u32 v22, v6, 4, s31
    s_waitcnt lgkmcnt(3)
    v_mfma_f32_16x16x32_bf16 v[36:39], a[8:11], v[148:151], v[36:39]
    v_cmp_gt_u32 vcc, 8, v1
    s_nop 1
    v_cndmask_b32 v22, v10, v22, vcc
    s_waitcnt lgkmcnt(2)
    v_mfma_f32_16x16x32_bf16 v[40:43], a[8:11], v[152:155], v[40:43]
    ds_read_b128 v[164:167], v9 offset:33792
    s_mov_b32 s16, 0xffff0000
    s_waitcnt lgkmcnt(2)
    v_mfma_f32_16x16x32_bf16 v[44:47], a[8:11], v[156:159], v[44:47]
    buffer_load_dwordx4 a[4:7], v5, s[40:43], s28 offen offset:3072 sc1
    s_mov_b32 s17, 0x3f80
    s_waitcnt vmcnt(18)
    v_mfma_f32_16x16x32_bf16 v[48:51], a[12:15], v[144:147], v[48:51]
    ds_read_b128 v[168:171], v9 offset:34816
    s_mov_b32 s18, 0x3f800000
    v_lshlrev_b32 v128, 16, v112
    v_mfma_f32_16x16x32_bf16 v[52:55], a[12:15], v[148:151], v[52:55]
    v_and_b32 v129, s16, v112
    v_mfma_f32_16x16x32_bf16 v[56:59], a[12:15], v[152:155], v[56:59]
    ds_read_b128 v[172:175], v9 offset:35840
    v_lshlrev_b32 v130, 16, v113
    v_and_b32 v131, s16, v113
    v_mfma_f32_16x16x32_bf16 v[60:63], a[12:15], v[156:159], v[60:63]
    s_mov_b32 s28, 163840
    buffer_load_dwordx4 a[8:11], v5, s[40:43], s28 offen offset:0 sc1
    v_lshlrev_b32 v132, 16, v114
    s_waitcnt vmcnt(18) lgkmcnt(3)
    v_mfma_f32_16x16x32_bf16 v[32:35], a[16:19], v[160:163], v[32:35]
    ds_read_b128 v[144:147], v9 offset:4096
    v_and_b32 v133, s16, v114
    v_lshlrev_b32 v134, 16, v115
    s_waitcnt lgkmcnt(3)
    v_mfma_f32_16x16x32_bf16 v[36:39], a[16:19], v[164:167], v[36:39]
    v_and_b32 v135, s16, v115
    s_waitcnt lgkmcnt(2)
    v_mfma_f32_16x16x32_bf16 v[40:43], a[16:19], v[168:171], v[40:43]
    ds_read_b128 v[148:151], v9 offset:5120
    v_lshlrev_b32 v28, 16, v116
    v_and_b32 v29, s16, v116
    s_waitcnt lgkmcnt(2)
    v_mfma_f32_16x16x32_bf16 v[44:47], a[16:19], v[172:175], v[44:47]
    buffer_load_dwordx4 a[12:15], v5, s[40:43], s28 offen offset:1024 sc1
    v_lshlrev_b32 v30, 16, v117
    s_waitcnt vmcnt(18)
    v_mfma_f32_16x16x32_bf16 v[48:51], a[20:23], v[160:163], v[48:51]
    ds_read_b128 v[152:155], v9 offset:6144
    v_and_b32 v31, s16, v117
    v_dot2c_f32_bf16 v128, s17, v120
    v_mfma_f32_16x16x32_bf16 v[52:55], a[20:23], v[164:167], v[52:55]
    v_dot2c_f32_bf16 v129, s18, v120
    v_mfma_f32_16x16x32_bf16 v[56:59], a[20:23], v[168:171], v[56:59]
    ds_read_b128 v[156:159], v9 offset:7168
    v_dot2c_f32_bf16 v130, s17, v121
    v_dot2c_f32_bf16 v131, s18, v121
    v_mfma_f32_16x16x32_bf16 v[60:63], a[20:23], v[172:175], v[60:63]
    v_dot2c_f32_bf16 v132, s17, v122
    s_waitcnt vmcnt(17) lgkmcnt(3)
    v_mfma_f32_16x16x32_bf16 v[64:67], a[24:27], v[144:147], v[64:67]
    ds_read_b128 v[160:163], v9 offset:8192
    v_cvt_pk_bf16_f32 v32, v32, v33
    s_waitcnt lgkmcnt(3)
    v_mfma_f32_16x16x32_bf16 v[68:71], a[24:27], v[148:151], v[68:71]
    v_cvt_pk_bf16_f32 v33, v34, v35
    v_cvt_pk_bf16_f32 v34, v48, v49
    s_waitcnt lgkmcnt(2)
    v_mfma_f32_16x16x32_bf16 v[72:75], a[24:27], v[152:155], v[72:75]
    ds_read_b128 v[164:167], v9 offset:9216
    v_cvt_pk_bf16_f32 v35, v50, v51
    s_waitcnt lgkmcnt(2)
    v_mfma_f32_16x16x32_bf16 v[76:79], a[24:27], v[156:159], v[76:79]
    buffer_store_dwordx4 v[32:35], v176, s[4:7], s44 offen offset:0 sc1
    s_waitcnt vmcnt(17)
    v_mfma_f32_16x16x32_bf16 v[80:83], a[28:31], v[144:147], v[80:83]
    ds_read_b128 v[168:171], v9 offset:10240
    ds_write_b128 v15, v[32:35] offset:19456
    v_mfma_f32_16x16x32_bf16 v[84:87], a[28:31], v[148:151], v[84:87]
    v_mfma_f32_16x16x32_bf16 v[88:91], a[28:31], v[152:155], v[88:91]
    ds_read_b128 v[172:175], v9 offset:11264
    v_cvt_pk_bf16_f32 v36, v36, v37
    v_mfma_f32_16x16x32_bf16 v[92:95], a[28:31], v[156:159], v[92:95]
    v_cvt_pk_bf16_f32 v37, v38, v39
    v_cvt_pk_bf16_f32 v38, v52, v53
    s_waitcnt vmcnt(15) lgkmcnt(4)
    v_mfma_f32_16x16x32_bf16 v[64:67], a[32:35], v[160:163], v[64:67]
    ds_read_b128 v[144:147], v9 offset:12288
    v_cvt_pk_bf16_f32 v39, v54, v55
    s_waitcnt lgkmcnt(4)
    v_mfma_f32_16x16x32_bf16 v[68:71], a[32:35], v[164:167], v[68:71]
    buffer_store_dwordx4 v[36:39], v15, s[4:7], s45 offen offset:0 sc1
    s_waitcnt lgkmcnt(3)
    v_mfma_f32_16x16x32_bf16 v[72:75], a[32:35], v[168:171], v[72:75]
    ds_read_b128 v[148:151], v9 offset:13312
    v_cvt_pk_bf16_f32 v40, v40, v41
    s_waitcnt lgkmcnt(2)
    v_mfma_f32_16x16x32_bf16 v[76:79], a[32:35], v[172:175], v[76:79]
    v_cvt_pk_bf16_f32 v41, v42, v43
    v_cvt_pk_bf16_f32 v42, v56, v57
    s_waitcnt vmcnt(14)
    v_mfma_f32_16x16x32_bf16 v[80:83], a[36:39], v[160:163], v[80:83]
    ds_read_b128 v[152:155], v9 offset:14336
    v_cvt_pk_bf16_f32 v43, v58, v59
    v_mfma_f32_16x16x32_bf16 v[84:87], a[36:39], v[164:167], v[84:87]
    buffer_store_dwordx4 v[40:43], v15, s[4:7], s46 offen offset:0 sc1
    v_mfma_f32_16x16x32_bf16 v[88:91], a[36:39], v[168:171], v[88:91]
    ds_read_b128 v[156:159], v9 offset:15360
    v_cvt_pk_bf16_f32 v44, v44, v45
    v_mfma_f32_16x16x32_bf16 v[92:95], a[36:39], v[172:175], v[92:95]
    v_cvt_pk_bf16_f32 v45, v46, v47
    v_cvt_pk_bf16_f32 v46, v60, v61
    s_waitcnt vmcnt(14) lgkmcnt(3)
    v_mfma_f32_16x16x32_bf16 v[64:67], a[40:43], v[144:147], v[64:67]
    ds_read_b128 v[160:163], v9 offset:16384
    v_cvt_pk_bf16_f32 v47, v62, v63
    s_waitcnt lgkmcnt(3)
    v_mfma_f32_16x16x32_bf16 v[68:71], a[40:43], v[148:151], v[68:71]
    buffer_store_dwordx4 v[44:47], v15, s[4:7], s47 offen offset:0 sc1
    s_waitcnt lgkmcnt(2)
    v_mfma_f32_16x16x32_bf16 v[72:75], a[40:43], v[152:155], v[72:75]
    ds_read_b128 v[164:167], v9 offset:17408
    v_dot2c_f32_bf16 v133, s18, v122
    v_dot2c_f32_bf16 v134, s17, v123
    s_waitcnt lgkmcnt(2)
    v_mfma_f32_16x16x32_bf16 v[76:79], a[40:43], v[156:159], v[76:79]
    v_dot2c_f32_bf16 v135, s18, v123
    s_waitcnt vmcnt(14)
    v_mfma_f32_16x16x32_bf16 v[80:83], a[44:47], v[144:147], v[80:83]
    ds_read_b128 v[168:171], v9 offset:18432
    v_dot2c_f32_bf16 v28, s17, v124
    v_dot2c_f32_bf16 v29, s18, v124
    v_mfma_f32_16x16x32_bf16 v[84:87], a[44:47], v[148:151], v[84:87]
    v_dot2c_f32_bf16 v30, s17, v125
    v_mfma_f32_16x16x32_bf16 v[88:91], a[44:47], v[152:155], v[88:91]
    ds_read_b128 v[172:175], v9 offset:19456
    v_dot2c_f32_bf16 v31, s18, v125
    v_mov_b32 v11, 0
    v_mfma_f32_16x16x32_bf16 v[92:95], a[44:47], v[156:159], v[92:95]
    v_cmp_gt_u32 s[52:53], 32, v1
    s_setprio 0
    s_waitcnt vmcnt(13) lgkmcnt(3)
    v_mfma_f32_16x16x32_bf16 v[64:67], a[48:51], v[160:163], v[64:67]
    ds_read_b128 v[144:147], v9 offset:20480
    v_cndmask_b32 v136, v128, v11, s[52:53]
    s_waitcnt lgkmcnt(3)
    v_mfma_f32_16x16x32_bf16 v[68:71], a[48:51], v[164:167], v[68:71]
    v_cndmask_b32 v137, v129, v11, s[52:53]
    v_cndmask_b32 v138, v130, v11, s[52:53]
    s_waitcnt lgkmcnt(2)
    v_mfma_f32_16x16x32_bf16 v[72:75], a[48:51], v[168:171], v[72:75]
    ds_read_b128 v[148:151], v9 offset:21504
    v_cndmask_b32 v139, v131, v11, s[52:53]
    s_waitcnt lgkmcnt(2)
    v_mfma_f32_16x16x32_bf16 v[76:79], a[48:51], v[172:175], v[76:79]
    v_cndmask_b32 v140, v132, v11, s[52:53]
    s_waitcnt vmcnt(12)
    v_mfma_f32_16x16x32_bf16 v[80:83], a[52:55], v[160:163], v[80:83]
    ds_read_b128 v[152:155], v9 offset:22528
    v_cndmask_b32 v141, v133, v11, s[52:53]
    v_mfma_f32_16x16x32_bf16 v[84:87], a[52:55], v[164:167], v[84:87]
    v_cndmask_b32 v142, v134, v11, s[52:53]
    v_mfma_f32_16x16x32_bf16 v[88:91], a[52:55], v[168:171], v[88:91]
    ds_read_b128 v[156:159], v9 offset:23552
    v_cndmask_b32 v143, v135, v11, s[52:53]
    v_cndmask_b32 v128, v11, v128, s[52:53]
    v_mfma_f32_16x16x32_bf16 v[92:95], a[52:55], v[172:175], v[92:95]
    v_cndmask_b32 v129, v11, v129, s[52:53]
    s_waitcnt vmcnt(11) lgkmcnt(3)
    v_mfma_f32_16x16x32_bf16 v[64:67], a[56:59], v[144:147], v[64:67]
    ds_read_b128 v[160:163], v9 offset:24576
    v_cndmask_b32 v130, v11, v130, s[52:53]
    s_waitcnt lgkmcnt(3)
    v_mfma_f32_16x16x32_bf16 v[68:71], a[56:59], v[148:151], v[68:71]
    v_cndmask_b32 v131, v11, v131, s[52:53]
    s_waitcnt lgkmcnt(2)
    v_mfma_f32_16x16x32_bf16 v[72:75], a[56:59], v[152:155], v[72:75]
    ds_read_b128 v[164:167], v9 offset:25600
    v_cndmask_b32 v132, v11, v132, s[52:53]
    s_waitcnt lgkmcnt(2)
    v_mfma_f32_16x16x32_bf16 v[76:79], a[56:59], v[156:159], v[76:79]
    v_cndmask_b32 v133, v11, v133, s[52:53]
    v_cndmask_b32 v134, v11, v134, s[52:53]
    s_waitcnt vmcnt(10)
    v_mfma_f32_16x16x32_bf16 v[80:83], a[60:63], v[144:147], v[80:83]
    ds_read_b128 v[168:171], v9 offset:26624
    v_cndmask_b32 v135, v11, v135, s[52:53]
    v_mfma_f32_16x16x32_bf16 v[84:87], a[60:63], v[148:151], v[84:87]
    v_mfma_f32_16x16x32_bf16 v[88:91], a[60:63], v[152:155], v[88:91]
    ds_read_b128 v[172:175], v9 offset:27648
    v_mfma_f32_16x16x32_bf16 v[92:95], a[60:63], v[156:159], v[92:95]
    s_waitcnt vmcnt(0)
    buffer_store_dword v24, v23, s[56:59], 0 offen sc1
    s_waitcnt lgkmcnt(3)
    v_mfma_f32_16x16x32_bf16 v[64:67], a[64:67], v[160:163], v[64:67]
    ds_read_b128 v[144:147], v9 offset:28672
    s_waitcnt lgkmcnt(3)
    v_mfma_f32_16x16x32_bf16 v[68:71], a[64:67], v[164:167], v[68:71]
    s_waitcnt lgkmcnt(2)
    v_mfma_f32_16x16x32_bf16 v[72:75], a[64:67], v[168:171], v[72:75]
    ds_read_b128 v[148:151], v9 offset:29696
    s_waitcnt lgkmcnt(2)
    v_mfma_f32_16x16x32_bf16 v[76:79], a[64:67], v[172:175], v[76:79]
    v_mfma_f32_16x16x32_bf16 v[80:83], a[68:71], v[160:163], v[80:83]
    ds_read_b128 v[152:155], v9 offset:30720
    v_mfma_f32_16x16x32_bf16 v[84:87], a[68:71], v[164:167], v[84:87]
    v_mfma_f32_16x16x32_bf16 v[88:91], a[68:71], v[168:171], v[88:91]
    ds_read_b128 v[156:159], v9 offset:31744
    v_mfma_f32_16x16x32_bf16 v[92:95], a[68:71], v[172:175], v[92:95]
    s_waitcnt lgkmcnt(3)
    v_mfma_f32_16x16x32_bf16 v[64:67], a[0:3], v[144:147], v[64:67]
    ds_read_b128 v[160:163], v9 offset:32768
    s_waitcnt lgkmcnt(3)
    v_mfma_f32_16x16x32_bf16 v[68:71], a[0:3], v[148:151], v[68:71]
    s_waitcnt lgkmcnt(2)
    v_mfma_f32_16x16x32_bf16 v[72:75], a[0:3], v[152:155], v[72:75]
    ds_read_b128 v[164:167], v9 offset:33792
    s_waitcnt lgkmcnt(2)
    v_mfma_f32_16x16x32_bf16 v[76:79], a[0:3], v[156:159], v[76:79]
    v_mfma_f32_16x16x32_bf16 v[80:83], a[4:7], v[144:147], v[80:83]
    ds_read_b128 v[168:171], v9 offset:34816
    v_mfma_f32_16x16x32_bf16 v[84:87], a[4:7], v[148:151], v[84:87]
    v_mfma_f32_16x16x32_bf16 v[88:91], a[4:7], v[152:155], v[88:91]
    ds_read_b128 v[172:175], v9 offset:35840
    v_mfma_f32_16x16x32_bf16 v[92:95], a[4:7], v[156:159], v[92:95]
    s_waitcnt lgkmcnt(3)
    v_mfma_f32_16x16x32_bf16 v[64:67], a[8:11], v[160:163], v[64:67]
    s_waitcnt lgkmcnt(2)
    v_mfma_f32_16x16x32_bf16 v[68:71], a[8:11], v[164:167], v[68:71]
    s_waitcnt lgkmcnt(1)
    v_mfma_f32_16x16x32_bf16 v[72:75], a[8:11], v[168:171], v[72:75]
    s_waitcnt lgkmcnt(0)
    v_mfma_f32_16x16x32_bf16 v[76:79], a[8:11], v[172:175], v[76:79]
    v_mfma_f32_16x16x32_bf16 v[80:83], a[12:15], v[160:163], v[80:83]
    v_mfma_f32_16x16x32_bf16 v[84:87], a[12:15], v[164:167], v[84:87]
    v_mfma_f32_16x16x32_bf16 v[88:91], a[12:15], v[168:171], v[88:91]
    v_mfma_f32_16x16x32_bf16 v[92:95], a[12:15], v[172:175], v[92:95]
    v_cvt_pk_bf16_f32 v64, v64, v65
    v_cvt_pk_bf16_f32 v65, v66, v67
    s_nop 2
    v_cvt_pk_bf16_f32 v66, v80, v81
    v_cvt_pk_bf16_f32 v67, v82, v83
    buffer_store_dwordx4 v[64:67], v176, s[4:7], s44 offen offset:1024 sc1
    ds_write_b128 v15, v[64:67] offset:20480
    v_cvt_pk_bf16_f32 v68, v68, v69
    v_cvt_pk_bf16_f32 v69, v70, v71
    v_cvt_pk_bf16_f32 v70, v84, v85
    v_cvt_pk_bf16_f32 v71, v86, v87
    buffer_store_dwordx4 v[68:71], v15, s[4:7], s45 offen offset:1024 sc1
    v_cvt_pk_bf16_f32 v72, v72, v73
    v_cvt_pk_bf16_f32 v73, v74, v75
    v_cvt_pk_bf16_f32 v74, v88, v89
    v_cvt_pk_bf16_f32 v75, v90, v91
    buffer_store_dwordx4 v[72:75], v15, s[4:7], s46 offen offset:1024 sc1
    v_cvt_pk_bf16_f32 v76, v76, v77
    v_cvt_pk_bf16_f32 v77, v78, v79
    v_cvt_pk_bf16_f32 v78, v92, v93
    v_cvt_pk_bf16_f32 v79, v94, v95
    buffer_store_dwordx4 v[76:79], v15, s[4:7], s47 offen offset:1024 sc1
.L_mlp_red:
    s_and_b32 s47, s21, 3
    s_xor_b32 s46, s47, 3
    s_xor_b32 s45, s47, 2
    s_xor_b32 s44, s47, 1
    s_mul_i32 s44, s44, 2359296
    s_mul_i32 s45, s45, 2359296
    s_mul_i32 s46, s46, 2359296
    s_mul_i32 s47, s47, 2359296
    s_mov_b32 s54, s30
    s_mov_b32 s53, s35
    s_mov_b32 s52, s34
    s_cmp_lt_u32 s19, 8
    s_cbranch_scc0 .L_mlp_od
    s_mov_b32 s24, 16384
    s_waitcnt vmcnt(0)
    buffer_store_dword v24, v23, s[56:59], s24 offen sc1
    v_mov_b32 v23, v10
.L_mlp_od:
    s_mov_b32 s55, 0x1000
.L_mlp_sa:
    s_load_dwordx8 s[24:31], s[14:15], s53 glc
    s_load_dwordx8 s[32:39], s[14:15], 32 glc
    s_sub_u32 s55, s55, 1
    s_cbranch_scc1 .L_mlp_sas
    s_waitcnt lgkmcnt(0)
    s_and_b64 s[24:25], s[24:25], s[32:33]
    s_and_b64 s[26:27], s[26:27], s[34:35]
    s_and_b64 s[28:29], s[28:29], s[36:37]
    s_and_b64 s[30:31], s[30:31], s[38:39]
    s_and_b64 s[24:25], s[24:25], s[28:29]
    s_and_b64 s[26:27], s[26:27], s[30:31]
    s_and_b64 s[24:25], s[24:25], s[26:27]
    s_and_b32 s24, s24, s25
    s_cbranch_scc1 .L_mlp_sak
    s_sleep 4
    s_branch .L_mlp_sa
.L_mlp_sas:
    s_waitcnt lgkmcnt(0)
    s_mov_b32 s60, s14
    s_mov_b32 s61, s15
    s_mov_b32 s62, 16448
    s_mov_b32 s63, 0x20000
    s_mov_b32 s55, 0x40000
.L_mlp_pa:
    buffer_load_dword v27, v25, s[60:63], 0 offen sc1
    s_waitcnt vmcnt(0)
    v_cmp_ne_u32 vcc, 0, v27
    s_sub_u32 s55, s55, 1
    s_cbranch_scc1 .L_mlp_pax
    s_cmp_lg_u32 vcc_lo, 0xffff
    s_cbranch_scc1 .L_mlp_pa
.L_mlp_pax:
.L_mlp_sak:
    buffer_load_dwordx4 v[32:35], v177, s[8:11], s47 offen sc1
    buffer_load_dwordx4 v[36:39], v16, s[8:11], s44 offen sc1
    buffer_load_dwordx4 v[40:43], v16, s[8:11], s45 offen sc1
    buffer_load_dwordx4 v[44:47], v16, s[8:11], s46 offen sc1
    buffer_load_dwordx4 v[48:51], v17, s[8:11], 0 offen sc1
    s_waitcnt lgkmcnt(0)
    s_barrier
    ds_read_b128 v[180:183], v18 offset:19456
    s_add_u32 s40, s12, 0xd20000
    s_addc_u32 s41, s13, 0
    s_cmp_eq_u32 s3, 0
    s_cselect_b32 s40, s40, s50
    s_cselect_b32 s41, s41, s51
    s_add_u32 s40, s40, s54
    s_addc_u32 s41, s41, 0
    s_mov_b32 s42, 0x4800
    s_mov_b32 s43, 0x20000
    s_mov_b32 s55, 0x1000
.L_mlp_sb:
    s_load_dwordx8 s[24:31], s[14:15], s52 glc
    s_sub_u32 s55, s55, 1
    s_cbranch_scc1 .L_mlp_sbs
    s_waitcnt lgkmcnt(0)
    s_and_b64 s[24:25], s[24:25], s[28:29]
    s_and_b64 s[26:27], s[26:27], s[30:31]
    s_and_b64 s[24:25], s[24:25], s[26:27]
    s_and_b32 s24, s24, s25
    s_cbranch_scc1 .L_mlp_sbk
    s_sleep 2
    s_branch .L_mlp_sb
.L_mlp_sbs:
    s_waitcnt lgkmcnt(0)
    s_mov_b32 s60, s14
    s_mov_b32 s61, s15
    s_mov_b32 s62, 16448
    s_mov_b32 s63, 0x20000
    s_mov_b32 s55, 0x40000
.L_mlp_pb:
    buffer_load_dword v27, v26, s[60:63], 0 offen sc1
    s_waitcnt vmcnt(0)
    v_cmp_ne_u32 vcc, 0, v27
    s_sub_u32 s55, s55, 1
    s_cbranch_scc1 .L_mlp_pbx
    s_cmp_lg_u32 vcc_lo, 0xff
    s_cbranch_scc1 .L_mlp_pb
.L_mlp_pbx:
.L_mlp_sbk:
    buffer_load_dwordx4 v[96:99], v177, s[8:11], s47 offen offset:1024 sc1
    buffer_load_dwordx4 v[100:103], v16, s[8:11], s44 offen offset:1024 sc1
    buffer_load_dwordx4 v[104:107], v16, s[8:11], s45 offen offset:1024 sc1
    buffer_load_dwordx4 v[108:111], v16, s[8:11], s46 offen offset:1024 sc1
    s_waitcnt vmcnt(8)
    v_dot2c_f32_bf16 v128, s17, v32
    v_dot2c_f32_bf16 v129, s18, v32
    v_dot2c_f32_bf16 v130, s17, v33
    v_dot2c_f32_bf16 v131, s18, v33
    v_dot2c_f32_bf16 v132, s17, v34
    v_dot2c_f32_bf16 v133, s18, v34
    v_dot2c_f32_bf16 v134, s17, v35
    v_dot2c_f32_bf16 v135, s18, v35
    s_waitcnt vmcnt(7)
    v_dot2c_f32_bf16 v128, s17, v36
    v_dot2c_f32_bf16 v129, s18, v36
    v_dot2c_f32_bf16 v130, s17, v37
    v_dot2c_f32_bf16 v131, s18, v37
    v_dot2c_f32_bf16 v132, s17, v38
    v_dot2c_f32_bf16 v133, s18, v38
    v_dot2c_f32_bf16 v134, s17, v39
    v_dot2c_f32_bf16 v135, s18, v39
    s_waitcnt vmcnt(6)
    v_dot2c_f32_bf16 v128, s17, v40
    v_dot2c_f32_bf16 v129, s18, v40
    v_dot2c_f32_bf16 v130, s17, v41
    v_dot2c_f32_bf16 v131, s18, v41
    v_dot2c_f32_bf16 v132, s17, v42
    v_dot2c_f32_bf16 v133, s18, v42
    v_dot2c_f32_bf16 v134, s17, v43
    v_dot2c_f32_bf16 v135, s18, v43
    s_waitcnt vmcnt(5)
    v_dot2c_f32_bf16 v128, s17, v44
    v_dot2c_f32_bf16 v129, s18, v44
    v_dot2c_f32_bf16 v130, s17, v45
    v_dot2c_f32_bf16 v131, s18, v45
    v_dot2c_f32_bf16 v132, s17, v46
    v_dot2c_f32_bf16 v133, s18, v46
    v_dot2c_f32_bf16 v134, s17, v47
    v_dot2c_f32_bf16 v135, s18, v47
    s_waitcnt vmcnt(4)
    v_lshlrev_b32 v56, 16, v48
    v_and_b32 v57, s16, v48
    v_lshlrev_b32 v58, 16, v49
    v_and_b32 v59, s16, v49
    v_lshlrev_b32 v60, 16, v50
    v_and_b32 v61, s16, v50
    v_lshlrev_b32 v62, 16, v51
    v_and_b32 v63, s16, v51
    v_permlane32_swap_b32 v56, v60
    v_permlane32_swap_b32 v57, v61
    v_permlane32_swap_b32 v58, v62
    v_permlane32_swap_b32 v59, v63
    v_add_f32 v56, v56, v60
    v_add_f32 v57, v57, v61
    v_add_f32 v58, v58, v62
    v_add_f32 v59, v59, v63
    v_add_f32_dpp v56, v56, v56 row_ror:8 row_mask:0xf bank_mask:0xf
    v_add_f32_dpp v57, v57, v57 row_ror:8 row_mask:0xf bank_mask:0xf
    v_add_f32_dpp v58, v58, v58 row_ror:8 row_mask:0xf bank_mask:0xf
    v_add_f32_dpp v59, v59, v59 row_ror:8 row_mask:0xf bank_mask:0xf
    v_mov_b32 v60, v56
    v_mov_b32 v61, v57
    v_mov_b32 v62, v58
    v_mov_b32 v63, v59
    v_permlane16_swap_b32 v56, v60
    v_permlane16_swap_b32 v57, v61
    v_permlane16_swap_b32 v58, v62
    v_permlane16_swap_b32 v59, v63
    v_add_f32 v28, v28, v56
    v_add_f32 v29, v29, v57
    v_add_f32 v30, v30, v58
    v_add_f32 v31, v31, v59
    v_add_f32 v28, v28, v60
    v_add_f32 v29, v29, v61
    v_add_f32 v30, v30, v62
    v_add_f32 v31, v31, v63
    v_cvt_pk_bf16_f32 v48, v28, v29
    v_cvt_pk_bf16_f32 v49, v30, v31
    s_lshr_b32 s24, s21, 1
    s_and_b32 s25, s21, 1
    s_add_u32 s26, s23, s24
    s_lshl_b32 s30, s26, 10
    s_add_u32 s44, s12, 0x11a0000
    s_addc_u32 s45, s13, 0
    s_add_u32 s44, s44, s30
    s_addc_u32 s45, s45, 0
    s_mov_b32 s46, 0x400
    s_mov_b32 s47, 0x20000
    v_mov_b32 v4, 0x80000000
    v_cndmask_b32 v28, v11, v28, s[0:1]
    v_cndmask_b32 v29, v11, v29, s[0:1]
    v_cndmask_b32 v30, v11, v30, s[0:1]
    v_cndmask_b32 v31, v11, v31, s[0:1]
    v_add_f32 v112, v28, v29
    v_mul_f32 v113, v28, v28
    v_mul_f32 v114, v29, v29
    v_add_f32 v112, v112, v30
    v_fmac_f32 v114, v30, v30
    v_add_f32 v112, v112, v31
    v_fmac_f32 v113, v31, v31
    s_waitcnt vmcnt(3)
    v_dot2c_f32_bf16 v136, s17, v96
    v_dot2c_f32_bf16 v137, s18, v96
    v_dot2c_f32_bf16 v138, s17, v97
    v_dot2c_f32_bf16 v139, s18, v97
    v_dot2c_f32_bf16 v140, s17, v98
    v_dot2c_f32_bf16 v141, s18, v98
    v_dot2c_f32_bf16 v142, s17, v99
    v_dot2c_f32_bf16 v143, s18, v99
    s_waitcnt vmcnt(2)
    v_dot2c_f32_bf16 v136, s17, v100
    v_dot2c_f32_bf16 v137, s18, v100
    v_dot2c_f32_bf16 v138, s17, v101
    v_dot2c_f32_bf16 v139, s18, v101
    v_dot2c_f32_bf16 v140, s17, v102
    v_dot2c_f32_bf16 v141, s18, v102
    v_dot2c_f32_bf16 v142, s17, v103
    v_dot2c_f32_bf16 v143, s18, v103
    s_waitcnt vmcnt(1)
    v_dot2c_f32_bf16 v136, s17, v104
    v_dot2c_f32_bf16 v137, s18, v104
    v_dot2c_f32_bf16 v138, s17, v105
    v_dot2c_f32_bf16 v139, s18, v105
    v_dot2c_f32_bf16 v140, s17, v106
    v_dot2c_f32_bf16 v141, s18, v106
    v_dot2c_f32_bf16 v142, s17, v107
    v_dot2c_f32_bf16 v143, s18, v107
    s_waitcnt vmcnt(0)
    v_dot2c_f32_bf16 v136, s17, v108
    v_dot2c_f32_bf16 v137, s18, v108
    v_dot2c_f32_bf16 v138, s17, v109
    v_dot2c_f32_bf16 v139, s18, v109
    v_dot2c_f32_bf16 v140, s17, v110
    v_dot2c_f32_bf16 v141, s18, v110
    v_dot2c_f32_bf16 v142, s17, v111
    v_dot2c_f32_bf16 v143, s18, v111
    v_permlane32_swap_b32 v128, v136
    v_permlane32_swap_b32 v129, v137
    v_permlane32_swap_b32 v130, v138
    v_permlane32_swap_b32 v131, v139
    v_permlane32_swap_b32 v132, v140
    v_permlane32_swap_b32 v133, v141
    v_permlane32_swap_b32 v134, v142
    v_permlane32_swap_b32 v135, v143
    v_add_f32 v128, v128, v136
    v_add_f32 v129, v129, v137
    v_add_f32 v130, v130, v138
    v_add_f32 v131, v131, v139
    v_add_f32 v132, v132, v140
    v_add_f32 v133, v133, v141
    v_add_f32 v134, v134, v142
    v_add_f32 v135, v135, v143
    v_dot2c_f32_bf16 v128, s17, v180
    v_dot2c_f32_bf16 v129, s18, v180
    v_dot2c_f32_bf16 v130, s17, v181
    v_dot2c_f32_bf16 v131, s18, v181
    v_dot2c_f32_bf16 v132, s17, v182
    v_dot2c_f32_bf16 v133, s18, v182
    v_dot2c_f32_bf16 v134, s17, v183
    v_dot2c_f32_bf16 v135, s18, v183
    v_cvt_pk_bf16_f32 v32, v128, v129
    v_cvt_pk_bf16_f32 v33, v130, v131
    v_cvt_pk_bf16_f32 v34, v132, v133
    v_cvt_pk_bf16_f32 v35, v134, v135
    s_cmp_eq_u32 s3, 0
    s_cbranch_scc1 .L_mlp_r0
    buffer_store_dwordx4 v[32:35], v20, s[40:43], 0 offen
    buffer_store_dwordx2 v[48:49], v21, s[40:43], 0 offen
    s_branch .L_mlp_fin
.L_mlp_r0:
    buffer_store_dwordx4 v[32:35], v20, s[40:43], 0 offen sc1
    buffer_store_dwordx2 v[48:49], v21, s[40:43], 0 offen sc1
    v_add_f32 v112, v112, v128
    v_fmac_f32 v114, v128, v128
    v_add_f32 v112, v112, v129
    v_fmac_f32 v113, v129, v129
    v_add_f32 v112, v112, v130
    v_fmac_f32 v114, v130, v130
    v_add_f32 v112, v112, v131
    v_fmac_f32 v113, v131, v131
    v_add_f32 v112, v112, v132
    v_fmac_f32 v114, v132, v132
    v_add_f32 v112, v112, v133
    v_fmac_f32 v113, v133, v133
    v_add_f32 v112, v112, v134
    v_fmac_f32 v114, v134, v134
    v_add_f32 v112, v112, v135
    v_fmac_f32 v113, v135, v135
    v_add_f32 v113, v113, v114
    v_add_f32_dpp v112, v112, v112 row_ror:8 row_mask:0xf bank_mask:0xf
    s_nop 0
    v_add_f32_dpp v113, v113, v113 row_ror:8 row_mask:0xf bank_mask:0xf
    v_mov_b32 v114, v112
    s_nop 1
    v_permlane32_swap_b32 v112, v114
    v_add_f32 v112, v112, v114
    v_mov_b32 v114, v112
    s_nop 1
    v_permlane16_swap_b32 v112, v114
    v_add_f32 v112, v112, v114
    v_mov_b32 v115, v113
    s_nop 1
    v_permlane32_swap_b32 v113, v115
    v_add_f32 v113, v113, v115
    v_mov_b32 v115, v113
    s_nop 1
    v_permlane16_swap_b32 v113, v115
    v_add_f32 v113, v113, v115
    buffer_store_dwordx2 v[112:113], v22, s[44:47], 0 offen sc1
    s_lshr_b32 s27, s26, 1
    s_lshl_b32 s27, s27, 7
    s_and_b32 s28, s26, 1
    s_lshl_b32 s28, s28, 1
    s_add_u32 s28, s28, s25
    s_lshl_b32 s28, s28, 2
    s_add_u32 s27, s27, s28
    v_mov_b32 v29, s27
    v_cmp_eq_u32 vcc, 0, v1
    v_mov_b32 v30, 1
    s_add_u32 s60, s12, 0x270d000
    s_addc_u32 s61, s13, 0
    s_mov_b32 s62, 0x2000
    s_mov_b32 s63, 0x20000
    v_cndmask_b32 v29, v4, v29, vcc
    s_and_b32 s22, s2, 3
    s_lshl_b32 s22, s22, 2
    s_bfe_u32 s23, s2, 0x20003
    s_add_u32 s22, s22, s23
    s_and_b32 s21, s2, 4
    s_lshl_b32 s21, s21, 1
    s_lshr_b32 s23, s2, 5
    s_add_u32 s21, s21, s23
    s_lshl_b32 s24, s22, 3
    s_lshl_b32 s23, s20, 1
    s_add_u32 s24, s24, s23
    s_cmp_ge_u32 s19, 4
    s_cbranch_scc1 .L_mlp_ql
    s_lshl_b32 s25, s24, 10
    s_mul_i32 s26, s24, 18432
    s_mov_b32 s52, 4096
    s_mov_b32 s53, 8192
    s_mov_b32 s54, 12288
    s_mov_b32 s55, 16384
    s_add_u32 s44, s12, 0x11a0000
    s_addc_u32 s45, s13, 0
    s_add_u32 s44, s44, s25
    s_addc_u32 s45, s45, 0
    s_mov_b32 s46, 0x800
    s_mov_b32 s47, 0x20000
    s_add_u32 s8, s12, 0xd20000
    s_addc_u32 s9, s13, 0
    s_add_u32 s8, s8, s26
    s_addc_u32 s9, s9, 0
    s_mov_b32 s10, 0x4800
    s_mov_b32 s11, 0x20000
    s_add_u32 s36, s8, 18432
    s_addc_u32 s37, s9, 0
    s_mov_b32 s38, s10
    s_mov_b32 s39, s11
    s_lshl_b32 s30, s24, 6
    s_add_u32 s32, s30, 8
    v_lshl_add_u32 v28, v1, 2, s30
    v_cmp_gt_u32 vcc, 4, v1
    v_add_u32 v10, 0x10000, v5
    v_add_u32 v11, 0x20000, v5
    v_cndmask_b32 v28, v4, v28, vcc
    s_lshl_b32 s40, s20, 7
    s_add_u32 s40, s40, 139264
    v_lshl_add_u32 v12, v3, 2, s40
    v_lshl_add_u32 v9, v2, 4, s40
    s_and_b32 s40, s20, 1
    s_lshl_b32 s41, s21, 1
    s_add_u32 s41, s41, s40
    s_mul_i32 s41, s41, 1408
    s_add_u32 s48, s12, 0x2700000
    s_addc_u32 s49, s13, 0
    s_add_u32 s48, s48, s41
    s_addc_u32 s49, s49, 0
    s_mov_b32 s50, 0x580
    s_mov_b32 s51, 0x20000
    s_cmp_lt_u32 s20, 2
    s_cselect_b64 s[56:57], -1, 0
    s_cmp_eq_u32 s40, 1
    s_cselect_b64 s[58:59], -1, 0
    v_mov_b32 v8, 0x80000000
    v_lshlrev_b32 v6, 2, v1
    v_cndmask_b32 v13, v8, v6, s[56:57]
    v_add_u32 v7, 1152, v6
    v_cmp_gt_u32 vcc, 48, v1
    s_nop 1
    v_cndmask_b32 v15, v8, v7, vcc
    v_add_u32 v7, 768, v6
    v_cndmask_b32 v15, v15, v7, s[56:57]
    v_lshlrev_b32 v6, 3, v3
    v_lshl_add_u32 v6, v2, 2, v6
    v_add_u32 v6, 1024, v6
    v_cmp_gt_u32 vcc, 2, v2
    s_nop 1
    v_cndmask_b32 v6, v8, v6, vcc
    v_and_b32 v7, 1, v3
    v_lshlrev_b32 v7, 2, v7
    v_lshl_add_u32 v7, v2, 3, v7
    v_add_u32 v7, 1344, v7
    v_cmp_gt_u32 vcc, 3, v2
    s_nop 1
    v_cndmask_b32 v7, v8, v7, vcc
    s_add_u32 s41, s40, 2
    v_lshrrev_b32 v16, 1, v3
    v_cmp_eq_u32 vcc, s41, v16
    s_nop 1
    v_cndmask_b32 v7, v8, v7, vcc
    v_cndmask_b32 v16, v7, v6, s[56:57]
    s_mul_i32 s41, s20, 5120
    v_add_u32 v17, s41, v5
    s_lshl_b32 s41, s20, 11
    s_add_u32 s41, s41, 1024
    s_cmp_lt_u32 s20, 2
    s_cselect_b32 s41, s41, 4096
    v_add_u32 v18, s41, v5
    s_lshl_b32 s41, s40, 11
    v_add_u32 v19, s41, v5
    v_and_b32 v6, 1, v3
    v_lshlrev_b32 v6, 4, v6
    v_mov_b32 v7, 0x3f80
    v_lshlrev_b32 v6, v6, v7
    v_lshrrev_b32 v7, 2, v3
    v_mov_b32 v22, 0
    v_mov_b32 v23, 0
    v_mov_b32 v26, 0
    v_mov_b32 v27, 0
    v_cmp_eq_u32 s[26:27], 0, v7
    v_cmp_eq_u32 s[28:29], 2, v7
    v_cmp_eq_u32 vcc, v7, v2
    s_nop 1
    v_cndmask_b32 v6, v22, v6, vcc
    v_and_b32 v7, 2, v3
    v_cmp_eq_u32 vcc, 0, v7
    s_nop 1
    v_cndmask_b32 v24, v22, v6, vcc
    v_cndmask_b32 v25, v6, v22, vcc
    s_lshl_b32 s41, s24, 3
    s_add_u32 s41, s41, s21
    s_xor_b32 s41, s41, 1
    s_mul_i32 s41, s41, 3072
    s_add_u32 s4, s12, 0x11e0000
    s_addc_u32 s5, s13, 0
    s_add_u32 s4, s4, s41
    s_addc_u32 s5, s5, 0
    s_mov_b32 s6, 0xc00
    s_mov_b32 s7, 0x20000
    s_mov_b32 s31, 0x358637bd
    s_waitcnt vmcnt(0)
    s_barrier
    s_cmp_lg_u32 s19, 0
    s_cbranch_scc1 .L_mlp_qf
    buffer_store_dword v30, v29, s[60:63], 0 offen sc1
.L_mlp_qf:
    s_mov_b32 s42, 0x1000
.L_mlp_qs:
    s_load_dwordx2 s[14:15], s[60:61], s30 glc
    s_load_dwordx2 s[16:17], s[60:61], s32 glc
    s_sub_u32 s42, s42, 1
    s_cbranch_scc1 .L_mlp_qss
    s_waitcnt lgkmcnt(0)
    s_and_b64 s[14:15], s[14:15], s[16:17]
    s_and_b32 s14, s14, s15
    s_cbranch_scc1 .L_mlp_qsk
    s_sleep 1
    s_branch .L_mlp_qs
.L_mlp_qss:
    s_waitcnt lgkmcnt(0)
    s_mov_b32 s42, 0x40000
.L_mlp_qp:
    buffer_load_dword v30, v28, s[60:63], 0 offen sc1
    s_waitcnt vmcnt(0)
    v_cmp_ne_u32 vcc, 0, v30
    s_sub_u32 s42, s42, 1
    s_cbranch_scc1 .L_mlp_qpx
    s_cmp_lg_u32 vcc_lo, 0xf
    s_cbranch_scc1 .L_mlp_qp
.L_mlp_qpx:
.L_mlp_qsk:
    buffer_load_dwordx4 v[28:31], v5, s[44:47], 0 offen sc1
    buffer_load_dwordx4 v[32:35], v5, s[44:47], 0 offen offset:1024 sc1
    buffer_load_dwordx4 a[0:3], v5, s[8:11], 0 offen offset:0 sc1
    buffer_load_dwordx4 a[4:7], v5, s[36:39], 0 offen offset:0 sc1
    buffer_load_dwordx4 a[8:11], v5, s[8:11], 0 offen offset:1024 sc1
    buffer_load_dwordx4 a[12:15], v5, s[36:39], 0 offen offset:1024 sc1
    buffer_load_dwordx4 a[16:19], v5, s[8:11], 0 offen offset:2048 sc1
    buffer_load_dwordx4 a[20:23], v5, s[36:39], 0 offen offset:2048 sc1
    buffer_load_dwordx4 a[24:27], v5, s[8:11], 0 offen offset:3072 sc1
    buffer_load_dwordx4 a[28:31], v5, s[36:39], 0 offen offset:3072 sc1
    buffer_load_dwordx4 a[32:35], v5, s[8:11], s52 offen offset:0 sc1
    buffer_load_dwordx4 a[36:39], v5, s[36:39], s52 offen offset:0 sc1
    buffer_load_dwordx4 a[40:43], v5, s[8:11], s52 offen offset:1024 sc1
    buffer_load_dwordx4 a[44:47], v5, s[36:39], s52 offen offset:1024 sc1
    buffer_load_dwordx4 a[48:51], v5, s[8:11], s52 offen offset:2048 sc1
    buffer_load_dwordx4 a[52:55], v5, s[36:39], s52 offen offset:2048 sc1
    buffer_load_dwordx4 a[56:59], v5, s[8:11], s52 offen offset:3072 sc1
    buffer_load_dwordx4 a[60:63], v5, s[36:39], s52 offen offset:3072 sc1
    s_barrier
    ds_read_b128 v[100:103], v5 offset:0
    ds_read_b128 v[104:107], v5 offset:1024
    ds_read_b128 v[108:111], v5 offset:2048
    ds_read_b128 v[112:115], v5 offset:3072
    ds_read_b128 v[116:119], v5 offset:4096
    ds_read_b128 v[120:123], v5 offset:5120
    ds_read_b128 v[124:127], v5 offset:6144
    s_waitcnt vmcnt(15) lgkmcnt(2)
    v_mfma_f32_16x16x32_bf16 v[76:79], a[0:3], v[116:119], 0
    ds_read_b128 v[144:147], v5 offset:11264
    s_waitcnt vmcnt(14)
    v_mfma_f32_16x16x32_bf16 v[80:83], a[4:7], v[116:119], 0
    v_add_f32 v28, v28, v30
    v_add_f32 v32, v32, v34
    v_add_f32 v29, v29, v31
    v_mfma_f32_16x16x32_bf16 v[44:47], a[0:3], v[100:103], 0
    ds_read_b128 v[128:131], v5 offset:7168
    v_mfma_f32_16x16x32_bf16 v[48:51], a[4:7], v[100:103], 0
    v_add_f32 v33, v33, v35
    v_mov_b32 v30, v28
    v_mfma_f32_16x16x32_bf16 v[60:63], a[0:3], v[108:111], 0
    ds_read_b128 v[136:139], v5 offset:9216
    v_mfma_f32_16x16x32_bf16 v[64:67], a[4:7], v[108:111], 0
    v_mov_b32 v34, v32
    v_permlane32_swap_b32 v28, v30
    s_nop 0
    v_permlane32_swap_b32 v32, v34
    v_mfma_f32_16x16x32_bf16 v[52:55], a[0:3], v[104:107], 0
    ds_read_b128 v[132:135], v5 offset:8192
    buffer_load_dwordx4 a[64:67], v5, s[8:11], s53 offen offset:0 sc1
    v_mfma_f32_16x16x32_bf16 v[56:59], a[4:7], v[104:107], 0
    v_add_f32 v28, v28, v30
    v_add_f32 v32, v32, v34
    v_mfma_f32_16x16x32_bf16 v[68:71], a[0:3], v[112:115], 0
    ds_read_b128 v[140:143], v5 offset:10240
    v_mfma_f32_16x16x32_bf16 v[72:75], a[4:7], v[112:115], 0
    v_mov_b32 v30, v28
    v_mov_b32 v34, v32
    s_nop 0
    v_permlane16_swap_b32 v28, v30
    s_waitcnt lgkmcnt(6)
    v_mfma_f32_16x16x32_bf16 v[84:87], v[120:123], a[0:3], 0
    ds_read_b128 v[148:151], v5 offset:12288
    v_mfma_f32_16x16x32_bf16 v[88:91], v[120:123], a[4:7], 0
    v_permlane16_swap_b32 v32, v34
    v_add_f32 v28, v28, v30
    s_waitcnt lgkmcnt(6)
    v_mfma_f32_16x16x32_bf16 v[92:95], v[124:127], a[0:3], 0
    ds_read_b128 v[152:155], v5 offset:13312
    v_mfma_f32_16x16x32_bf16 v[96:99], v[124:127], a[4:7], 0
    buffer_load_dwordx4 a[68:71], v5, s[36:39], s53 offen offset:0 sc1
    v_add_f32 v32, v32, v34
    v_mov_b32 v31, v29
    v_mov_b32 v35, v33
    s_waitcnt vmcnt(15) lgkmcnt(6)
    v_mfma_f32_16x16x32_bf16 v[76:79], a[8:11], v[144:147], v[76:79]
    ds_read_b128 v[116:119], v5 offset:18432
    s_waitcnt vmcnt(14)
    v_mfma_f32_16x16x32_bf16 v[80:83], a[12:15], v[144:147], v[80:83]
    v_permlane32_swap_b32 v29, v31
    v_permlane32_swap_b32 v33, v35
    s_waitcnt lgkmcnt(6)
    v_mfma_f32_16x16x32_bf16 v[44:47], a[8:11], v[128:131], v[44:47]
    ds_read_b128 v[100:103], v5 offset:14336
    v_mfma_f32_16x16x32_bf16 v[48:51], a[12:15], v[128:131], v[48:51]
    v_add_f32 v29, v29, v31
    v_add_f32 v33, v33, v35
    v_mov_b32 v31, v29
    s_waitcnt lgkmcnt(6)
    v_mfma_f32_16x16x32_bf16 v[60:63], a[8:11], v[136:139], v[60:63]
    ds_read_b128 v[108:111], v5 offset:16384
    v_mfma_f32_16x16x32_bf16 v[64:67], a[12:15], v[136:139], v[64:67]
    v_mov_b32 v35, v33
    v_permlane16_swap_b32 v29, v31
    s_waitcnt lgkmcnt(6)
    v_mfma_f32_16x16x32_bf16 v[52:55], a[8:11], v[132:135], v[52:55]
    ds_read_b128 v[104:107], v5 offset:15360
    buffer_load_dwordx4 a[0:3], v5, s[8:11], s53 offen offset:1024 sc1
    v_mfma_f32_16x16x32_bf16 v[56:59], a[12:15], v[132:135], v[56:59]
    v_permlane16_swap_b32 v33, v35
    v_add_f32 v29, v29, v31
    v_add_f32 v33, v33, v35
    s_waitcnt lgkmcnt(6)
    v_mfma_f32_16x16x32_bf16 v[68:71], a[8:11], v[140:143], v[68:71]
    ds_read_b128 v[112:115], v5 offset:17408
    v_mfma_f32_16x16x32_bf16 v[72:75], a[12:15], v[140:143], v[72:75]
    v_mul_f32 v28, 0xbae38e39, v28
    v_mul_f32 v32, 0xbae38e39, v32
    s_waitcnt lgkmcnt(6)
    v_mfma_f32_16x16x32_bf16 v[84:87], v[148:151], a[8:11], v[84:87]
    ds_read_b128 v[120:123], v5 offset:19456
    v_mfma_f32_16x16x32_bf16 v[88:91], v[148:151], a[12:15], v[88:91]
    v_mul_f32 v29, 0x3ae38e39, v29
    v_mul_f32 v33, 0x3ae38e39, v33
    s_waitcnt lgkmcnt(6)
    v_mfma_f32_16x16x32_bf16 v[92:95], v[152:155], a[8:11], v[92:95]
    ds_read_b128 v[124:127], v5 offset:20480
    v_mfma_f32_16x16x32_bf16 v[96:99], v[152:155], a[12:15], v[96:99]
    buffer_load_dwordx4 a[4:7], v5, s[36:39], s53 offen offset:1024 sc1
    v_fma_f32 v29, -v28, v28, v29
    v_fma_f32 v33, -v32, v32, v33
    v_max_f32 v29, 0, v29
    s_waitcnt vmcnt(15) lgkmcnt(6)
    v_mfma_f32_16x16x32_bf16 v[76:79], a[16:19], v[116:119], v[76:79]
    ds_read_b128 v[144:147], v5 offset:25600
    s_waitcnt vmcnt(14)
    v_mfma_f32_16x16x32_bf16 v[80:83], a[20:23], v[116:119], v[80:83]
    v_max_f32 v33, 0, v33
    v_add_f32 v30, 0x3727c5ac, v29
    s_waitcnt lgkmcnt(6)
    v_mfma_f32_16x16x32_bf16 v[44:47], a[16:19], v[100:103], v[44:47]
    ds_read_b128 v[128:131], v5 offset:21504
    v_mfma_f32_16x16x32_bf16 v[48:51], a[20:23], v[100:103], v[48:51]
    v_add_f32 v34, 0x3727c5ac, v33
    v_rsq_f32 v30, v30
    s_waitcnt lgkmcnt(6)
    v_mfma_f32_16x16x32_bf16 v[60:63], a[16:19], v[108:111], v[60:63]
    ds_read_b128 v[136:139], v5 offset:23552
    v_mfma_f32_16x16x32_bf16 v[64:67], a[20:23], v[108:111], v[64:67]
    v_rsq_f32 v34, v34
    s_waitcnt lgkmcnt(6)
    v_mfma_f32_16x16x32_bf16 v[52:55], a[16:19], v[104:107], v[52:55]
    ds_read_b128 v[132:135], v5 offset:22528
    buffer_load_dwordx4 a[8:11], v5, s[8:11], s53 offen offset:2048 sc1
    v_mfma_f32_16x16x32_bf16 v[56:59], a[20:23], v[104:107], v[56:59]
    ds_write_b32 v12, v30 offset:0
    ds_write_b32 v12, v34 offset:64
    s_waitcnt lgkmcnt(8)
    v_mfma_f32_16x16x32_bf16 v[68:71], a[16:19], v[112:115], v[68:71]
    ds_read_b128 v[140:143], v5 offset:24576
    v_mfma_f32_16x16x32_bf16 v[72:75], a[20:23], v[112:115], v[72:75]
    v_cvt_pk_bf16_f32 v31, v28, v28
    v_cvt_pk_bf16_f32 v35, v32, v32
    v_lshlrev_b32 v31, 16, v31
    s_waitcnt lgkmcnt(8)
    v_mfma_f32_16x16x32_bf16 v[84:87], v[120:123], a[16:19], v[84:87]
    ds_read_b128 v[148:151], v5 offset:26624
    v_mfma_f32_16x16x32_bf16 v[88:91], v[120:123], a[20:23], v[88:91]
    v_lshlrev_b32 v35, 16, v35
    v_sub_f32 v31, v28, v31
    s_waitcnt lgkmcnt(8)
    v_mfma_f32_16x16x32_bf16 v[92:95], v[124:127], a[16:19], v[92:95]
    ds_read_b128 v[152:155], v5 offset:27648
    v_mfma_f32_16x16x32_bf16 v[96:99], v[124:127], a[20:23], v[96:99]
    buffer_load_dwordx4 a[12:15], v5, s[36:39], s53 offen offset:2048 sc1
    v_sub_f32 v35, v32, v35
    v_cvt_pk_bf16_f32 v36, v28, v31
    s_waitcnt vmcnt(15) lgkmcnt(8)
    v_mfma_f32_16x16x32_bf16 v[76:79], a[24:27], v[144:147], v[76:79]
    ds_read_b128 v[116:119], v5 offset:32768
    s_waitcnt vmcnt(14)
    v_mfma_f32_16x16x32_bf16 v[80:83], a[28:31], v[144:147], v[80:83]
    v_cvt_pk_bf16_f32 v40, v32, v35
    v_mov_b32 v37, v36
    v_mov_b32 v41, v40
    s_waitcnt lgkmcnt(8)
    v_mfma_f32_16x16x32_bf16 v[44:47], a[24:27], v[128:131], v[44:47]
    ds_read_b128 v[100:103], v5 offset:28672
    v_mfma_f32_16x16x32_bf16 v[48:51], a[28:31], v[128:131], v[48:51]
    v_mov_b32 v38, 0
    v_mov_b32 v42, 0
    s_waitcnt lgkmcnt(8)
    v_mfma_f32_16x16x32_bf16 v[60:63], a[24:27], v[136:139], v[60:63]
    ds_read_b128 v[108:111], v5 offset:30720
    v_mfma_f32_16x16x32_bf16 v[64:67], a[28:31], v[136:139], v[64:67]
    v_mov_b32 v39, 0
    v_mov_b32 v43, 0
    ds_read_b32 v156, v12 offset:0
    s_waitcnt lgkmcnt(9)
    v_mfma_f32_16x16x32_bf16 v[52:55], a[24:27], v[132:135], v[52:55]
    ds_read_b128 v[104:107], v5 offset:29696
    buffer_load_dwordx4 a[16:19], v5, s[8:11], s53 offen offset:3072 sc1
    v_mfma_f32_16x16x32_bf16 v[56:59], a[28:31], v[132:135], v[56:59]
    ds_read_b128 v[160:163], v9 offset:0
    ds_read_b32 v158, v12 offset:64
    s_waitcnt lgkmcnt(9)
    v_mfma_f32_16x16x32_bf16 v[68:71], a[24:27], v[140:143], v[68:71]
    ds_read_b128 v[112:115], v5 offset:31744
    v_mfma_f32_16x16x32_bf16 v[72:75], a[28:31], v[140:143], v[72:75]
    ds_read_b128 v[164:167], v9 offset:64
    s_waitcnt lgkmcnt(5)
    v_mul_f32 v157, 0x3fb8aa3b, v156
    s_waitcnt lgkmcnt(2)
    v_mul_f32 v159, 0x3fb8aa3b, v158
    v_mfma_f32_16x16x32_bf16 v[84:87], v[148:151], a[24:27], v[84:87]
    ds_read_b128 v[120:123], v5 offset:33792
    v_mfma_f32_16x16x32_bf16 v[88:91], v[148:151], a[28:31], v[88:91]
    v_mul_f32 v168, 0x3fb8aa3b, v160
    v_mul_f32 v169, 0x3fb8aa3b, v161
    v_mfma_f32_16x16x32_bf16 v[92:95], v[152:155], a[24:27], v[92:95]
    ds_read_b128 v[124:127], v5 offset:34816
    v_mfma_f32_16x16x32_bf16 v[96:99], v[152:155], a[28:31], v[96:99]
    buffer_load_dwordx4 a[20:23], v5, s[36:39], s53 offen offset:3072 sc1
    v_mul_f32 v170, 0x3fb8aa3b, v162
    v_mul_f32 v171, 0x3fb8aa3b, v163
    s_waitcnt lgkmcnt(2)
    v_mul_f32 v172, 0x3fb8aa3b, v164
    s_waitcnt vmcnt(15)
    v_mfma_f32_16x16x32_bf16 v[76:79], a[32:35], v[116:119], v[76:79]
    ds_read_b128 v[144:147], v5 offset:39936
    s_waitcnt vmcnt(14)
    v_mfma_f32_16x16x32_bf16 v[80:83], a[36:39], v[116:119], v[80:83]
    v_mul_f32 v173, 0x3fb8aa3b, v165
    v_mul_f32 v174, 0x3fb8aa3b, v166
    v_mfma_f32_16x16x32_bf16 v[44:47], a[32:35], v[100:103], v[44:47]
    ds_read_b128 v[128:131], v5 offset:35840
    v_mfma_f32_16x16x32_bf16 v[48:51], a[36:39], v[100:103], v[48:51]
    v_mul_f32 v175, 0x3fb8aa3b, v167
    v_mfma_f32_16x16x32_bf16 v[60:63], a[32:35], v[108:111], v[60:63]
    ds_read_b128 v[136:139], v5 offset:37888
    v_mfma_f32_16x16x32_bf16 v[64:67], a[36:39], v[108:111], v[64:67]
    v_mfma_f32_16x16x32_bf16 v[52:55], a[32:35], v[104:107], v[52:55]
    ds_read_b128 v[132:135], v5 offset:36864
    buffer_load_dwordx4 a[24:27], v5, s[8:11], s54 offen offset:0 sc1
    v_mfma_f32_16x16x32_bf16 v[56:59], a[36:39], v[104:107], v[56:59]
    v_mfma_f32_16x16x32_bf16 v[68:71], a[32:35], v[112:115], v[68:71]
    ds_read_b128 v[140:143], v5 offset:38912
    v_mfma_f32_16x16x32_bf16 v[72:75], a[36:39], v[112:115], v[72:75]
    s_waitcnt lgkmcnt(6)
    v_mfma_f32_16x16x32_bf16 v[84:87], v[120:123], a[32:35], v[84:87]
    ds_read_b128 v[148:151], v5 offset:40960
    v_mfma_f32_16x16x32_bf16 v[88:91], v[120:123], a[36:39], v[88:91]
    s_waitcnt lgkmcnt(6)
    v_mfma_f32_16x16x32_bf16 v[92:95], v[124:127], a[32:35], v[92:95]
    ds_read_b128 v[152:155], v5 offset:41984
    v_mfma_f32_16x16x32_bf16 v[96:99], v[124:127], a[36:39], v[96:99]
    buffer_load_dwordx4 a[28:31], v5, s[36:39], s54 offen offset:0 sc1
    s_barrier
    s_waitcnt vmcnt(15) lgkmcnt(6)
    v_mfma_f32_16x16x32_bf16 v[76:79], a[40:43], v[144:147], v[76:79]
    ds_read_b128 v[116:119], v5 offset:47104
    s_waitcnt vmcnt(14)
    v_mfma_f32_16x16x32_bf16 v[80:83], a[44:47], v[144:147], v[80:83]
    s_waitcnt lgkmcnt(6)
    v_mfma_f32_16x16x32_bf16 v[44:47], a[40:43], v[128:131], v[44:47]
    ds_read_b128 v[100:103], v5 offset:43008
    v_mfma_f32_16x16x32_bf16 v[48:51], a[44:47], v[128:131], v[48:51]
    s_waitcnt lgkmcnt(6)
    v_mfma_f32_16x16x32_bf16 v[60:63], a[40:43], v[136:139], v[60:63]
    ds_read_b128 v[108:111], v5 offset:45056
    v_mfma_f32_16x16x32_bf16 v[64:67], a[44:47], v[136:139], v[64:67]
    s_waitcnt lgkmcnt(6)
    v_mfma_f32_16x16x32_bf16 v[52:55], a[40:43], v[132:135], v[52:55]
    ds_read_b128 v[104:107], v5 offset:44032
    buffer_load_dwordx4 a[32:35], v5, s[8:11], s54 offen offset:1024 sc1
    v_mfma_f32_16x16x32_bf16 v[56:59], a[44:47], v[132:135], v[56:59]
    s_waitcnt lgkmcnt(6)
    v_mfma_f32_16x16x32_bf16 v[68:71], a[40:43], v[140:143], v[68:71]
    ds_read_b128 v[112:115], v5 offset:46080
    v_mfma_f32_16x16x32_bf16 v[72:75], a[44:47], v[140:143], v[72:75]
    s_waitcnt lgkmcnt(6)
    v_mfma_f32_16x16x32_bf16 v[84:87], v[148:151], a[40:43], v[84:87]
    ds_read_b128 v[120:123], v5 offset:48128
    v_mfma_f32_16x16x32_bf16 v[88:91], v[148:151], a[44:47], v[88:91]
    s_waitcnt lgkmcnt(6)
    v_mfma_f32_16x16x32_bf16 v[92:95], v[152:155], a[40:43], v[92:95]
    ds_read_b128 v[124:127], v5 offset:49152
    v_mfma_f32_16x16x32_bf16 v[96:99], v[152:155], a[44:47], v[96:99]
    buffer_load_dwordx4 a[36:39], v5, s[36:39], s54 offen offset:1024 sc1
    s_waitcnt vmcnt(15) lgkmcnt(6)
    v_mfma_f32_16x16x32_bf16 v[76:79], a[48:51], v[116:119], v[76:79]
    ds_read_b128 v[144:147], v5 offset:54272
    s_waitcnt vmcnt(14)
    v_mfma_f32_16x16x32_bf16 v[80:83], a[52:55], v[116:119], v[80:83]
    s_waitcnt lgkmcnt(6)
    v_mfma_f32_16x16x32_bf16 v[44:47], a[48:51], v[100:103], v[44:47]
    ds_read_b128 v[128:131], v5 offset:50176
    v_mfma_f32_16x16x32_bf16 v[48:51], a[52:55], v[100:103], v[48:51]
    s_waitcnt lgkmcnt(6)
    v_mfma_f32_16x16x32_bf16 v[60:63], a[48:51], v[108:111], v[60:63]
    ds_read_b128 v[136:139], v5 offset:52224
    v_mfma_f32_16x16x32_bf16 v[64:67], a[52:55], v[108:111], v[64:67]
    s_waitcnt lgkmcnt(6)
    v_mfma_f32_16x16x32_bf16 v[52:55], a[48:51], v[104:107], v[52:55]
    ds_read_b128 v[132:135], v5 offset:51200
    buffer_load_dwordx4 a[40:43], v5, s[8:11], s54 offen offset:2048 sc1
    v_mfma_f32_16x16x32_bf16 v[56:59], a[52:55], v[104:107], v[56:59]
    s_waitcnt lgkmcnt(6)
    v_mfma_f32_16x16x32_bf16 v[68:71], a[48:51], v[112:115], v[68:71]
    ds_read_b128 v[140:143], v5 offset:53248
    v_mfma_f32_16x16x32_bf16 v[72:75], a[52:55], v[112:115], v[72:75]
    s_waitcnt lgkmcnt(6)
    v_mfma_f32_16x16x32_bf16 v[84:87], v[120:123], a[48:51], v[84:87]
    ds_read_b128 v[148:151], v5 offset:55296
    v_mfma_f32_16x16x32_bf16 v[88:91], v[120:123], a[52:55], v[88:91]
    s_waitcnt lgkmcnt(6)
    v_mfma_f32_16x16x32_bf16 v[92:95], v[124:127], a[48:51], v[92:95]
    ds_read_b128 v[152:155], v5 offset:56320
    v_mfma_f32_16x16x32_bf16 v[96:99], v[124:127], a[52:55], v[96:99]
    buffer_load_dwordx4 a[44:47], v5, s[36:39], s54 offen offset:2048 sc1
    s_waitcnt vmcnt(15) lgkmcnt(6)
    v_mfma_f32_16x16x32_bf16 v[76:79], a[56:59], v[144:147], v[76:79]
    ds_read_b128 v[116:119], v5 offset:61440
    s_waitcnt vmcnt(14)
    v_mfma_f32_16x16x32_bf16 v[80:83], a[60:63], v[144:147], v[80:83]
    s_waitcnt lgkmcnt(6)
    v_mfma_f32_16x16x32_bf16 v[44:47], a[56:59], v[128:131], v[44:47]
    ds_read_b128 v[100:103], v5 offset:57344
    v_mfma_f32_16x16x32_bf16 v[48:51], a[60:63], v[128:131], v[48:51]
    s_waitcnt lgkmcnt(6)
    v_mfma_f32_16x16x32_bf16 v[60:63], a[56:59], v[136:139], v[60:63]
    ds_read_b128 v[108:111], v5 offset:59392
    v_mfma_f32_16x16x32_bf16 v[64:67], a[60:63], v[136:139], v[64:67]
    s_waitcnt lgkmcnt(6)
    v_mfma_f32_16x16x32_bf16 v[52:55], a[56:59], v[132:135], v[52:55]
    ds_read_b128 v[104:107], v5 offset:58368
    buffer_load_dwordx4 a[48:51], v5, s[8:11], s54 offen offset:3072 sc1
    v_mfma_f32_16x16x32_bf16 v[56:59], a[60:63], v[132:135], v[56:59]
    s_waitcnt lgkmcnt(6)
    v_mfma_f32_16x16x32_bf16 v[68:71], a[56:59], v[140:143], v[68:71]
    ds_read_b128 v[112:115], v5 offset:60416
    v_mfma_f32_16x16x32_bf16 v[72:75], a[60:63], v[140:143], v[72:75]
    s_waitcnt lgkmcnt(6)
    v_mfma_f32_16x16x32_bf16 v[84:87], v[148:151], a[56:59], v[84:87]
    ds_read_b128 v[120:123], v5 offset:62464
    v_mfma_f32_16x16x32_bf16 v[88:91], v[148:151], a[60:63], v[88:91]
    s_waitcnt lgkmcnt(6)
    v_mfma_f32_16x16x32_bf16 v[92:95], v[152:155], a[56:59], v[92:95]
    ds_read_b128 v[124:127], v5 offset:63488
    v_mfma_f32_16x16x32_bf16 v[96:99], v[152:155], a[60:63], v[96:99]
    buffer_load_dwordx4 a[52:55], v5, s[36:39], s54 offen offset:3072 sc1
    s_waitcnt vmcnt(15) lgkmcnt(6)
    v_mfma_f32_16x16x32_bf16 v[76:79], a[64:67], v[116:119], v[76:79]
    ds_read_b128 v[132:135], v10 offset:3072
    s_waitcnt vmcnt(14)
    v_mfma_f32_16x16x32_bf16 v[80:83], a[68:71], v[116:119], v[80:83]
    s_waitcnt lgkmcnt(6)
    v_mfma_f32_16x16x32_bf16 v[44:47], a[64:67], v[100:103], v[44:47]
    ds_read_b128 v[136:139], v10 offset:4096
    v_mfma_f32_16x16x32_bf16 v[48:51], a[68:71], v[100:103], v[48:51]
    s_waitcnt lgkmcnt(6)
    v_mfma_f32_16x16x32_bf16 v[60:63], a[64:67], v[108:111], v[60:63]
    ds_read_b128 v[140:143], v10 offset:5120
    v_mfma_f32_16x16x32_bf16 v[64:67], a[68:71], v[108:111], v[64:67]
    s_waitcnt lgkmcnt(6)
    v_mfma_f32_16x16x32_bf16 v[52:55], a[64:67], v[104:107], v[52:55]
    ds_read_b128 v[144:147], v10 offset:10240
    buffer_load_dwordx4 a[56:59], v5, s[8:11], s55 offen offset:0 sc1
    v_mfma_f32_16x16x32_bf16 v[56:59], a[68:71], v[104:107], v[56:59]
    s_waitcnt lgkmcnt(6)
    v_mfma_f32_16x16x32_bf16 v[68:71], a[64:67], v[112:115], v[68:71]
    ds_read_b128 v[148:151], v10 offset:11264
    v_mfma_f32_16x16x32_bf16 v[72:75], a[68:71], v[112:115], v[72:75]
    s_waitcnt lgkmcnt(6)
    v_mfma_f32_16x16x32_bf16 v[84:87], v[120:123], a[64:67], v[84:87]
    ds_read_b128 v[152:155], v10 offset:12288
    v_mfma_f32_16x16x32_bf16 v[88:91], v[120:123], a[68:71], v[88:91]
    s_waitcnt lgkmcnt(6)
    v_mfma_f32_16x16x32_bf16 v[92:95], v[124:127], a[64:67], v[92:95]
    v_mfma_f32_16x16x32_bf16 v[96:99], v[124:127], a[68:71], v[96:99]
    buffer_load_dwordx4 a[60:63], v5, s[36:39], s55 offen offset:0 sc1
    s_waitcnt vmcnt(15) lgkmcnt(5)
    v_mfma_f32_16x16x32_bf16 v[76:79], a[0:3], v[132:135], v[76:79]
    ds_read_b128 v[100:103], v10 offset:17408
    s_waitcnt vmcnt(14)
    v_mfma_f32_16x16x32_bf16 v[80:83], a[4:7], v[132:135], v[80:83]
    ds_read_b128 v[104:107], v10 offset:18432
    s_waitcnt lgkmcnt(6)
    v_mfma_f32_16x16x32_bf16 v[84:87], v[136:139], a[0:3], v[84:87]
    ds_read_b128 v[108:111], v10 offset:19456
    buffer_load_dwordx4 a[64:67], v5, s[8:11], s55 offen offset:1024 sc1
    v_mfma_f32_16x16x32_bf16 v[88:91], v[136:139], a[4:7], v[88:91]
    s_waitcnt lgkmcnt(6)
    v_mfma_f32_16x16x32_bf16 v[92:95], v[140:143], a[0:3], v[92:95]
    v_mfma_f32_16x16x32_bf16 v[96:99], v[140:143], a[4:7], v[96:99]
    buffer_load_dwordx4 a[68:71], v5, s[36:39], s55 offen offset:1024 sc1
    s_waitcnt vmcnt(15) lgkmcnt(5)
    v_mfma_f32_16x16x32_bf16 v[76:79], a[8:11], v[144:147], v[76:79]
    ds_read_b128 v[112:115], v10 offset:24576
    s_waitcnt vmcnt(14)
    v_mfma_f32_16x16x32_bf16 v[80:83], a[12:15], v[144:147], v[80:83]
    ds_read_b128 v[116:119], v10 offset:25600
    s_waitcnt lgkmcnt(6)
    v_mfma_f32_16x16x32_bf16 v[84:87], v[148:151], a[8:11], v[84:87]
    ds_read_b128 v[120:123], v10 offset:26624
    v_mfma_f32_16x16x32_bf16 v[88:91], v[148:151], a[12:15], v[88:91]
    s_waitcnt lgkmcnt(6)
    v_mfma_f32_16x16x32_bf16 v[92:95], v[152:155], a[8:11], v[92:95]
    v_mfma_f32_16x16x32_bf16 v[96:99], v[152:155], a[12:15], v[96:99]
    s_waitcnt vmcnt(13) lgkmcnt(5)
    v_mfma_f32_16x16x32_bf16 v[76:79], a[16:19], v[100:103], v[76:79]
    ds_read_b128 v[132:135], v10 offset:31744
    s_waitcnt vmcnt(12)
    v_mfma_f32_16x16x32_bf16 v[80:83], a[20:23], v[100:103], v[80:83]
    ds_read_b128 v[136:139], v10 offset:32768
    s_waitcnt lgkmcnt(6)
    v_mfma_f32_16x16x32_bf16 v[84:87], v[104:107], a[16:19], v[84:87]
    ds_read_b128 v[140:143], v10 offset:33792
    v_mfma_f32_16x16x32_bf16 v[88:91], v[104:107], a[20:23], v[88:91]
    s_waitcnt lgkmcnt(6)
    v_mfma_f32_16x16x32_bf16 v[92:95], v[108:111], a[16:19], v[92:95]
    v_mfma_f32_16x16x32_bf16 v[96:99], v[108:111], a[20:23], v[96:99]
    s_waitcnt vmcnt(11) lgkmcnt(5)
    v_mfma_f32_16x16x32_bf16 v[76:79], a[24:27], v[112:115], v[76:79]
    ds_read_b128 v[144:147], v10 offset:38912
    s_waitcnt vmcnt(10)
    v_mfma_f32_16x16x32_bf16 v[80:83], a[28:31], v[112:115], v[80:83]
    ds_read_b128 v[148:151], v10 offset:39936
    s_waitcnt lgkmcnt(6)
    v_mfma_f32_16x16x32_bf16 v[84:87], v[116:119], a[24:27], v[84:87]
    ds_read_b128 v[152:155], v10 offset:40960
    v_mfma_f32_16x16x32_bf16 v[88:91], v[116:119], a[28:31], v[88:91]
    s_waitcnt lgkmcnt(6)
    v_mfma_f32_16x16x32_bf16 v[92:95], v[120:123], a[24:27], v[92:95]
    v_mfma_f32_16x16x32_bf16 v[96:99], v[120:123], a[28:31], v[96:99]
    s_waitcnt vmcnt(9) lgkmcnt(5)
    v_mfma_f32_16x16x32_bf16 v[76:79], a[32:35], v[132:135], v[76:79]
    ds_read_b128 v[100:103], v10 offset:46080
    s_waitcnt vmcnt(8)
    v_mfma_f32_16x16x32_bf16 v[80:83], a[36:39], v[132:135], v[80:83]
    ds_read_b128 v[104:107], v10 offset:47104
    s_waitcnt lgkmcnt(6)
    v_mfma_f32_16x16x32_bf16 v[84:87], v[136:139], a[32:35], v[84:87]
    ds_read_b128 v[108:111], v10 offset:48128
    v_mfma_f32_16x16x32_bf16 v[88:91], v[136:139], a[36:39], v[88:91]
    s_waitcnt lgkmcnt(6)
    v_mfma_f32_16x16x32_bf16 v[92:95], v[140:143], a[32:35], v[92:95]
    v_mfma_f32_16x16x32_bf16 v[96:99], v[140:143], a[36:39], v[96:99]
    s_waitcnt vmcnt(7) lgkmcnt(5)
    v_mfma_f32_16x16x32_bf16 v[76:79], a[40:43], v[144:147], v[76:79]
    ds_read_b128 v[132:135], v10 offset:53248
    s_waitcnt vmcnt(6)
    v_mfma_f32_16x16x32_bf16 v[80:83], a[44:47], v[144:147], v[80:83]
    ds_read_b128 v[136:139], v10 offset:54272
    s_waitcnt lgkmcnt(6)
    v_mfma_f32_16x16x32_bf16 v[84:87], v[148:151], a[40:43], v[84:87]
    ds_read_b128 v[140:143], v10 offset:55296
    v_mfma_f32_16x16x32_bf16 v[88:91], v[148:151], a[44:47], v[88:91]
    s_waitcnt lgkmcnt(6)
    v_mfma_f32_16x16x32_bf16 v[92:95], v[152:155], a[40:43], v[92:95]
    v_mfma_f32_16x16x32_bf16 v[96:99], v[152:155], a[44:47], v[96:99]
    s_waitcnt vmcnt(5) lgkmcnt(5)
    v_mfma_f32_16x16x32_bf16 v[76:79], a[48:51], v[100:103], v[76:79]
    ds_read_b128 v[112:115], v10 offset:60416
    s_waitcnt vmcnt(4)
    v_mfma_f32_16x16x32_bf16 v[80:83], a[52:55], v[100:103], v[80:83]
    ds_read_b128 v[116:119], v10 offset:61440
    s_waitcnt lgkmcnt(6)
    v_mfma_f32_16x16x32_bf16 v[84:87], v[104:107], a[48:51], v[84:87]
    ds_read_b128 v[120:123], v10 offset:62464
    v_mfma_f32_16x16x32_bf16 v[88:91], v[104:107], a[52:55], v[88:91]
    s_waitcnt lgkmcnt(6)
    v_mfma_f32_16x16x32_bf16 v[92:95], v[108:111], a[48:51], v[92:95]
    v_mfma_f32_16x16x32_bf16 v[96:99], v[108:111], a[52:55], v[96:99]
    s_waitcnt vmcnt(3) lgkmcnt(5)
    v_mfma_f32_16x16x32_bf16 v[76:79], a[56:59], v[132:135], v[76:79]
    ds_read_b128 v[100:103], v11 offset:2048
    s_waitcnt vmcnt(2)
    v_mfma_f32_16x16x32_bf16 v[80:83], a[60:63], v[132:135], v[80:83]
    ds_read_b128 v[104:107], v11 offset:3072
    s_waitcnt lgkmcnt(6)
    v_mfma_f32_16x16x32_bf16 v[84:87], v[136:139], a[56:59], v[84:87]
    ds_read_b128 v[108:111], v11 offset:4096
    v_mfma_f32_16x16x32_bf16 v[88:91], v[136:139], a[60:63], v[88:91]
    s_waitcnt lgkmcnt(6)
    v_mfma_f32_16x16x32_bf16 v[92:95], v[140:143], a[56:59], v[92:95]
    v_mfma_f32_16x16x32_bf16 v[96:99], v[140:143], a[60:63], v[96:99]
    s_waitcnt vmcnt(1) lgkmcnt(5)
    v_mfma_f32_16x16x32_bf16 v[76:79], a[64:67], v[112:115], v[76:79]
    ds_read_b128 v[132:135], v5 offset:64512
    s_waitcnt vmcnt(0)
    v_mfma_f32_16x16x32_bf16 v[80:83], a[68:71], v[112:115], v[80:83]
    ds_read_b128 v[136:139], v10 offset:0
    s_waitcnt lgkmcnt(6)
    v_mfma_f32_16x16x32_bf16 v[84:87], v[116:119], a[64:67], v[84:87]
    v_mfma_f32_16x16x32_bf16 v[88:91], v[116:119], a[68:71], v[88:91]
    s_waitcnt lgkmcnt(5)
    v_mfma_f32_16x16x32_bf16 v[92:95], v[120:123], a[64:67], v[92:95]
    v_mfma_f32_16x16x32_bf16 v[96:99], v[120:123], a[68:71], v[96:99]
    s_waitcnt lgkmcnt(4)
    v_mfma_f32_16x16x32_bf16 v[76:79], v[36:39], v[100:103], v[76:79]
    ds_read_b128 v[140:143], v10 offset:6144
    v_mfma_f32_16x16x32_bf16 v[80:83], v[40:43], v[100:103], v[80:83]
    ds_read_b128 v[144:147], v10 offset:7168
    s_waitcnt lgkmcnt(5)
    v_mfma_f32_16x16x32_bf16 v[84:87], v[104:107], v[36:39], v[84:87]
    v_mfma_f32_16x16x32_bf16 v[88:91], v[104:107], v[40:43], v[88:91]
    s_waitcnt lgkmcnt(4)
    v_mfma_f32_16x16x32_bf16 v[92:95], v[108:111], v[36:39], v[92:95]
    v_mfma_f32_16x16x32_bf16 v[96:99], v[108:111], v[40:43], v[96:99]
    s_waitcnt lgkmcnt(3)
    v_mfma_f32_16x16x32_bf16 v[44:47], a[0:3], v[132:135], v[44:47]
    ds_read_b128 v[148:151], v10 offset:13312
    v_mov_b32 v12, 0x3f803f80
    v_mul_f32 v128, v76, v160
    v_mul_f32 v129, v77, v161
    v_mul_f32 v130, v78, v162
    v_mfma_f32_16x16x32_bf16 v[48:51], a[4:7], v[132:135], v[48:51]
    ds_read_b128 v[152:155], v10 offset:14336
    v_mul_f32 v131, v79, v163
    v_mul_f32 v120, v76, v168
    v_mul_f32 v121, v77, v169
    s_waitcnt lgkmcnt(4)
    v_mfma_f32_16x16x32_bf16 v[52:55], a[0:3], v[136:139], v[52:55]
    v_mul_f32 v122, v78, v170
    v_mul_f32 v123, v79, v171
    v_max_f32 v76, 0, v76
    v_max_f32 v77, 0, v77
    v_mfma_f32_16x16x32_bf16 v[56:59], a[4:7], v[136:139], v[56:59]
    v_max_f32 v78, 0, v78
    v_max_f32 v79, 0, v79
    v_exp_f32 v120, v120 clamp
    s_waitcnt lgkmcnt(3)
    v_mfma_f32_16x16x32_bf16 v[44:47], a[8:11], v[140:143], v[44:47]
    ds_read_b128 v[132:135], v10 offset:20480
    v_exp_f32 v121, v121 clamp
    v_mfma_f32_16x16x32_bf16 v[48:51], a[12:15], v[140:143], v[48:51]
    ds_read_b128 v[136:139], v10 offset:21504
    v_exp_f32 v122, v122 clamp
    v_exp_f32 v123, v123 clamp
    s_waitcnt lgkmcnt(4)
    v_mfma_f32_16x16x32_bf16 v[52:55], a[8:11], v[144:147], v[52:55]
    v_fma_f32 v76, v76, v160, s31
    v_fma_f32 v77, v77, v161, s31
    v_fma_f32 v78, v78, v162, s31
    v_mfma_f32_16x16x32_bf16 v[56:59], a[12:15], v[144:147], v[56:59]
    v_fma_f32 v79, v79, v163, s31
    v_add_f32 v76, v76, v120
    v_add_f32 v77, v77, v121
    s_waitcnt lgkmcnt(3)
    v_mfma_f32_16x16x32_bf16 v[44:47], a[16:19], v[148:151], v[44:47]
    ds_read_b128 v[140:143], v10 offset:27648
    v_add_f32 v78, v78, v122
    v_add_f32 v79, v79, v123
    v_cndmask_b32 v76, v76, v128, s[26:27]
    v_mfma_f32_16x16x32_bf16 v[48:51], a[20:23], v[148:151], v[48:51]
    ds_read_b128 v[144:147], v10 offset:28672
    v_cndmask_b32 v77, v77, v129, s[26:27]
    v_cndmask_b32 v78, v78, v130, s[26:27]
    v_cndmask_b32 v79, v79, v131, s[26:27]
    s_waitcnt lgkmcnt(4)
    v_mfma_f32_16x16x32_bf16 v[52:55], a[16:19], v[152:155], v[52:55]
    v_cvt_pk_bf16_f32 v116, v76, v77
    v_cvt_pk_bf16_f32 v117, v78, v79
    v_mul_f32 v128, v80, v164
    v_mfma_f32_16x16x32_bf16 v[56:59], a[20:23], v[152:155], v[56:59]
    v_mul_f32 v129, v81, v165
    v_mul_f32 v130, v82, v166
    v_mul_f32 v131, v83, v167
    v_mul_f32 v124, v80, v172
    s_waitcnt lgkmcnt(3)
    v_mfma_f32_16x16x32_bf16 v[44:47], a[24:27], v[132:135], v[44:47]
    ds_read_b128 v[148:151], v10 offset:34816
    v_mul_f32 v125, v81, v173
    v_mul_f32 v126, v82, v174
    v_mul_f32 v127, v83, v175
    v_mfma_f32_16x16x32_bf16 v[48:51], a[28:31], v[132:135], v[48:51]
    ds_read_b128 v[152:155], v10 offset:35840
    v_max_f32 v80, 0, v80
    v_max_f32 v81, 0, v81
    v_max_f32 v82, 0, v82
    v_max_f32 v83, 0, v83
    s_waitcnt lgkmcnt(4)
    v_mfma_f32_16x16x32_bf16 v[52:55], a[24:27], v[136:139], v[52:55]
    v_exp_f32 v124, v124 clamp
    v_exp_f32 v125, v125 clamp
    v_mfma_f32_16x16x32_bf16 v[56:59], a[28:31], v[136:139], v[56:59]
    v_exp_f32 v126, v126 clamp
    s_waitcnt lgkmcnt(3)
    v_mfma_f32_16x16x32_bf16 v[44:47], a[32:35], v[140:143], v[44:47]
    ds_read_b128 v[132:135], v10 offset:41984
    v_exp_f32 v127, v127 clamp
    v_fma_f32 v80, v80, v164, s31
    v_fma_f32 v81, v81, v165, s31
    v_mfma_f32_16x16x32_bf16 v[48:51], a[36:39], v[140:143], v[48:51]
    ds_read_b128 v[136:139], v10 offset:43008
    v_fma_f32 v82, v82, v166, s31
    v_fma_f32 v83, v83, v167, s31
    v_add_f32 v80, v80, v124
    s_waitcnt lgkmcnt(4)
    v_mfma_f32_16x16x32_bf16 v[52:55], a[32:35], v[144:147], v[52:55]
    v_add_f32 v81, v81, v125
    v_add_f32 v82, v82, v126
    v_add_f32 v83, v83, v127
    v_mfma_f32_16x16x32_bf16 v[56:59], a[36:39], v[144:147], v[56:59]
    v_cndmask_b32 v80, v80, v128, s[26:27]
    v_cndmask_b32 v81, v81, v129, s[26:27]
    v_cndmask_b32 v82, v82, v130, s[26:27]
    s_waitcnt lgkmcnt(3)
    v_mfma_f32_16x16x32_bf16 v[44:47], a[40:43], v[148:151], v[44:47]
    ds_read_b128 v[140:143], v10 offset:49152
    v_cndmask_b32 v83, v83, v131, s[26:27]
    v_cvt_pk_bf16_f32 v118, v80, v81
    v_cvt_pk_bf16_f32 v119, v82, v83
    v_mfma_f32_16x16x32_bf16 v[48:51], a[44:47], v[148:151], v[48:51]
    ds_read_b128 v[144:147], v10 offset:50176
    v_cndmask_b32 v116, v116, v12, s[28:29]
    v_cndmask_b32 v117, v117, v12, s[28:29]
    s_waitcnt lgkmcnt(4)
    v_mfma_f32_16x16x32_bf16 v[52:55], a[40:43], v[152:155], v[52:55]
    v_cndmask_b32 v118, v118, v12, s[28:29]
    v_cndmask_b32 v119, v119, v12, s[28:29]
    ds_write_b128 v17, v[116:119] offset:4096
    v_mfma_f32_16x16x32_bf16 v[56:59], a[44:47], v[152:155], v[56:59]
    v_mfma_f32_16x16x32_bf16 v[28:31], v[116:119], v[24:27], 0
    v_mfma_f32_16x16x32_bf16 v[32:35], v[116:119], v[22:25], 0
    s_waitcnt lgkmcnt(4)
    v_mfma_f32_16x16x32_bf16 v[44:47], a[48:51], v[132:135], v[44:47]
    ds_read_b128 v[148:151], v10 offset:56320
    v_mul_f32 v120, v92, v157
    v_mul_f32 v121, v93, v157
    v_mul_f32 v122, v94, v157
    v_mul_f32 v123, v95, v157
    v_mfma_f32_16x16x32_bf16 v[48:51], a[52:55], v[132:135], v[48:51]
    ds_read_b128 v[152:155], v10 offset:57344
    v_max_f32 v92, 0, v92
    v_max_f32 v93, 0, v93
    v_max_f32 v94, 0, v94
    s_waitcnt lgkmcnt(5)
    v_mfma_f32_16x16x32_bf16 v[52:55], a[48:51], v[136:139], v[52:55]
    v_max_f32 v95, 0, v95
    v_exp_f32 v120, v120 clamp
    v_mfma_f32_16x16x32_bf16 v[56:59], a[52:55], v[136:139], v[56:59]
    v_exp_f32 v121, v121 clamp
    v_exp_f32 v122, v122 clamp
    s_waitcnt lgkmcnt(4)
    v_mfma_f32_16x16x32_bf16 v[44:47], a[56:59], v[140:143], v[44:47]
    ds_read_b128 v[132:135], v10 offset:63488
    v_exp_f32 v123, v123 clamp
    v_fma_f32 v92, v92, v156, s31
    v_mfma_f32_16x16x32_bf16 v[48:51], a[60:63], v[140:143], v[48:51]
    ds_read_b128 v[136:139], v10 offset:64512
    v_fma_f32 v93, v93, v156, s31
    v_fma_f32 v94, v94, v156, s31
    v_fma_f32 v95, v95, v156, s31
    s_waitcnt lgkmcnt(5)
    v_mfma_f32_16x16x32_bf16 v[52:55], a[56:59], v[144:147], v[52:55]
    v_add_f32 v92, v92, v120
    v_add_f32 v93, v93, v121
    v_add_f32 v94, v94, v122
    v_add_f32 v95, v95, v123
    v_mfma_f32_16x16x32_bf16 v[56:59], a[60:63], v[144:147], v[56:59]
    v_cvt_pk_bf16_f32 v92, v92, v93
    v_cvt_pk_bf16_f32 v93, v94, v95
    v_mul_f32 v124, v96, v159
    s_waitcnt lgkmcnt(3)
    v_mfma_f32_16x16x32_bf16 v[44:47], a[64:67], v[148:151], v[44:47]
    ds_read_b128 v[140:143], v10 offset:1024
    v_mul_f32 v125, v97, v159
    v_mul_f32 v126, v98, v159
    v_mul_f32 v127, v99, v159
    v_mfma_f32_16x16x32_bf16 v[48:51], a[68:71], v[148:151], v[48:51]
    ds_read_b128 v[144:147], v10 offset:2048
    v_max_f32 v96, 0, v96
    v_max_f32 v97, 0, v97
    v_max_f32 v98, 0, v98
    v_max_f32 v99, 0, v99
    s_waitcnt lgkmcnt(4)
    v_mfma_f32_16x16x32_bf16 v[52:55], a[64:67], v[152:155], v[52:55]
    v_exp_f32 v124, v124 clamp
    v_exp_f32 v125, v125 clamp
    v_mfma_f32_16x16x32_bf16 v[56:59], a[68:71], v[152:155], v[56:59]
    v_exp_f32 v126, v126 clamp
    s_waitcnt lgkmcnt(3)
    v_mfma_f32_16x16x32_bf16 v[44:47], v[36:39], v[132:135], v[44:47]
    ds_read_b128 v[148:151], v10 offset:8192
    v_exp_f32 v127, v127 clamp
    v_fma_f32 v96, v96, v158, s31
    v_fma_f32 v97, v97, v158, s31
    v_mfma_f32_16x16x32_bf16 v[48:51], v[40:43], v[132:135], v[48:51]
    ds_read_b128 v[152:155], v10 offset:9216
    v_fma_f32 v98, v98, v158, s31
    v_fma_f32 v99, v99, v158, s31
    v_add_f32 v96, v96, v124
    s_waitcnt lgkmcnt(4)
    v_mfma_f32_16x16x32_bf16 v[52:55], v[36:39], v[136:139], v[52:55]
    v_add_f32 v97, v97, v125
    v_add_f32 v98, v98, v126
    v_add_f32 v99, v99, v127
    v_mfma_f32_16x16x32_bf16 v[56:59], v[40:43], v[136:139], v[56:59]
    v_cvt_pk_bf16_f32 v94, v96, v97
    v_cvt_pk_bf16_f32 v95, v98, v99
    buffer_store_dwordx4 v[92:95], v5, s[4:7], 0 offen offset:1024 sc1
    s_waitcnt lgkmcnt(3)
    v_mfma_f32_16x16x32_bf16 v[60:63], a[0:3], v[140:143], v[60:63]
    ds_read_b128 v[132:135], v10 offset:15360
    v_mul_f32 v120, v84, v157
    v_mul_f32 v121, v85, v157
    v_mul_f32 v122, v86, v157
    v_mul_f32 v123, v87, v157
    v_mfma_f32_16x16x32_bf16 v[64:67], a[4:7], v[140:143], v[64:67]
    ds_read_b128 v[136:139], v10 offset:16384
    v_max_f32 v84, 0, v84
    v_max_f32 v85, 0, v85
    v_max_f32 v86, 0, v86
    s_waitcnt lgkmcnt(4)
    v_mfma_f32_16x16x32_bf16 v[68:71], a[0:3], v[144:147], v[68:71]
    v_max_f32 v87, 0, v87
    v_exp_f32 v120, v120 clamp
    v_mfma_f32_16x16x32_bf16 v[72:75], a[4:7], v[144:147], v[72:75]
    v_exp_f32 v121, v121 clamp
    v_exp_f32 v122, v122 clamp
    s_waitcnt lgkmcnt(3)
    v_mfma_f32_16x16x32_bf16 v[60:63], a[8:11], v[148:151], v[60:63]
    ds_read_b128 v[140:143], v10 offset:22528
    v_exp_f32 v123, v123 clamp
    v_fma_f32 v84, v84, v156, s31
    v_mfma_f32_16x16x32_bf16 v[64:67], a[12:15], v[148:151], v[64:67]
    ds_read_b128 v[144:147], v10 offset:23552
    v_fma_f32 v85, v85, v156, s31
    v_fma_f32 v86, v86, v156, s31
    v_fma_f32 v87, v87, v156, s31
    s_waitcnt lgkmcnt(4)
    v_mfma_f32_16x16x32_bf16 v[68:71], a[8:11], v[152:155], v[68:71]
    v_add_f32 v84, v84, v120
    v_add_f32 v85, v85, v121
    v_add_f32 v86, v86, v122
    v_add_f32 v87, v87, v123
    v_mfma_f32_16x16x32_bf16 v[72:75], a[12:15], v[152:155], v[72:75]
    v_cvt_pk_bf16_f32 v176, v84, v85
    v_cvt_pk_bf16_f32 v177, v86, v87
    s_waitcnt lgkmcnt(3)
    v_mfma_f32_16x16x32_bf16 v[60:63], a[16:19], v[132:135], v[60:63]
    ds_read_b128 v[148:151], v10 offset:29696
    v_cvt_pk_bf16_f32 v178, v28, v29
    v_cvt_pk_bf16_f32 v179, v30, v31
    buffer_store_dwordx4 v[176:179], v5, s[4:7], 0 offen offset:0 sc1
    v_mul_f32 v124, v88, v159
    v_mfma_f32_16x16x32_bf16 v[64:67], a[20:23], v[132:135], v[64:67]
    ds_read_b128 v[152:155], v10 offset:30720
    v_mul_f32 v125, v89, v159
    v_mul_f32 v126, v90, v159
    v_mul_f32 v127, v91, v159
    s_waitcnt lgkmcnt(4)
    v_mfma_f32_16x16x32_bf16 v[68:71], a[16:19], v[136:139], v[68:71]
    v_max_f32 v88, 0, v88
    v_max_f32 v89, 0, v89
    v_max_f32 v90, 0, v90
    v_max_f32 v91, 0, v91
    v_mfma_f32_16x16x32_bf16 v[72:75], a[20:23], v[136:139], v[72:75]
    v_exp_f32 v124, v124 clamp
    v_exp_f32 v125, v125 clamp
    s_waitcnt lgkmcnt(3)
    v_mfma_f32_16x16x32_bf16 v[60:63], a[24:27], v[140:143], v[60:63]
    ds_read_b128 v[132:135], v10 offset:36864
    v_exp_f32 v126, v126 clamp
    v_mfma_f32_16x16x32_bf16 v[64:67], a[28:31], v[140:143], v[64:67]
    ds_read_b128 v[136:139], v10 offset:37888
    v_exp_f32 v127, v127 clamp
    v_fma_f32 v88, v88, v158, s31
    v_fma_f32 v89, v89, v158, s31
    s_waitcnt lgkmcnt(4)
    v_mfma_f32_16x16x32_bf16 v[68:71], a[24:27], v[144:147], v[68:71]
    v_fma_f32 v90, v90, v158, s31
    v_fma_f32 v91, v91, v158, s31
    v_add_f32 v88, v88, v124
    v_mfma_f32_16x16x32_bf16 v[72:75], a[28:31], v[144:147], v[72:75]
    v_add_f32 v89, v89, v125
    v_add_f32 v90, v90, v126
    v_add_f32 v91, v91, v127
    s_waitcnt lgkmcnt(3)
    v_mfma_f32_16x16x32_bf16 v[60:63], a[32:35], v[148:151], v[60:63]
    ds_read_b128 v[140:143], v10 offset:44032
    v_cvt_pk_bf16_f32 v182, v88, v89
    v_cvt_pk_bf16_f32 v183, v90, v91
    v_cvt_pk_bf16_f32 v181, v32, v33
    v_mfma_f32_16x16x32_bf16 v[64:67], a[36:39], v[148:151], v[64:67]
    ds_read_b128 v[144:147], v10 offset:45056
    v_cvt_pk_bf16_f32 v180, v34, v35
    buffer_store_dwordx4 v[180:183], v5, s[4:7], 0 offen offset:2048 sc1
    v_mul_f32 v120, v44, v168
    s_waitcnt lgkmcnt(4)
    v_mfma_f32_16x16x32_bf16 v[68:71], a[32:35], v[152:155], v[68:71]
    v_mul_f32 v121, v45, v169
    v_mul_f32 v122, v46, v170
    v_mul_f32 v123, v47, v171
    v_max_f32 v44, 0, v44
    v_mfma_f32_16x16x32_bf16 v[72:75], a[36:39], v[152:155], v[72:75]
    v_max_f32 v45, 0, v45
    v_max_f32 v46, 0, v46
    v_max_f32 v47, 0, v47
    s_waitcnt lgkmcnt(3)
    v_mfma_f32_16x16x32_bf16 v[60:63], a[40:43], v[132:135], v[60:63]
    ds_read_b128 v[148:151], v10 offset:51200
    v_exp_f32 v120, v120 clamp
    v_exp_f32 v121, v121 clamp
    v_mfma_f32_16x16x32_bf16 v[64:67], a[44:47], v[132:135], v[64:67]
    ds_read_b128 v[152:155], v10 offset:52224
    v_exp_f32 v122, v122 clamp
    v_exp_f32 v123, v123 clamp
    s_waitcnt lgkmcnt(4)
    v_mfma_f32_16x16x32_bf16 v[68:71], a[40:43], v[136:139], v[68:71]
    v_fma_f32 v44, v44, v160, s31
    v_fma_f32 v45, v45, v161, s31
    v_mfma_f32_16x16x32_bf16 v[72:75], a[44:47], v[136:139], v[72:75]
    v_fma_f32 v46, v46, v162, s31
    v_fma_f32 v47, v47, v163, s31
    v_add_f32 v44, v44, v120
    s_waitcnt lgkmcnt(3)
    v_mfma_f32_16x16x32_bf16 v[60:63], a[48:51], v[140:143], v[60:63]
    ds_read_b128 v[132:135], v10 offset:58368
    v_add_f32 v45, v45, v121
    v_add_f32 v46, v46, v122
    v_add_f32 v47, v47, v123
    v_mfma_f32_16x16x32_bf16 v[64:67], a[52:55], v[140:143], v[64:67]
    ds_read_b128 v[136:139], v10 offset:59392
    v_cvt_pk_bf16_f32 v100, v44, v45
    v_cvt_pk_bf16_f32 v101, v46, v47
    v_mul_f32 v124, v48, v172
    v_mul_f32 v125, v49, v173
    s_waitcnt lgkmcnt(4)
    v_mfma_f32_16x16x32_bf16 v[68:71], a[48:51], v[144:147], v[68:71]
    v_mul_f32 v126, v50, v174
    v_mul_f32 v127, v51, v175
    v_max_f32 v48, 0, v48
    v_mfma_f32_16x16x32_bf16 v[72:75], a[52:55], v[144:147], v[72:75]
    v_max_f32 v49, 0, v49
    v_max_f32 v50, 0, v50
    v_max_f32 v51, 0, v51
    s_waitcnt lgkmcnt(3)
    v_mfma_f32_16x16x32_bf16 v[60:63], a[56:59], v[148:151], v[60:63]
    ds_read_b128 v[140:143], v11 offset:0
    v_exp_f32 v124, v124 clamp
    v_exp_f32 v125, v125 clamp
    v_mfma_f32_16x16x32_bf16 v[64:67], a[60:63], v[148:151], v[64:67]
    ds_read_b128 v[144:147], v11 offset:1024
    v_exp_f32 v126, v126 clamp
    v_exp_f32 v127, v127 clamp
    s_waitcnt lgkmcnt(4)
    v_mfma_f32_16x16x32_bf16 v[68:71], a[56:59], v[152:155], v[68:71]
    v_fma_f32 v48, v48, v164, s31
    v_fma_f32 v49, v49, v165, s31
    v_mfma_f32_16x16x32_bf16 v[72:75], a[60:63], v[152:155], v[72:75]
    v_fma_f32 v50, v50, v166, s31
    v_fma_f32 v51, v51, v167, s31
    v_add_f32 v48, v48, v124
    v_add_f32 v49, v49, v125
    s_waitcnt lgkmcnt(3)
    v_mfma_f32_16x16x32_bf16 v[60:63], a[64:67], v[132:135], v[60:63]
    v_add_f32 v50, v50, v126
    v_add_f32 v51, v51, v127
    v_cvt_pk_bf16_f32 v102, v48, v49
    v_mfma_f32_16x16x32_bf16 v[64:67], a[68:71], v[132:135], v[64:67]
    v_cvt_pk_bf16_f32 v103, v50, v51
    ds_write_b128 v17, v[100:103] offset:0
    s_waitcnt lgkmcnt(3)
    v_mfma_f32_16x16x32_bf16 v[68:71], a[64:67], v[136:139], v[68:71]
    v_mul_f32 v52, v52, v160
    v_mul_f32 v53, v53, v161
    v_mul_f32 v54, v54, v162
    v_mfma_f32_16x16x32_bf16 v[72:75], a[68:71], v[136:139], v[72:75]
    v_mul_f32 v55, v55, v163
    v_cvt_pk_bf16_f32 v104, v52, v53
    v_cvt_pk_bf16_f32 v105, v54, v55
    s_waitcnt lgkmcnt(2)
    v_mfma_f32_16x16x32_bf16 v[60:63], v[36:39], v[140:143], v[60:63]
    v_mul_f32 v56, v56, v164
    v_mul_f32 v57, v57, v165
    v_mul_f32 v58, v58, v166
    v_mfma_f32_16x16x32_bf16 v[64:67], v[40:43], v[140:143], v[64:67]
    v_mul_f32 v59, v59, v167
    v_cvt_pk_bf16_f32 v106, v56, v57
    v_cvt_pk_bf16_f32 v107, v58, v59
    s_waitcnt lgkmcnt(1)
    v_mfma_f32_16x16x32_bf16 v[68:71], v[36:39], v[144:147], v[68:71]
    ds_write_b128 v17, v[104:107] offset:1024
    v_mfma_f32_16x16x32_bf16 v[72:75], v[40:43], v[144:147], v[72:75]
    v_mul_f32 v120, v60, v168
    v_mul_f32 v121, v61, v169
    v_mul_f32 v122, v62, v170
    v_mul_f32 v123, v63, v171
    v_max_f32 v60, 0, v60
    v_max_f32 v61, 0, v61
    v_max_f32 v62, 0, v62
    v_max_f32 v63, 0, v63
    v_exp_f32 v120, v120 clamp
    v_exp_f32 v121, v121 clamp
    v_exp_f32 v122, v122 clamp
    v_exp_f32 v123, v123 clamp
    v_fma_f32 v60, v60, v160, s31
    v_fma_f32 v61, v61, v161, s31
    v_fma_f32 v62, v62, v162, s31
    v_fma_f32 v63, v63, v163, s31
    v_add_f32 v60, v60, v120
    v_add_f32 v61, v61, v121
    v_add_f32 v62, v62, v122
    v_add_f32 v63, v63, v123
    v_cvt_pk_bf16_f32 v108, v60, v61
    v_cvt_pk_bf16_f32 v109, v62, v63
    v_mul_f32 v124, v64, v172
    v_mul_f32 v125, v65, v173
    v_mul_f32 v126, v66, v174
    v_mul_f32 v127, v67, v175
    v_max_f32 v64, 0, v64
    v_max_f32 v65, 0, v65
    v_max_f32 v66, 0, v66
    v_max_f32 v67, 0, v67
    v_exp_f32 v124, v124 clamp
    v_exp_f32 v125, v125 clamp
    v_exp_f32 v126, v126 clamp
    v_exp_f32 v127, v127 clamp
    v_fma_f32 v64, v64, v164, s31
    v_fma_f32 v65, v65, v165, s31
    v_fma_f32 v66, v66, v166, s31
    v_fma_f32 v67, v67, v167, s31
    v_add_f32 v64, v64, v124
    v_add_f32 v65, v65, v125
    v_add_f32 v66, v66, v126
    v_add_f32 v67, v67, v127
    v_cvt_pk_bf16_f32 v110, v64, v65
    v_cvt_pk_bf16_f32 v111, v66, v67
    ds_write_b128 v17, v[108:111] offset:2048
    v_mul_f32 v68, v68, v160
    v_mul_f32 v69, v69, v161
    v_mul_f32 v70, v70, v162
    v_mul_f32 v71, v71, v163
    v_cvt_pk_bf16_f32 v112, v68, v69
    v_cvt_pk_bf16_f32 v113, v70, v71
    v_mul_f32 v72, v72, v164
    v_mul_f32 v73, v73, v165
    v_mul_f32 v74, v74, v166
    v_mul_f32 v75, v75, v167
    v_cvt_pk_bf16_f32 v114, v72, v73
    v_cvt_pk_bf16_f32 v115, v74, v75
    ds_write_b128 v17, v[112:115] offset:3072
    s_waitcnt lgkmcnt(0)
    s_barrier
    ds_read_b128 a[0:3], v18 offset:0
    ds_read_b128 a[4:7], v19 offset:0
    ds_read_b128 a[8:11], v5 offset:4096
    ds_read_b128 a[12:15], v18 offset:5120
    ds_read_b128 a[16:19], v19 offset:5120
    ds_read_b128 a[20:23], v5 offset:9216
    ds_read_b128 a[24:27], v18 offset:10240
    ds_read_b128 a[28:31], v19 offset:10240
    ds_read_b128 a[32:35], v5 offset:14336
    ds_read_b128 a[36:39], v18 offset:15360
    ds_read_b128 a[40:43], v19 offset:15360
    ds_read_b128 a[44:47], v5 offset:19456
    s_waitcnt lgkmcnt(10)
    v_mfma_f32_16x16x32_bf16 v[132:135], a[0:3], a[4:7], 0
    s_waitcnt lgkmcnt(9)
    v_mfma_f32_16x16x32_bf16 v[136:139], a[8:11], a[0:3], 0
    s_waitcnt lgkmcnt(7)
    v_mfma_f32_16x16x32_bf16 v[132:135], a[12:15], a[16:19], v[132:135]
    s_waitcnt lgkmcnt(6)
    v_mfma_f32_16x16x32_bf16 v[136:139], a[20:23], a[12:15], v[136:139]
    s_waitcnt lgkmcnt(4)
    v_mfma_f32_16x16x32_bf16 v[132:135], a[24:27], a[28:31], v[132:135]
    s_waitcnt lgkmcnt(3)
    v_mfma_f32_16x16x32_bf16 v[136:139], a[32:35], a[24:27], v[136:139]
    s_waitcnt lgkmcnt(1)
    v_mfma_f32_16x16x32_bf16 v[132:135], a[36:39], a[40:43], v[132:135]
    s_waitcnt lgkmcnt(0)
    v_mfma_f32_16x16x32_bf16 v[136:139], a[44:47], a[36:39], v[136:139]
    s_nop 5
    buffer_atomic_add_f32 v132, v13, s[48:51], 0 offen offset:0 sc1
    buffer_atomic_add_f32 v133, v13, s[48:51], 0 offen offset:256 sc1
    buffer_atomic_add_f32 v134, v13, s[48:51], 0 offen offset:512 sc1
    v_cndmask_b32 v128, v132, v134, s[58:59]
    v_cndmask_b32 v129, v133, v135, s[58:59]
    v_cndmask_b32 v130, v136, v138, s[58:59]
    v_cndmask_b32 v131, v137, v139, s[58:59]
    v_permlane16_swap_b32 v128, v129
    s_nop 0
    v_permlane16_swap_b32 v130, v131
    v_cndmask_b32 v128, v128, v135, s[56:57]
    v_cndmask_b32 v130, v130, v131, s[56:57]
    buffer_atomic_add_f32 v128, v15, s[48:51], 0 offen sc1
    buffer_atomic_add_f32 v130, v16, s[48:51], 0 offen sc1
    s_lshr_b32 s18, s21, 1
    s_lshl_b32 s18, s18, 7
    s_lshr_b32 s17, s24, 2
    s_lshl_b32 s17, s17, 10
    s_add_u32 s17, s17, s18
    s_add_u32 s17, s17, 4
    s_branch .L_mlp_l1
.L_mlp_ql:
    s_mul_i32 s28, s21, 136192
    s_lshl_b32 s30, s20, 12
    s_lshl_b32 s32, s20, 11
    s_add_u32 s32, s32, 131072
    s_add_u32 s16, s12, 0xa50000
    s_addc_u32 s17, s13, 0
    s_add_u32 s16, s16, s28
    s_addc_u32 s17, s17, 0
    s_mov_b32 s18, 0x21400
    s_mov_b32 s19, 0x20000
    s_add_u32 m0, s30, 0
    s_nop 0
    buffer_load_dwordx4 v5, s[16:19], m0 offen offset:0 lds
    buffer_load_dwordx4 v5, s[16:19], m0 offen offset:1024 lds
    buffer_load_dwordx4 v5, s[16:19], m0 offen offset:2048 lds
    buffer_load_dwordx4 v5, s[16:19], m0 offen offset:3072 lds
    s_waitcnt vmcnt(4)
    s_barrier
    s_add_u32 m0, s30, 16384
    s_nop 0
    buffer_load_dwordx4 v5, s[16:19], m0 offen offset:0 lds
    buffer_load_dwordx4 v5, s[16:19], m0 offen offset:1024 lds
    buffer_load_dwordx4 v5, s[16:19], m0 offen offset:2048 lds
    buffer_load_dwordx4 v5, s[16:19], m0 offen offset:3072 lds
    s_add_u32 m0, s30, 32768
    s_nop 0
    buffer_load_dwordx4 v5, s[16:19], m0 offen offset:0 lds
    buffer_load_dwordx4 v5, s[16:19], m0 offen offset:1024 lds
    buffer_load_dwordx4 v5, s[16:19], m0 offen offset:2048 lds
    buffer_load_dwordx4 v5, s[16:19], m0 offen offset:3072 lds
    s_add_u32 m0, s30, 49152
    s_nop 0
    buffer_load_dwordx4 v5, s[16:19], m0 offen offset:0 lds
    buffer_load_dwordx4 v5, s[16:19], m0 offen offset:1024 lds
    buffer_load_dwordx4 v5, s[16:19], m0 offen offset:2048 lds
    buffer_load_dwordx4 v5, s[16:19], m0 offen offset:3072 lds
    s_add_u32 m0, s30, 65536
    s_nop 0
    buffer_load_dwordx4 v5, s[16:19], m0 offen offset:0 lds
    buffer_load_dwordx4 v5, s[16:19], m0 offen offset:1024 lds
    buffer_load_dwordx4 v5, s[16:19], m0 offen offset:2048 lds
    buffer_load_dwordx4 v5, s[16:19], m0 offen offset:3072 lds
    s_add_u32 m0, s30, 81920
    s_nop 0
    buffer_load_dwordx4 v5, s[16:19], m0 offen offset:0 lds
    buffer_load_dwordx4 v5, s[16:19], m0 offen offset:1024 lds
    buffer_load_dwordx4 v5, s[16:19], m0 offen offset:2048 lds
    buffer_load_dwordx4 v5, s[16:19], m0 offen offset:3072 lds
    s_add_u32 m0, s30, 98304
    s_nop 0
    buffer_load_dwordx4 v5, s[16:19], m0 offen offset:0 lds
    buffer_load_dwordx4 v5, s[16:19], m0 offen offset:1024 lds
    buffer_load_dwordx4 v5, s[16:19], m0 offen offset:2048 lds
    buffer_load_dwordx4 v5, s[16:19], m0 offen offset:3072 lds
    s_add_u32 m0, s30, 114688
    s_nop 0
    buffer_load_dwordx4 v5, s[16:19], m0 offen offset:0 lds
    buffer_load_dwordx4 v5, s[16:19], m0 offen offset:1024 lds
    buffer_load_dwordx4 v5, s[16:19], m0 offen offset:2048 lds
    buffer_load_dwordx4 v5, s[16:19], m0 offen offset:3072 lds
    s_mov_b32 m0, s32
    s_nop 0
    buffer_load_dwordx4 v5, s[16:19], m0 offen offset:0 lds
    buffer_load_dwordx4 v5, s[16:19], m0 offen offset:1024 lds
    s_waitcnt vmcnt(22)
    s_barrier
    s_waitcnt vmcnt(0)
    s_barrier
.L_mlp_l1:
    s_mov_b32 s3, 1
    s_branch .L_mlp_l0
.L_mlp_fin:
.L_mlp_end:
    s_endpgm

.section .rodata,"a"
.p2align 6
.amdhsa_kernel interleave_layers__linear_attn_block__mixer_channel_mlp__prompt_kernel
  .amdhsa_next_free_vgpr 256
  .amdhsa_next_free_sgpr 102
  .amdhsa_accum_offset 184
  .amdhsa_group_segment_fixed_size 0
  .amdhsa_kernarg_size 88
  .amdhsa_user_sgpr_count 2
  .amdhsa_user_sgpr_kernarg_segment_ptr 1
  .amdhsa_system_sgpr_workgroup_id_x 1
.end_amdhsa_kernel
```
